```python
import torch

def _softmax(x, axis=-1):
    return torch.softmax(x, dim=axis)
def _gelu(x):
    return torch.nn.functional.gelu(x, approximate="tanh")
def _silu(x):
    return torch.nn.functional.silu(x)
def _sigmoid(x):
    return torch.sigmoid(x)
def _layernorm(x, axis=-1, eps=1e-5):
    m = x.mean(dim=axis, keepdim=True)
    v = x.var(dim=axis, keepdim=True, unbiased=False)
    return (x - m) / torch.sqrt(v + eps)
def _scatter_add(tgt, idx, src, axis=0):
    return tgt.clone().index_add_(axis, idx, src)
def _segment_sum(src, seg, n):
    out = torch.zeros((n,) + src.shape[1:], dtype=src.dtype)
    return out.index_add_(0, seg, src)
def _pad(x, pw):
    flat = tuple(v for pair in reversed(pw) for v in pair)
    return torch.nn.functional.pad(x, flat)

kernel_name = 'concat_heads__gqa_block_cached__gqa_block_cached__near_ridge'

def setup_inputs():

    _w = (lambda a: (lambda t: t.to(torch.bfloat16) if t.is_floating_point() else t)(torch.as_tensor(a)))
    def _A_setup():
        B, Sq, D = 8, 112, 576
        Hq, Hkv, Sk, Dh = 32, 16, 512, 128
        assert Hq % Hkv == 0, (Hq, Hkv)
        return {
            "x": _w((lambda *s: torch.randn(*s, dtype=torch.bfloat16) * 0.8)(B, Sq, D)),
            "k_cache": _w((lambda *s: torch.randn(*s, dtype=torch.bfloat16) * 0.8)(B, Hkv, Sk, Dh)),
            "v_cache": _w((lambda *s: torch.randn(*s, dtype=torch.bfloat16) * 0.05)(B, Hkv, Sk, Dh)),
            "wq": _w((lambda *s: torch.randn(*s, dtype=torch.bfloat16) * 0.8)(D, Hq * Dh) * (D ** -0.5)),
            "wo": _w((lambda *s: torch.randn(*s, dtype=torch.bfloat16) * 0.05)(Hq * Dh, D) * ((Hq * Dh) ** -0.5)),
        }
    _A_in = _A_setup()

    def _B_setup():
        B, Sq, D = 8, 112, 576
        Hq, Hkv, Sk, Dh = 32, 16, 512, 128
        assert Hq % Hkv == 0, (Hq, Hkv)
        return {
            "x": _w((lambda *s: torch.randn(*s, dtype=torch.bfloat16) * 0.8)(B, Sq, D)),
            "k_cache": _w((lambda *s: torch.randn(*s, dtype=torch.bfloat16) * 0.8)(B, Hkv, Sk, Dh)),
            "v_cache": _w((lambda *s: torch.randn(*s, dtype=torch.bfloat16) * 0.05)(B, Hkv, Sk, Dh)),
            "wq": _w((lambda *s: torch.randn(*s, dtype=torch.bfloat16) * 0.8)(D, Hq * Dh) * (D ** -0.5)),
            "wo": _w((lambda *s: torch.randn(*s, dtype=torch.bfloat16) * 0.05)(Hq * Dh, D) * ((Hq * Dh) ** -0.5)),
        }
    _B_in = _B_setup()

    return {
        "A_x": _A_in["x"],
        "A_k_cache": _A_in["k_cache"],
        "A_v_cache": _A_in["v_cache"],
        "A_wq": _A_in["wq"],
        "A_wo": _A_in["wo"],
        "B_x": _B_in["x"],
        "B_k_cache": _B_in["k_cache"],
        "B_v_cache": _B_in["v_cache"],
        "B_wq": _B_in["wq"],
        "B_wo": _B_in["wo"],
    }

def reference(A_x, A_k_cache, A_v_cache, A_wq, A_wo, B_x, B_k_cache, B_v_cache, B_wq, B_wo):
    def _A_ref(x, k_cache, v_cache, wq, wo):
        B, Sq, D = x.shape
        Hq, Dh = 32, 128
        Hkv = k_cache.shape[1]
        rep = Hq // Hkv
        q = (lambda x, *d: x.permute(*d))((x @ wq).reshape(B, Sq, Hq, Dh), 0, 2, 1, 3)
        k = (lambda x, n, axis: torch.repeat_interleave(x, n, dim=axis))(k_cache, rep, axis=1)
        v = (lambda x, n, axis: torch.repeat_interleave(x, n, dim=axis))(v_cache, rep, axis=1)
        scores = torch.einsum("bhqd,bhkd->bhqk", q, k) * (Dh ** -0.5)
        p = _softmax(scores, axis=-1)
        o = torch.einsum("bhqk,bhkd->bhqd", p, v)
        return (lambda x, *d: x.permute(*d))(o, 0, 2, 1, 3).reshape(B, Sq, Hq * Dh) @ wo

    def _B_ref(x, k_cache, v_cache, wq, wo):
        B, Sq, D = x.shape
        Hq, Dh = 32, 128
        Hkv = k_cache.shape[1]
        rep = Hq // Hkv
        q = (lambda x, *d: x.permute(*d))((x @ wq).reshape(B, Sq, Hq, Dh), 0, 2, 1, 3)
        k = (lambda x, n, axis: torch.repeat_interleave(x, n, dim=axis))(k_cache, rep, axis=1)
        v = (lambda x, n, axis: torch.repeat_interleave(x, n, dim=axis))(v_cache, rep, axis=1)
        scores = torch.einsum("bhqd,bhkd->bhqk", q, k) * (Dh ** -0.5)
        p = _softmax(scores, axis=-1)
        o = torch.einsum("bhqk,bhkd->bhqd", p, v)
        return (lambda x, *d: x.permute(*d))(o, 0, 2, 1, 3).reshape(B, Sq, Hq * Dh) @ wo

    a = _A_ref(A_x, A_k_cache, A_v_cache, A_wq, A_wo)
    b = _B_ref(B_x, B_k_cache, B_v_cache, B_wq, B_wo)
    return torch.concatenate([a, b], axis=-1)
```

```asm
; @launch grid=(256,1,1) block=(512,1,1) lds=158720
.amdgcn_target "amdgcn-amd-amdhsa--gfx950"
.text
.globl concat_heads__gqa_block_cached__gqa_block_cached__near_ridge_kernel
.p2align 8
.type concat_heads__gqa_block_cached__gqa_block_cached__near_ridge_kernel,@function
concat_heads__gqa_block_cached__gqa_block_cached__near_ridge_kernel:
    s_cmp_ge_u32 s2, 256
    s_cbranch_scc1 concat_heads__gqa_block_cached__gqa_block_cached__near_ridge_kernel_exit
    s_load_dwordx8 s[4:11], s[0:1], 0
    s_load_dwordx8 s[12:19], s[0:1], 40
    s_load_dwordx2 s[40:41], s[0:1], 96
    s_load_dwordx2 s[68:69], s[0:1], 32
    s_load_dwordx2 s[70:71], s[0:1], 72
    s_load_dwordx4 s[76:79], s[0:1], 80
    s_bfe_u32 s43, s2, 0x10002
    s_lshr_b32 s42, s2, 5
    s_and_b32 s44, s2, 3
    s_lshl_b32 s44, s44, 2
    s_bfe_u32 s46, s2, 0x20003
    s_add_u32 s44, s44, s46
    v_lshrrev_b32 v1, 6, v0
    s_nop 1
    v_readfirstlane_b32 s45, v1
    v_and_b32 v2, 63, v0
    s_mov_b32 s57, 157696
    s_bfe_u32 s62, s2, 0x40003
    s_lshl_b32 s62, s62, 13
    s_mov_b32 s48, 0x3e0293ee
    s_mov_b32 s49, s48
    s_mov_b32 s50, 0xbe0293ee
    s_mov_b32 s51, 0x427af233
    s_lshl_b32 s52, s45, 10
    s_lshl_b32 s53, s45, 15
    s_lshl_b32 s54, s45, 11
    s_min_u32 s55, s45, 6
    s_lshl_b32 s55, s55, 11
    s_bfe_u32 s46, s2, 0x20003
    s_add_u32 s46, s46, s42
    s_and_b32 s46, s46, 1
    s_mul_i32 s46, s46, 4
    s_lshl_b32 s97, s46, 7
    s_lshl_b32 s96, s46, 19
    s_cmp_eq_u32 s45, 7
    s_cbranch_scc1 concat_heads__gqa_block_cached__gqa_block_cached__near_ridge_kernel_w7
    v_lshrrev_b32 v11, 5, v2
    v_bfe_u32 v12, v2, 1, 4
    v_and_b32 v13, 1, v2
    v_lshlrev_b32 v13, 4, v13
    s_bfe_u32 s46, s45, 0x10001
    s_lshl_b32 s46, s46, 2
    v_add_u32 v14, 0, v11
    v_or_b32 v15, s46, v14
    v_xor_b32 v15, v15, v12
    v_lshlrev_b32 v15, 5, v15
    v_lshlrev_b32 v14, 13, v14
    v_add3_u32 v3, v14, v15, v13
    v_add_u32 v14, 2, v11
    v_or_b32 v15, s46, v14
    v_xor_b32 v15, v15, v12
    v_lshlrev_b32 v15, 5, v15
    v_lshlrev_b32 v14, 13, v14
    v_add3_u32 v4, v14, v15, v13
    v_lshrrev_b32 v11, 3, v2
    s_lshl_b32 s46, s45, 4
    v_add_u32 v11, s46, v11
    s_movk_i32 s46, 1152
    v_mul_lo_u32 v11, v11, s46
    v_lshrrev_b32 v12, 4, v2
    v_and_b32 v13, 7, v2
    v_xor_b32 v12, v12, v13
    v_lshl_add_u32 v5, v12, 4, v11
    v_xor_b32 v12, 4, v12
    v_lshl_add_u32 v9, v12, 4, v11
    v_add_u32 v9, 9216, v9
    s_waitcnt lgkmcnt(0)
    s_cmp_eq_u32 s43, 0
    s_cselect_b32 s4, s4, s12
    s_cselect_b32 s5, s5, s13
    s_cselect_b32 s6, s6, s14
    s_cselect_b32 s7, s7, s15
    s_cselect_b32 s8, s8, s16
    s_cselect_b32 s9, s9, s17
    s_cselect_b32 s10, s10, s18
    s_cselect_b32 s11, s11, s19
    s_mul_i32 s46, s42, 129024
    s_add_u32 s20, s4, s46
    s_addc_u32 s21, s5, 0
    s_mov_b32 s22, 129024
    s_mov_b32 s23, 0x00020000
    s_lshl_b32 s46, s44, 9
    s_add_u32 s24, s10, s46
    s_addc_u32 s25, s11, 0
    s_sub_u32 s26, 4718592, s46
    s_mov_b32 s27, 0x00020000
    s_add_u32 m0, s54, 116736
    s_add_u32 s47, s53, s96
    buffer_load_dwordx4 v3, s[24:27], s47 offen lds
    s_add_u32 m0, s54, 117760
    s_add_u32 s47, s53, s96
    buffer_load_dwordx4 v4, s[24:27], s47 offen lds
    s_add_u32 s96, s96, 262144
    s_cmp_ge_u32 s96, 4718592
    s_cselect_b32 s96, 0, s96
    s_add_u32 m0, s55, 0
    s_mov_b32 s47, s97
    buffer_load_dwordx4 v5, s[20:23], s47 offen lds
    s_add_u32 m0, s55, 1024
    s_mov_b32 s47, s97
    buffer_load_dwordx4 v9, s[20:23], s47 offen lds
    s_add_u32 s97, s97, 128
    s_cmp_ge_u32 s97, 1152
    s_cselect_b32 s97, 0, s97
    s_add_u32 m0, s54, 133120
    s_add_u32 s47, s53, s96
    buffer_load_dwordx4 v3, s[24:27], s47 offen lds
    s_add_u32 m0, s54, 134144
    s_add_u32 s47, s53, s96
    buffer_load_dwordx4 v4, s[24:27], s47 offen lds
    s_add_u32 s96, s96, 262144
    s_cmp_ge_u32 s96, 4718592
    s_cselect_b32 s96, 0, s96
    s_add_u32 m0, s54, 43008
    s_add_u32 s47, s53, s96
    buffer_load_dwordx4 v3, s[24:27], s47 offen lds
    s_add_u32 m0, s54, 44032
    s_add_u32 s47, s53, s96
    buffer_load_dwordx4 v4, s[24:27], s47 offen lds
    s_add_u32 s96, s96, 262144
    s_cmp_ge_u32 s96, 4718592
    s_cselect_b32 s96, 0, s96
    s_add_u32 m0, s55, 14336
    s_mov_b32 s47, s97
    buffer_load_dwordx4 v5, s[20:23], s47 offen lds
    s_add_u32 m0, s55, 15360
    s_mov_b32 s47, s97
    buffer_load_dwordx4 v9, s[20:23], s47 offen lds
    s_add_u32 s97, s97, 128
    s_cmp_ge_u32 s97, 1152
    s_cselect_b32 s97, 0, s97
    s_lshl_b32 s46, s42, 4
    s_add_u32 s46, s46, s44
    s_lshl_b32 s46, s46, 17
    s_add_u32 s28, s6, s46
    s_addc_u32 s29, s7, 0
    s_mov_b32 s30, 131072
    s_mov_b32 s31, 0x00020000
    s_add_u32 s32, s8, s46
    s_addc_u32 s33, s9, 0
    s_mov_b32 s34, 131072
    s_mov_b32 s35, 0x00020000
    s_lshl_b32 s47, s43, 3
    s_add_u32 s47, s47, s42
    s_mul_i32 s46, s47, 2129920
    s_add_u32 s88, s40, s46
    s_addc_u32 s89, s41, 0
    s_mov_b32 s90, 2127872
    s_mov_b32 s91, 0x00020000
    s_mul_i32 s46, s44, 133120
    s_add_u32 s36, s88, s46
    s_addc_u32 s37, s89, 0
    s_mov_b32 s38, 131072
    s_mov_b32 s39, 0x00020000
    s_mov_b32 s80, s76
    s_mov_b32 s81, s77
    s_mov_b32 s82, 2064384
    s_mov_b32 s83, 0x00020000
    s_lshl_b32 s46, s47, 4
    s_add_u32 s84, s78, s46
    s_addc_u32 s85, s79, 0
    s_mov_b32 s86, 16
    s_mov_b32 s87, 0x00020000
    s_cmp_eq_u32 s43, 0
    s_cselect_b32 s72, s68, s70
    s_cselect_b32 s73, s69, s71
    s_mul_i32 s46, s44, 294912
    s_add_u32 s72, s72, s46
    s_addc_u32 s73, s73, 0
    s_mov_b32 s74, 294912
    s_mov_b32 s75, 0x00020000
    v_lshrrev_b32 v11, 4, v2
    v_bfe_u32 v12, v2, 2, 2
    v_and_b32 v13, 3, v2
    v_lshlrev_b32 v14, 3, v11
    v_add_u32 v14, v14, v12
    v_lshlrev_b32 v14, 9, v14
    v_lshlrev_b32 v13, 3, v13
    v_add_u32 v14, v14, v13
    v_and_b32 v15, 1, v11
    v_lshlrev_b32 v15, 2, v15
    v_or_b32 v15, v15, v12
    s_lshl_b32 s46, s45, 1
    s_add_u32 s47, s46, 0
    v_xor_b32 v16, s47, v15
    v_lshlrev_b32 v16, 5, v16
    v_add_u32 v6, v14, v16
    s_add_u32 s47, s46, 1
    v_xor_b32 v16, s47, v15
    v_lshlrev_b32 v16, 5, v16
    v_add_u32 v7, v14, v16
    v_add_u32 v10, 83968, v6
    v_add_u32 v29, 83968, v7
    v_add_u32 v6, 43008, v6
    v_add_u32 v7, 43008, v7
    v_bfe_u32 v12, v2, 1, 3
    v_xor_b32 v12, v12, v11
    v_lshlrev_b32 v12, 4, v12
    v_and_b32 v14, 15, v2
    v_lshl_add_u32 v8, v14, 7, v12
    v_xor_b32 v31, 64, v8
    s_bfe_u32 s61, s45, 0x10001
    s_and_b32 s59, s45, 1
    v_lshrrev_b32 v11, 5, v2
    v_bfe_u32 v12, v2, 1, 4
    v_and_b32 v13, 1, v2
    v_lshlrev_b32 v13, 4, v13
    s_lshl_b32 s46, s61, 2
    v_add_u32 v14, 0, v11
    v_or_b32 v15, s46, v14
    v_xor_b32 v15, v15, v12
    v_lshlrev_b32 v15, 5, v15
    v_mul_u32_u24 v14, 1152, v14
    v_add3_u32 v26, v14, v15, v13
    v_add_u32 v14, 2, v11
    v_or_b32 v15, s46, v14
    v_xor_b32 v15, v15, v12
    v_lshlrev_b32 v15, 5, v15
    v_mul_u32_u24 v14, 1152, v14
    v_add3_u32 v27, v14, v15, v13
    s_lshl_b32 s46, s59, 1
    v_lshrrev_b32 v11, 3, v2
    v_mul_u32_u24 v11, 1152, v11
    v_bfe_u32 v12, v2, 1, 2
    v_bfe_u32 v14, v2, 4, 1
    v_or_b32 v14, s46, v14
    v_xor_b32 v14, v14, v12
    v_lshlrev_b32 v14, 5, v14
    v_add3_u32 v28, v11, v14, v13
    s_cmp_lt_u32 s45, 4
    s_cselect_b32 s46, 0, 0x7ff00000
    v_add_u32 v28, s46, v28
    s_mul_i32 s92, s45, 4608
    s_lshl_b32 s93, s92, 1
    s_add_u32 s94, s52, 16384
    v_mov_b32 v128, 0
    v_mov_b32 v129, 0
    v_mov_b32 v130, 0
    v_mov_b32 v131, 0
    v_mov_b32 v132, 0
    v_mov_b32 v133, 0
    v_mov_b32 v134, 0
    v_mov_b32 v135, 0
    v_mov_b32 v136, 0
    v_mov_b32 v137, 0
    v_mov_b32 v138, 0
    v_mov_b32 v139, 0
    v_mov_b32 v140, 0
    v_mov_b32 v141, 0
    v_mov_b32 v142, 0
    v_mov_b32 v143, 0
    v_mov_b32 v144, 0
    v_mov_b32 v145, 0
    v_mov_b32 v146, 0
    v_mov_b32 v147, 0
    v_mov_b32 v148, 0
    v_mov_b32 v149, 0
    v_mov_b32 v150, 0
    v_mov_b32 v151, 0
    v_mov_b32 v152, 0
    v_mov_b32 v153, 0
    v_mov_b32 v154, 0
    v_mov_b32 v155, 0
    v_mov_b32 v156, 0
    v_mov_b32 v157, 0
    v_mov_b32 v158, 0
    v_mov_b32 v159, 0
    v_mov_b32 v160, 0
    v_mov_b32 v161, 0
    v_mov_b32 v162, 0
    v_mov_b32 v163, 0
    v_mov_b32 v164, 0
    v_mov_b32 v165, 0
    v_mov_b32 v166, 0
    v_mov_b32 v167, 0
    v_mov_b32 v168, 0
    v_mov_b32 v169, 0
    v_mov_b32 v170, 0
    v_mov_b32 v171, 0
    v_mov_b32 v172, 0
    v_mov_b32 v173, 0
    v_mov_b32 v174, 0
    v_mov_b32 v175, 0
    v_mov_b32 v176, 0
    v_mov_b32 v177, 0
    v_mov_b32 v178, 0
    v_mov_b32 v179, 0
    v_mov_b32 v180, 0
    v_mov_b32 v181, 0
    v_mov_b32 v182, 0
    v_mov_b32 v183, 0
    s_waitcnt vmcnt(6)
    s_barrier
    s_add_u32 m0, s54, 83968
    s_add_u32 s47, s53, s96
    buffer_load_dwordx4 v3, s[24:27], s47 offen lds
    s_add_u32 m0, s54, 84992
    s_add_u32 s47, s53, s96
    buffer_load_dwordx4 v4, s[24:27], s47 offen lds
    s_add_u32 s96, s96, 262144
    s_cmp_ge_u32 s96, 4718592
    s_cselect_b32 s96, 0, s96
    s_add_u32 m0, s54, 100352
    s_add_u32 s47, s53, s96
    buffer_load_dwordx4 v3, s[24:27], s47 offen lds
    s_add_u32 m0, s54, 101376
    s_add_u32 s47, s53, s96
    buffer_load_dwordx4 v4, s[24:27], s47 offen lds
    s_add_u32 s96, s96, 262144
    s_cmp_ge_u32 s96, 4718592
    s_cselect_b32 s96, 0, s96
    s_add_u32 m0, s55, 28672
    s_mov_b32 s47, s97
    buffer_load_dwordx4 v5, s[20:23], s47 offen lds
    s_add_u32 m0, s55, 29696
    s_mov_b32 s47, s97
    buffer_load_dwordx4 v9, s[20:23], s47 offen lds
    s_add_u32 s97, s97, 128
    s_cmp_ge_u32 s97, 1152
    s_cselect_b32 s97, 0, s97
    ds_read_b64_tr_b16 v[32:33], v10 offset:32768
    ds_read_b64_tr_b16 v[34:35], v10 offset:34816
    ds_read_b64_tr_b16 v[36:37], v29 offset:32768
    ds_read_b64_tr_b16 v[38:39], v29 offset:34816
    ds_read_b128 v[48:51], v8 offset:0
    ds_read_b128 v[52:55], v8 offset:2048
    ds_read_b128 v[56:59], v8 offset:4096
    ds_read_b128 v[60:63], v8 offset:6144
    ds_read_b128 v[64:67], v8 offset:8192
    ds_read_b128 v[68:71], v8 offset:10240
    ds_read_b128 v[72:75], v8 offset:12288
    s_waitcnt vmcnt(10) lgkmcnt(0)
    s_barrier
    v_mfma_f32_16x16x32_bf16 v[128:131], v[32:35], v[48:51], v[128:131]
    s_add_u32 m0, s54, 116736
    s_add_u32 s47, s53, s96
    buffer_load_dwordx4 v3, s[24:27], s47 offen lds
    s_add_u32 m0, s54, 117760
    s_add_u32 s47, s53, s96
    buffer_load_dwordx4 v4, s[24:27], s47 offen lds
    s_add_u32 s96, s96, 262144
    s_cmp_ge_u32 s96, 4718592
    s_cselect_b32 s96, 0, s96
    v_mfma_f32_16x16x32_bf16 v[132:135], v[32:35], v[52:55], v[132:135]
    ds_read_b64_tr_b16 v[40:41], v10 offset:49152
    ds_read_b64_tr_b16 v[42:43], v10 offset:51200
    v_mfma_f32_16x16x32_bf16 v[136:139], v[32:35], v[56:59], v[136:139]
    ds_read_b64_tr_b16 v[44:45], v29 offset:49152
    ds_read_b64_tr_b16 v[46:47], v29 offset:51200
    v_mfma_f32_16x16x32_bf16 v[140:143], v[32:35], v[60:63], v[140:143]
    ds_read_b128 v[76:79], v31 offset:0
    ds_read_b128 v[80:83], v31 offset:2048
    v_mfma_f32_16x16x32_bf16 v[144:147], v[32:35], v[64:67], v[144:147]
    ds_read_b128 v[84:87], v31 offset:4096
    v_mfma_f32_16x16x32_bf16 v[148:151], v[32:35], v[68:71], v[148:151]
    ds_read_b128 v[88:91], v31 offset:6144
    v_mfma_f32_16x16x32_bf16 v[152:155], v[32:35], v[72:75], v[152:155]
    ds_read_b128 v[92:95], v31 offset:8192
    v_mfma_f32_16x16x32_bf16 v[156:159], v[36:39], v[48:51], v[156:159]
    ds_read_b128 v[96:99], v31 offset:10240
    v_mfma_f32_16x16x32_bf16 v[160:163], v[36:39], v[52:55], v[160:163]
    ds_read_b128 v[100:103], v31 offset:12288
    v_mfma_f32_16x16x32_bf16 v[164:167], v[36:39], v[56:59], v[164:167]
    v_mfma_f32_16x16x32_bf16 v[168:171], v[36:39], v[60:63], v[168:171]
    v_mfma_f32_16x16x32_bf16 v[172:175], v[36:39], v[64:67], v[172:175]
    v_mfma_f32_16x16x32_bf16 v[176:179], v[36:39], v[68:71], v[176:179]
    v_mfma_f32_16x16x32_bf16 v[180:183], v[36:39], v[72:75], v[180:183]
    s_waitcnt vmcnt(8) lgkmcnt(0)
    s_barrier
    v_mfma_f32_16x16x32_bf16 v[128:131], v[40:43], v[76:79], v[128:131]
    s_add_u32 m0, s54, 133120
    s_add_u32 s47, s53, s96
    buffer_load_dwordx4 v3, s[24:27], s47 offen lds
    s_add_u32 m0, s54, 134144
    s_add_u32 s47, s53, s96
    buffer_load_dwordx4 v4, s[24:27], s47 offen lds
    s_add_u32 s96, s96, 262144
    s_cmp_ge_u32 s96, 4718592
    s_cselect_b32 s96, 0, s96
    s_add_u32 m0, s55, 0
    s_mov_b32 s47, s97
    buffer_load_dwordx4 v5, s[20:23], s47 offen lds
    v_mfma_f32_16x16x32_bf16 v[132:135], v[40:43], v[80:83], v[132:135]
    ds_read_b64_tr_b16 v[32:33], v6 offset:0
    ds_read_b64_tr_b16 v[34:35], v6 offset:2048
    v_mfma_f32_16x16x32_bf16 v[136:139], v[40:43], v[84:87], v[136:139]
    ds_read_b64_tr_b16 v[36:37], v7 offset:0
    ds_read_b64_tr_b16 v[38:39], v7 offset:2048
    v_mfma_f32_16x16x32_bf16 v[140:143], v[40:43], v[88:91], v[140:143]
    ds_read_b128 v[48:51], v8 offset:14336
    ds_read_b128 v[52:55], v8 offset:16384
    v_mfma_f32_16x16x32_bf16 v[144:147], v[40:43], v[92:95], v[144:147]
    ds_read_b128 v[56:59], v8 offset:18432
    v_mfma_f32_16x16x32_bf16 v[148:151], v[40:43], v[96:99], v[148:151]
    ds_read_b128 v[60:63], v8 offset:20480
    v_mfma_f32_16x16x32_bf16 v[152:155], v[40:43], v[100:103], v[152:155]
    ds_read_b128 v[64:67], v8 offset:22528
    v_mfma_f32_16x16x32_bf16 v[156:159], v[44:47], v[76:79], v[156:159]
    ds_read_b128 v[68:71], v8 offset:24576
    v_mfma_f32_16x16x32_bf16 v[160:163], v[44:47], v[80:83], v[160:163]
    ds_read_b128 v[72:75], v8 offset:26624
    v_mfma_f32_16x16x32_bf16 v[164:167], v[44:47], v[84:87], v[164:167]
    v_mfma_f32_16x16x32_bf16 v[168:171], v[44:47], v[88:91], v[168:171]
    v_mfma_f32_16x16x32_bf16 v[172:175], v[44:47], v[92:95], v[172:175]
    v_mfma_f32_16x16x32_bf16 v[176:179], v[44:47], v[96:99], v[176:179]
    v_mfma_f32_16x16x32_bf16 v[180:183], v[44:47], v[100:103], v[180:183]
    s_waitcnt vmcnt(9) lgkmcnt(0)
    s_barrier
    v_mfma_f32_16x16x32_bf16 v[128:131], v[32:35], v[48:51], v[128:131]
    s_add_u32 m0, s54, 43008
    s_add_u32 s47, s53, s96
    buffer_load_dwordx4 v3, s[24:27], s47 offen lds
    s_add_u32 m0, s54, 44032
    s_add_u32 s47, s53, s96
    buffer_load_dwordx4 v4, s[24:27], s47 offen lds
    s_add_u32 s96, s96, 262144
    s_cmp_ge_u32 s96, 4718592
    s_cselect_b32 s96, 0, s96
    s_add_u32 m0, s55, 1024
    s_mov_b32 s47, s97
    buffer_load_dwordx4 v9, s[20:23], s47 offen lds
    s_add_u32 s97, s97, 128
    s_cmp_ge_u32 s97, 1152
    s_cselect_b32 s97, 0, s97
    v_mfma_f32_16x16x32_bf16 v[132:135], v[32:35], v[52:55], v[132:135]
    ds_read_b64_tr_b16 v[40:41], v10 offset:0
    ds_read_b64_tr_b16 v[42:43], v10 offset:2048
    v_mfma_f32_16x16x32_bf16 v[136:139], v[32:35], v[56:59], v[136:139]
    ds_read_b64_tr_b16 v[44:45], v29 offset:0
    ds_read_b64_tr_b16 v[46:47], v29 offset:2048
    v_mfma_f32_16x16x32_bf16 v[140:143], v[32:35], v[60:63], v[140:143]
    ds_read_b128 v[76:79], v31 offset:14336
    ds_read_b128 v[80:83], v31 offset:16384
    v_mfma_f32_16x16x32_bf16 v[144:147], v[32:35], v[64:67], v[144:147]
    ds_read_b128 v[84:87], v31 offset:18432
    v_mfma_f32_16x16x32_bf16 v[148:151], v[32:35], v[68:71], v[148:151]
    ds_read_b128 v[88:91], v31 offset:20480
    v_mfma_f32_16x16x32_bf16 v[152:155], v[32:35], v[72:75], v[152:155]
    ds_read_b128 v[92:95], v31 offset:22528
    v_mfma_f32_16x16x32_bf16 v[156:159], v[36:39], v[48:51], v[156:159]
    ds_read_b128 v[96:99], v31 offset:24576
    v_mfma_f32_16x16x32_bf16 v[160:163], v[36:39], v[52:55], v[160:163]
    ds_read_b128 v[100:103], v31 offset:26624
    v_mfma_f32_16x16x32_bf16 v[164:167], v[36:39], v[56:59], v[164:167]
    v_mfma_f32_16x16x32_bf16 v[168:171], v[36:39], v[60:63], v[168:171]
    v_mfma_f32_16x16x32_bf16 v[172:175], v[36:39], v[64:67], v[172:175]
    v_mfma_f32_16x16x32_bf16 v[176:179], v[36:39], v[68:71], v[176:179]
    v_mfma_f32_16x16x32_bf16 v[180:183], v[36:39], v[72:75], v[180:183]
    s_waitcnt vmcnt(8) lgkmcnt(0)
    s_barrier
    v_mfma_f32_16x16x32_bf16 v[128:131], v[40:43], v[76:79], v[128:131]
    s_add_u32 m0, s54, 83968
    s_add_u32 s47, s53, s96
    buffer_load_dwordx4 v3, s[24:27], s47 offen lds
    s_add_u32 m0, s54, 84992
    s_add_u32 s47, s53, s96
    buffer_load_dwordx4 v4, s[24:27], s47 offen lds
    s_add_u32 s96, s96, 262144
    s_cmp_ge_u32 s96, 4718592
    s_cselect_b32 s96, 0, s96
    s_add_u32 m0, s55, 14336
    s_mov_b32 s47, s97
    buffer_load_dwordx4 v5, s[20:23], s47 offen lds
    v_mfma_f32_16x16x32_bf16 v[132:135], v[40:43], v[80:83], v[132:135]
    ds_read_b64_tr_b16 v[32:33], v10 offset:16384
    ds_read_b64_tr_b16 v[34:35], v10 offset:18432
    v_mfma_f32_16x16x32_bf16 v[136:139], v[40:43], v[84:87], v[136:139]
    ds_read_b64_tr_b16 v[36:37], v29 offset:16384
    ds_read_b64_tr_b16 v[38:39], v29 offset:18432
    v_mfma_f32_16x16x32_bf16 v[140:143], v[40:43], v[88:91], v[140:143]
    ds_read_b128 v[48:51], v8 offset:28672
    ds_read_b128 v[52:55], v8 offset:30720
    v_mfma_f32_16x16x32_bf16 v[144:147], v[40:43], v[92:95], v[144:147]
    ds_read_b128 v[56:59], v8 offset:32768
    v_mfma_f32_16x16x32_bf16 v[148:151], v[40:43], v[96:99], v[148:151]
    ds_read_b128 v[60:63], v8 offset:34816
    v_mfma_f32_16x16x32_bf16 v[152:155], v[40:43], v[100:103], v[152:155]
    ds_read_b128 v[64:67], v8 offset:36864
    v_mfma_f32_16x16x32_bf16 v[156:159], v[44:47], v[76:79], v[156:159]
    ds_read_b128 v[68:71], v8 offset:38912
    v_mfma_f32_16x16x32_bf16 v[160:163], v[44:47], v[80:83], v[160:163]
    ds_read_b128 v[72:75], v8 offset:40960
    v_mfma_f32_16x16x32_bf16 v[164:167], v[44:47], v[84:87], v[164:167]
    v_mfma_f32_16x16x32_bf16 v[168:171], v[44:47], v[88:91], v[168:171]
    v_mfma_f32_16x16x32_bf16 v[172:175], v[44:47], v[92:95], v[172:175]
    v_mfma_f32_16x16x32_bf16 v[176:179], v[44:47], v[96:99], v[176:179]
    v_mfma_f32_16x16x32_bf16 v[180:183], v[44:47], v[100:103], v[180:183]
    s_waitcnt vmcnt(9) lgkmcnt(0)
    s_barrier
    v_mfma_f32_16x16x32_bf16 v[128:131], v[32:35], v[48:51], v[128:131]
    s_add_u32 m0, s54, 100352
    s_add_u32 s47, s53, s96
    buffer_load_dwordx4 v3, s[24:27], s47 offen lds
    s_add_u32 m0, s54, 101376
    s_add_u32 s47, s53, s96
    buffer_load_dwordx4 v4, s[24:27], s47 offen lds
    s_add_u32 s96, s96, 262144
    s_cmp_ge_u32 s96, 4718592
    s_cselect_b32 s96, 0, s96
    s_add_u32 m0, s55, 15360
    s_mov_b32 s47, s97
    buffer_load_dwordx4 v9, s[20:23], s47 offen lds
    s_add_u32 s97, s97, 128
    s_cmp_ge_u32 s97, 1152
    s_cselect_b32 s97, 0, s97
    v_mfma_f32_16x16x32_bf16 v[132:135], v[32:35], v[52:55], v[132:135]
    ds_read_b64_tr_b16 v[40:41], v10 offset:32768
    ds_read_b64_tr_b16 v[42:43], v10 offset:34816
    v_mfma_f32_16x16x32_bf16 v[136:139], v[32:35], v[56:59], v[136:139]
    ds_read_b64_tr_b16 v[44:45], v29 offset:32768
    ds_read_b64_tr_b16 v[46:47], v29 offset:34816
    v_mfma_f32_16x16x32_bf16 v[140:143], v[32:35], v[60:63], v[140:143]
    ds_read_b128 v[76:79], v31 offset:28672
    ds_read_b128 v[80:83], v31 offset:30720
    v_mfma_f32_16x16x32_bf16 v[144:147], v[32:35], v[64:67], v[144:147]
    ds_read_b128 v[84:87], v31 offset:32768
    v_mfma_f32_16x16x32_bf16 v[148:151], v[32:35], v[68:71], v[148:151]
    ds_read_b128 v[88:91], v31 offset:34816
    v_mfma_f32_16x16x32_bf16 v[152:155], v[32:35], v[72:75], v[152:155]
    ds_read_b128 v[92:95], v31 offset:36864
    v_mfma_f32_16x16x32_bf16 v[156:159], v[36:39], v[48:51], v[156:159]
    ds_read_b128 v[96:99], v31 offset:38912
    v_mfma_f32_16x16x32_bf16 v[160:163], v[36:39], v[52:55], v[160:163]
    ds_read_b128 v[100:103], v31 offset:40960
    v_mfma_f32_16x16x32_bf16 v[164:167], v[36:39], v[56:59], v[164:167]
    v_mfma_f32_16x16x32_bf16 v[168:171], v[36:39], v[60:63], v[168:171]
    v_mfma_f32_16x16x32_bf16 v[172:175], v[36:39], v[64:67], v[172:175]
    v_mfma_f32_16x16x32_bf16 v[176:179], v[36:39], v[68:71], v[176:179]
    v_mfma_f32_16x16x32_bf16 v[180:183], v[36:39], v[72:75], v[180:183]
    s_waitcnt vmcnt(6) lgkmcnt(0)
    s_barrier
    v_mfma_f32_16x16x32_bf16 v[128:131], v[40:43], v[76:79], v[128:131]
    s_add_u32 m0, s54, 116736
    s_add_u32 s47, s53, s96
    buffer_load_dwordx4 v3, s[24:27], s47 offen lds
    s_add_u32 m0, s54, 117760
    s_add_u32 s47, s53, s96
    buffer_load_dwordx4 v4, s[24:27], s47 offen lds
    s_add_u32 s96, s96, 262144
    s_cmp_ge_u32 s96, 4718592
    s_cselect_b32 s96, 0, s96
    s_add_u32 m0, s55, 28672
    s_mov_b32 s47, s97
    buffer_load_dwordx4 v5, s[20:23], s47 offen lds
    v_mfma_f32_16x16x32_bf16 v[132:135], v[40:43], v[80:83], v[132:135]
    ds_read_b64_tr_b16 v[32:33], v10 offset:49152
    ds_read_b64_tr_b16 v[34:35], v10 offset:51200
    v_mfma_f32_16x16x32_bf16 v[136:139], v[40:43], v[84:87], v[136:139]
    ds_read_b64_tr_b16 v[36:37], v29 offset:49152
    ds_read_b64_tr_b16 v[38:39], v29 offset:51200
    v_mfma_f32_16x16x32_bf16 v[140:143], v[40:43], v[88:91], v[140:143]
    ds_read_b128 v[48:51], v8 offset:0
    ds_read_b128 v[52:55], v8 offset:2048
    v_mfma_f32_16x16x32_bf16 v[144:147], v[40:43], v[92:95], v[144:147]
    ds_read_b128 v[56:59], v8 offset:4096
    v_mfma_f32_16x16x32_bf16 v[148:151], v[40:43], v[96:99], v[148:151]
    ds_read_b128 v[60:63], v8 offset:6144
    v_mfma_f32_16x16x32_bf16 v[152:155], v[40:43], v[100:103], v[152:155]
    ds_read_b128 v[64:67], v8 offset:8192
    v_mfma_f32_16x16x32_bf16 v[156:159], v[44:47], v[76:79], v[156:159]
    ds_read_b128 v[68:71], v8 offset:10240
    v_mfma_f32_16x16x32_bf16 v[160:163], v[44:47], v[80:83], v[160:163]
    ds_read_b128 v[72:75], v8 offset:12288
    v_mfma_f32_16x16x32_bf16 v[164:167], v[44:47], v[84:87], v[164:167]
    v_mfma_f32_16x16x32_bf16 v[168:171], v[44:47], v[88:91], v[168:171]
    v_mfma_f32_16x16x32_bf16 v[172:175], v[44:47], v[92:95], v[172:175]
    v_mfma_f32_16x16x32_bf16 v[176:179], v[44:47], v[96:99], v[176:179]
    v_mfma_f32_16x16x32_bf16 v[180:183], v[44:47], v[100:103], v[180:183]
    s_waitcnt lgkmcnt(0)
    s_barrier
    v_mfma_f32_16x16x32_bf16 v[128:131], v[32:35], v[48:51], v[128:131]
    s_add_u32 m0, s54, 133120
    s_add_u32 s47, s53, s96
    buffer_load_dwordx4 v3, s[24:27], s47 offen lds
    s_add_u32 m0, s54, 134144
    s_add_u32 s47, s53, s96
    buffer_load_dwordx4 v4, s[24:27], s47 offen lds
    s_add_u32 s96, s96, 262144
    s_cmp_ge_u32 s96, 4718592
    s_cselect_b32 s96, 0, s96
    s_add_u32 m0, s55, 29696
    s_mov_b32 s47, s97
    buffer_load_dwordx4 v9, s[20:23], s47 offen lds
    s_add_u32 s97, s97, 128
    s_cmp_ge_u32 s97, 1152
    s_cselect_b32 s97, 0, s97
    v_mfma_f32_16x16x32_bf16 v[132:135], v[32:35], v[52:55], v[132:135]
    ds_read_b64_tr_b16 v[40:41], v6 offset:0
    ds_read_b64_tr_b16 v[42:43], v6 offset:2048
    v_mfma_f32_16x16x32_bf16 v[136:139], v[32:35], v[56:59], v[136:139]
    ds_read_b64_tr_b16 v[44:45], v7 offset:0
    ds_read_b64_tr_b16 v[46:47], v7 offset:2048
    v_mfma_f32_16x16x32_bf16 v[140:143], v[32:35], v[60:63], v[140:143]
    ds_read_b128 v[76:79], v31 offset:0
    ds_read_b128 v[80:83], v31 offset:2048
    v_mfma_f32_16x16x32_bf16 v[144:147], v[32:35], v[64:67], v[144:147]
    ds_read_b128 v[84:87], v31 offset:4096
    v_mfma_f32_16x16x32_bf16 v[148:151], v[32:35], v[68:71], v[148:151]
    ds_read_b128 v[88:91], v31 offset:6144
    v_mfma_f32_16x16x32_bf16 v[152:155], v[32:35], v[72:75], v[152:155]
    ds_read_b128 v[92:95], v31 offset:8192
    v_mfma_f32_16x16x32_bf16 v[156:159], v[36:39], v[48:51], v[156:159]
    ds_read_b128 v[96:99], v31 offset:10240
    v_mfma_f32_16x16x32_bf16 v[160:163], v[36:39], v[52:55], v[160:163]
    ds_read_b128 v[100:103], v31 offset:12288
    v_mfma_f32_16x16x32_bf16 v[164:167], v[36:39], v[56:59], v[164:167]
    v_mfma_f32_16x16x32_bf16 v[168:171], v[36:39], v[60:63], v[168:171]
    v_mfma_f32_16x16x32_bf16 v[172:175], v[36:39], v[64:67], v[172:175]
    v_mfma_f32_16x16x32_bf16 v[176:179], v[36:39], v[68:71], v[176:179]
    v_mfma_f32_16x16x32_bf16 v[180:183], v[36:39], v[72:75], v[180:183]
    s_waitcnt vmcnt(6) lgkmcnt(0)
    s_barrier
    v_mfma_f32_16x16x32_bf16 v[128:131], v[40:43], v[76:79], v[128:131]
    s_add_u32 m0, s54, 43008
    s_add_u32 s47, s53, s96
    buffer_load_dwordx4 v3, s[24:27], s47 offen lds
    s_add_u32 m0, s54, 44032
    s_add_u32 s47, s53, s96
    buffer_load_dwordx4 v4, s[24:27], s47 offen lds
    s_add_u32 s96, s96, 262144
    s_cmp_ge_u32 s96, 4718592
    s_cselect_b32 s96, 0, s96
    s_add_u32 m0, s55, 0
    s_mov_b32 s47, s97
    buffer_load_dwordx4 v5, s[20:23], s47 offen lds
    v_mfma_f32_16x16x32_bf16 v[132:135], v[40:43], v[80:83], v[132:135]
    ds_read_b64_tr_b16 v[32:33], v10 offset:0
    ds_read_b64_tr_b16 v[34:35], v10 offset:2048
    v_mfma_f32_16x16x32_bf16 v[136:139], v[40:43], v[84:87], v[136:139]
    ds_read_b64_tr_b16 v[36:37], v29 offset:0
    ds_read_b64_tr_b16 v[38:39], v29 offset:2048
    v_mfma_f32_16x16x32_bf16 v[140:143], v[40:43], v[88:91], v[140:143]
    ds_read_b128 v[48:51], v8 offset:14336
    ds_read_b128 v[52:55], v8 offset:16384
    v_mfma_f32_16x16x32_bf16 v[144:147], v[40:43], v[92:95], v[144:147]
    ds_read_b128 v[56:59], v8 offset:18432
    v_mfma_f32_16x16x32_bf16 v[148:151], v[40:43], v[96:99], v[148:151]
    ds_read_b128 v[60:63], v8 offset:20480
    v_mfma_f32_16x16x32_bf16 v[152:155], v[40:43], v[100:103], v[152:155]
    ds_read_b128 v[64:67], v8 offset:22528
    v_mfma_f32_16x16x32_bf16 v[156:159], v[44:47], v[76:79], v[156:159]
    ds_read_b128 v[68:71], v8 offset:24576
    v_mfma_f32_16x16x32_bf16 v[160:163], v[44:47], v[80:83], v[160:163]
    ds_read_b128 v[72:75], v8 offset:26624
    v_mfma_f32_16x16x32_bf16 v[164:167], v[44:47], v[84:87], v[164:167]
    v_mfma_f32_16x16x32_bf16 v[168:171], v[44:47], v[88:91], v[168:171]
    v_mfma_f32_16x16x32_bf16 v[172:175], v[44:47], v[92:95], v[172:175]
    v_mfma_f32_16x16x32_bf16 v[176:179], v[44:47], v[96:99], v[176:179]
    v_mfma_f32_16x16x32_bf16 v[180:183], v[44:47], v[100:103], v[180:183]
    s_waitcnt lgkmcnt(0)
    s_barrier
    v_mfma_f32_16x16x32_bf16 v[128:131], v[32:35], v[48:51], v[128:131]
    s_add_u32 m0, s54, 83968
    s_add_u32 s47, s53, s96
    buffer_load_dwordx4 v3, s[24:27], s47 offen lds
    s_add_u32 m0, s54, 84992
    s_add_u32 s47, s53, s96
    buffer_load_dwordx4 v4, s[24:27], s47 offen lds
    s_add_u32 s96, s96, 262144
    s_cmp_ge_u32 s96, 4718592
    s_cselect_b32 s96, 0, s96
    s_add_u32 m0, s55, 1024
    s_mov_b32 s47, s97
    buffer_load_dwordx4 v9, s[20:23], s47 offen lds
    s_add_u32 s97, s97, 128
    s_cmp_ge_u32 s97, 1152
    s_cselect_b32 s97, 0, s97
    v_mfma_f32_16x16x32_bf16 v[132:135], v[32:35], v[52:55], v[132:135]
    ds_read_b64_tr_b16 v[40:41], v10 offset:16384
    ds_read_b64_tr_b16 v[42:43], v10 offset:18432
    v_mfma_f32_16x16x32_bf16 v[136:139], v[32:35], v[56:59], v[136:139]
    ds_read_b64_tr_b16 v[44:45], v29 offset:16384
    ds_read_b64_tr_b16 v[46:47], v29 offset:18432
    v_mfma_f32_16x16x32_bf16 v[140:143], v[32:35], v[60:63], v[140:143]
    ds_read_b128 v[76:79], v31 offset:14336
    ds_read_b128 v[80:83], v31 offset:16384
    v_mfma_f32_16x16x32_bf16 v[144:147], v[32:35], v[64:67], v[144:147]
    ds_read_b128 v[84:87], v31 offset:18432
    v_mfma_f32_16x16x32_bf16 v[148:151], v[32:35], v[68:71], v[148:151]
    ds_read_b128 v[88:91], v31 offset:20480
    v_mfma_f32_16x16x32_bf16 v[152:155], v[32:35], v[72:75], v[152:155]
    ds_read_b128 v[92:95], v31 offset:22528
    v_mfma_f32_16x16x32_bf16 v[156:159], v[36:39], v[48:51], v[156:159]
    ds_read_b128 v[96:99], v31 offset:24576
    v_mfma_f32_16x16x32_bf16 v[160:163], v[36:39], v[52:55], v[160:163]
    ds_read_b128 v[100:103], v31 offset:26624
    v_mfma_f32_16x16x32_bf16 v[164:167], v[36:39], v[56:59], v[164:167]
    v_mfma_f32_16x16x32_bf16 v[168:171], v[36:39], v[60:63], v[168:171]
    v_mfma_f32_16x16x32_bf16 v[172:175], v[36:39], v[64:67], v[172:175]
    v_mfma_f32_16x16x32_bf16 v[176:179], v[36:39], v[68:71], v[176:179]
    v_mfma_f32_16x16x32_bf16 v[180:183], v[36:39], v[72:75], v[180:183]
    s_waitcnt vmcnt(6) lgkmcnt(0)
    s_barrier
    v_mfma_f32_16x16x32_bf16 v[128:131], v[40:43], v[76:79], v[128:131]
    s_add_u32 m0, s54, 100352
    s_add_u32 s47, s53, s96
    buffer_load_dwordx4 v3, s[24:27], s47 offen lds
    s_add_u32 m0, s54, 101376
    s_add_u32 s47, s53, s96
    buffer_load_dwordx4 v4, s[24:27], s47 offen lds
    s_add_u32 s96, s96, 262144
    s_cmp_ge_u32 s96, 4718592
    s_cselect_b32 s96, 0, s96
    s_add_u32 m0, s55, 14336
    s_mov_b32 s47, s97
    buffer_load_dwordx4 v5, s[20:23], s47 offen lds
    v_mfma_f32_16x16x32_bf16 v[132:135], v[40:43], v[80:83], v[132:135]
    ds_read_b64_tr_b16 v[32:33], v10 offset:32768
    ds_read_b64_tr_b16 v[34:35], v10 offset:34816
    v_mfma_f32_16x16x32_bf16 v[136:139], v[40:43], v[84:87], v[136:139]
    ds_read_b64_tr_b16 v[36:37], v29 offset:32768
    ds_read_b64_tr_b16 v[38:39], v29 offset:34816
    v_mfma_f32_16x16x32_bf16 v[140:143], v[40:43], v[88:91], v[140:143]
    ds_read_b128 v[48:51], v8 offset:28672
    ds_read_b128 v[52:55], v8 offset:30720
    v_mfma_f32_16x16x32_bf16 v[144:147], v[40:43], v[92:95], v[144:147]
    ds_read_b128 v[56:59], v8 offset:32768
    v_mfma_f32_16x16x32_bf16 v[148:151], v[40:43], v[96:99], v[148:151]
    ds_read_b128 v[60:63], v8 offset:34816
    v_mfma_f32_16x16x32_bf16 v[152:155], v[40:43], v[100:103], v[152:155]
    ds_read_b128 v[64:67], v8 offset:36864
    v_mfma_f32_16x16x32_bf16 v[156:159], v[44:47], v[76:79], v[156:159]
    ds_read_b128 v[68:71], v8 offset:38912
    v_mfma_f32_16x16x32_bf16 v[160:163], v[44:47], v[80:83], v[160:163]
    ds_read_b128 v[72:75], v8 offset:40960
    v_mfma_f32_16x16x32_bf16 v[164:167], v[44:47], v[84:87], v[164:167]
    v_mfma_f32_16x16x32_bf16 v[168:171], v[44:47], v[88:91], v[168:171]
    v_mfma_f32_16x16x32_bf16 v[172:175], v[44:47], v[92:95], v[172:175]
    v_mfma_f32_16x16x32_bf16 v[176:179], v[44:47], v[96:99], v[176:179]
    v_mfma_f32_16x16x32_bf16 v[180:183], v[44:47], v[100:103], v[180:183]
    s_waitcnt lgkmcnt(0)
    s_barrier
    v_mfma_f32_16x16x32_bf16 v[128:131], v[32:35], v[48:51], v[128:131]
    s_add_u32 m0, s54, 116736
    s_add_u32 s47, s53, s96
    buffer_load_dwordx4 v3, s[24:27], s47 offen lds
    s_add_u32 m0, s54, 117760
    s_add_u32 s47, s53, s96
    buffer_load_dwordx4 v4, s[24:27], s47 offen lds
    s_add_u32 s96, s96, 262144
    s_cmp_ge_u32 s96, 4718592
    s_cselect_b32 s96, 0, s96
    s_add_u32 m0, s55, 15360
    s_mov_b32 s47, s97
    buffer_load_dwordx4 v9, s[20:23], s47 offen lds
    s_add_u32 s97, s97, 128
    s_cmp_ge_u32 s97, 1152
    s_cselect_b32 s97, 0, s97
    v_mfma_f32_16x16x32_bf16 v[132:135], v[32:35], v[52:55], v[132:135]
    ds_read_b64_tr_b16 v[40:41], v10 offset:49152
    ds_read_b64_tr_b16 v[42:43], v10 offset:51200
    v_mfma_f32_16x16x32_bf16 v[136:139], v[32:35], v[56:59], v[136:139]
    ds_read_b64_tr_b16 v[44:45], v29 offset:49152
    ds_read_b64_tr_b16 v[46:47], v29 offset:51200
    v_mfma_f32_16x16x32_bf16 v[140:143], v[32:35], v[60:63], v[140:143]
    ds_read_b128 v[76:79], v31 offset:28672
    ds_read_b128 v[80:83], v31 offset:30720
    v_mfma_f32_16x16x32_bf16 v[144:147], v[32:35], v[64:67], v[144:147]
    ds_read_b128 v[84:87], v31 offset:32768
    v_mfma_f32_16x16x32_bf16 v[148:151], v[32:35], v[68:71], v[148:151]
    ds_read_b128 v[88:91], v31 offset:34816
    v_mfma_f32_16x16x32_bf16 v[152:155], v[32:35], v[72:75], v[152:155]
    ds_read_b128 v[92:95], v31 offset:36864
    v_mfma_f32_16x16x32_bf16 v[156:159], v[36:39], v[48:51], v[156:159]
    ds_read_b128 v[96:99], v31 offset:38912
    v_mfma_f32_16x16x32_bf16 v[160:163], v[36:39], v[52:55], v[160:163]
    ds_read_b128 v[100:103], v31 offset:40960
    v_mfma_f32_16x16x32_bf16 v[164:167], v[36:39], v[56:59], v[164:167]
    v_mfma_f32_16x16x32_bf16 v[168:171], v[36:39], v[60:63], v[168:171]
    v_mfma_f32_16x16x32_bf16 v[172:175], v[36:39], v[64:67], v[172:175]
    v_mfma_f32_16x16x32_bf16 v[176:179], v[36:39], v[68:71], v[176:179]
    v_mfma_f32_16x16x32_bf16 v[180:183], v[36:39], v[72:75], v[180:183]
    s_waitcnt vmcnt(6) lgkmcnt(0)
    s_barrier
    v_mfma_f32_16x16x32_bf16 v[128:131], v[40:43], v[76:79], v[128:131]
    s_add_u32 m0, s54, 133120
    s_add_u32 s47, s53, s96
    buffer_load_dwordx4 v3, s[24:27], s47 offen lds
    s_add_u32 m0, s54, 134144
    s_add_u32 s47, s53, s96
    buffer_load_dwordx4 v4, s[24:27], s47 offen lds
    s_add_u32 s96, s96, 262144
    s_cmp_ge_u32 s96, 4718592
    s_cselect_b32 s96, 0, s96
    s_add_u32 m0, s55, 28672
    s_mov_b32 s47, s97
    buffer_load_dwordx4 v5, s[20:23], s47 offen lds
    v_mfma_f32_16x16x32_bf16 v[132:135], v[40:43], v[80:83], v[132:135]
    ds_read_b64_tr_b16 v[32:33], v6 offset:0
    ds_read_b64_tr_b16 v[34:35], v6 offset:2048
    v_mfma_f32_16x16x32_bf16 v[136:139], v[40:43], v[84:87], v[136:139]
    ds_read_b64_tr_b16 v[36:37], v7 offset:0
    ds_read_b64_tr_b16 v[38:39], v7 offset:2048
    v_mfma_f32_16x16x32_bf16 v[140:143], v[40:43], v[88:91], v[140:143]
    ds_read_b128 v[48:51], v8 offset:0
    ds_read_b128 v[52:55], v8 offset:2048
    v_mfma_f32_16x16x32_bf16 v[144:147], v[40:43], v[92:95], v[144:147]
    ds_read_b128 v[56:59], v8 offset:4096
    v_mfma_f32_16x16x32_bf16 v[148:151], v[40:43], v[96:99], v[148:151]
    ds_read_b128 v[60:63], v8 offset:6144
    v_mfma_f32_16x16x32_bf16 v[152:155], v[40:43], v[100:103], v[152:155]
    ds_read_b128 v[64:67], v8 offset:8192
    v_mfma_f32_16x16x32_bf16 v[156:159], v[44:47], v[76:79], v[156:159]
    ds_read_b128 v[68:71], v8 offset:10240
    v_mfma_f32_16x16x32_bf16 v[160:163], v[44:47], v[80:83], v[160:163]
    ds_read_b128 v[72:75], v8 offset:12288
    v_mfma_f32_16x16x32_bf16 v[164:167], v[44:47], v[84:87], v[164:167]
    v_mfma_f32_16x16x32_bf16 v[168:171], v[44:47], v[88:91], v[168:171]
    v_mfma_f32_16x16x32_bf16 v[172:175], v[44:47], v[92:95], v[172:175]
    v_mfma_f32_16x16x32_bf16 v[176:179], v[44:47], v[96:99], v[176:179]
    v_mfma_f32_16x16x32_bf16 v[180:183], v[44:47], v[100:103], v[180:183]
    s_waitcnt lgkmcnt(0)
    s_barrier
    v_mfma_f32_16x16x32_bf16 v[128:131], v[32:35], v[48:51], v[128:131]
    s_add_u32 m0, s54, 43008
    s_add_u32 s47, s53, s96
    buffer_load_dwordx4 v3, s[24:27], s47 offen lds
    s_add_u32 m0, s54, 44032
    s_add_u32 s47, s53, s96
    buffer_load_dwordx4 v4, s[24:27], s47 offen lds
    s_add_u32 s96, s96, 262144
    s_cmp_ge_u32 s96, 4718592
    s_cselect_b32 s96, 0, s96
    s_add_u32 m0, s55, 29696
    s_mov_b32 s47, s97
    buffer_load_dwordx4 v9, s[20:23], s47 offen lds
    s_add_u32 s97, s97, 128
    s_cmp_ge_u32 s97, 1152
    s_cselect_b32 s97, 0, s97
    v_mfma_f32_16x16x32_bf16 v[132:135], v[32:35], v[52:55], v[132:135]
    ds_read_b64_tr_b16 v[40:41], v10 offset:0
    ds_read_b64_tr_b16 v[42:43], v10 offset:2048
    v_mfma_f32_16x16x32_bf16 v[136:139], v[32:35], v[56:59], v[136:139]
    ds_read_b64_tr_b16 v[44:45], v29 offset:0
    ds_read_b64_tr_b16 v[46:47], v29 offset:2048
    v_mfma_f32_16x16x32_bf16 v[140:143], v[32:35], v[60:63], v[140:143]
    ds_read_b128 v[76:79], v31 offset:0
    ds_read_b128 v[80:83], v31 offset:2048
    v_mfma_f32_16x16x32_bf16 v[144:147], v[32:35], v[64:67], v[144:147]
    ds_read_b128 v[84:87], v31 offset:4096
    v_mfma_f32_16x16x32_bf16 v[148:151], v[32:35], v[68:71], v[148:151]
    ds_read_b128 v[88:91], v31 offset:6144
    v_mfma_f32_16x16x32_bf16 v[152:155], v[32:35], v[72:75], v[152:155]
    ds_read_b128 v[92:95], v31 offset:8192
    v_mfma_f32_16x16x32_bf16 v[156:159], v[36:39], v[48:51], v[156:159]
    ds_read_b128 v[96:99], v31 offset:10240
    v_mfma_f32_16x16x32_bf16 v[160:163], v[36:39], v[52:55], v[160:163]
    ds_read_b128 v[100:103], v31 offset:12288
    v_mfma_f32_16x16x32_bf16 v[164:167], v[36:39], v[56:59], v[164:167]
    v_mfma_f32_16x16x32_bf16 v[168:171], v[36:39], v[60:63], v[168:171]
    v_mfma_f32_16x16x32_bf16 v[172:175], v[36:39], v[64:67], v[172:175]
    v_mfma_f32_16x16x32_bf16 v[176:179], v[36:39], v[68:71], v[176:179]
    v_mfma_f32_16x16x32_bf16 v[180:183], v[36:39], v[72:75], v[180:183]
    s_waitcnt vmcnt(6) lgkmcnt(0)
    s_barrier
    v_mfma_f32_16x16x32_bf16 v[128:131], v[40:43], v[76:79], v[128:131]
    v_mfma_f32_16x16x32_bf16 v[132:135], v[40:43], v[80:83], v[132:135]
    ds_read_b64_tr_b16 v[32:33], v10 offset:16384
    ds_read_b64_tr_b16 v[34:35], v10 offset:18432
    v_mfma_f32_16x16x32_bf16 v[136:139], v[40:43], v[84:87], v[136:139]
    ds_read_b64_tr_b16 v[36:37], v29 offset:16384
    ds_read_b64_tr_b16 v[38:39], v29 offset:18432
    v_mfma_f32_16x16x32_bf16 v[140:143], v[40:43], v[88:91], v[140:143]
    ds_read_b128 v[48:51], v8 offset:14336
    ds_read_b128 v[52:55], v8 offset:16384
    v_mfma_f32_16x16x32_bf16 v[144:147], v[40:43], v[92:95], v[144:147]
    ds_read_b128 v[56:59], v8 offset:18432
    v_mfma_f32_16x16x32_bf16 v[148:151], v[40:43], v[96:99], v[148:151]
    ds_read_b128 v[60:63], v8 offset:20480
    v_mfma_f32_16x16x32_bf16 v[152:155], v[40:43], v[100:103], v[152:155]
    ds_read_b128 v[64:67], v8 offset:22528
    v_mfma_f32_16x16x32_bf16 v[156:159], v[44:47], v[76:79], v[156:159]
    ds_read_b128 v[68:71], v8 offset:24576
    v_mfma_f32_16x16x32_bf16 v[160:163], v[44:47], v[80:83], v[160:163]
    ds_read_b128 v[72:75], v8 offset:26624
    v_mfma_f32_16x16x32_bf16 v[164:167], v[44:47], v[84:87], v[164:167]
    v_mfma_f32_16x16x32_bf16 v[168:171], v[44:47], v[88:91], v[168:171]
    v_mfma_f32_16x16x32_bf16 v[172:175], v[44:47], v[92:95], v[172:175]
    v_mfma_f32_16x16x32_bf16 v[176:179], v[44:47], v[96:99], v[176:179]
    v_mfma_f32_16x16x32_bf16 v[180:183], v[44:47], v[100:103], v[180:183]
    s_waitcnt lgkmcnt(0)
    s_barrier
    v_mfma_f32_16x16x32_bf16 v[128:131], v[32:35], v[48:51], v[128:131]
    v_mfma_f32_16x16x32_bf16 v[132:135], v[32:35], v[52:55], v[132:135]
    ds_read_b64_tr_b16 v[40:41], v10 offset:32768
    ds_read_b64_tr_b16 v[42:43], v10 offset:34816
    v_mfma_f32_16x16x32_bf16 v[136:139], v[32:35], v[56:59], v[136:139]
    ds_read_b64_tr_b16 v[44:45], v29 offset:32768
    ds_read_b64_tr_b16 v[46:47], v29 offset:34816
    v_mfma_f32_16x16x32_bf16 v[140:143], v[32:35], v[60:63], v[140:143]
    ds_read_b128 v[76:79], v31 offset:14336
    ds_read_b128 v[80:83], v31 offset:16384
    v_mfma_f32_16x16x32_bf16 v[144:147], v[32:35], v[64:67], v[144:147]
    ds_read_b128 v[84:87], v31 offset:18432
    v_mfma_f32_16x16x32_bf16 v[148:151], v[32:35], v[68:71], v[148:151]
    ds_read_b128 v[88:91], v31 offset:20480
    v_mfma_f32_16x16x32_bf16 v[152:155], v[32:35], v[72:75], v[152:155]
    ds_read_b128 v[92:95], v31 offset:22528
    v_mfma_f32_16x16x32_bf16 v[156:159], v[36:39], v[48:51], v[156:159]
    ds_read_b128 v[96:99], v31 offset:24576
    v_mfma_f32_16x16x32_bf16 v[160:163], v[36:39], v[52:55], v[160:163]
    ds_read_b128 v[100:103], v31 offset:26624
    v_mfma_f32_16x16x32_bf16 v[164:167], v[36:39], v[56:59], v[164:167]
    v_mfma_f32_16x16x32_bf16 v[168:171], v[36:39], v[60:63], v[168:171]
    v_mfma_f32_16x16x32_bf16 v[172:175], v[36:39], v[64:67], v[172:175]
    v_mfma_f32_16x16x32_bf16 v[176:179], v[36:39], v[68:71], v[176:179]
    v_mfma_f32_16x16x32_bf16 v[180:183], v[36:39], v[72:75], v[180:183]
    s_waitcnt vmcnt(0) lgkmcnt(0)
    s_barrier
    v_mfma_f32_16x16x32_bf16 v[128:131], v[40:43], v[76:79], v[128:131]
    v_mfma_f32_16x16x32_bf16 v[132:135], v[40:43], v[80:83], v[132:135]
    ds_read_b64_tr_b16 v[32:33], v10 offset:49152
    ds_read_b64_tr_b16 v[34:35], v10 offset:51200
    v_mfma_f32_16x16x32_bf16 v[136:139], v[40:43], v[84:87], v[136:139]
    ds_read_b64_tr_b16 v[36:37], v29 offset:49152
    ds_read_b64_tr_b16 v[38:39], v29 offset:51200
    v_mfma_f32_16x16x32_bf16 v[140:143], v[40:43], v[88:91], v[140:143]
    ds_read_b128 v[48:51], v8 offset:28672
    ds_read_b128 v[52:55], v8 offset:30720
    v_mfma_f32_16x16x32_bf16 v[144:147], v[40:43], v[92:95], v[144:147]
    ds_read_b128 v[56:59], v8 offset:32768
    v_mfma_f32_16x16x32_bf16 v[148:151], v[40:43], v[96:99], v[148:151]
    ds_read_b128 v[60:63], v8 offset:34816
    v_mfma_f32_16x16x32_bf16 v[152:155], v[40:43], v[100:103], v[152:155]
    ds_read_b128 v[64:67], v8 offset:36864
    v_mfma_f32_16x16x32_bf16 v[156:159], v[44:47], v[76:79], v[156:159]
    ds_read_b128 v[68:71], v8 offset:38912
    v_mfma_f32_16x16x32_bf16 v[160:163], v[44:47], v[80:83], v[160:163]
    ds_read_b128 v[72:75], v8 offset:40960
    v_mfma_f32_16x16x32_bf16 v[164:167], v[44:47], v[84:87], v[164:167]
    v_mfma_f32_16x16x32_bf16 v[168:171], v[44:47], v[88:91], v[168:171]
    v_mfma_f32_16x16x32_bf16 v[172:175], v[44:47], v[92:95], v[172:175]
    v_mfma_f32_16x16x32_bf16 v[176:179], v[44:47], v[96:99], v[176:179]
    v_mfma_f32_16x16x32_bf16 v[180:183], v[44:47], v[100:103], v[180:183]
    s_waitcnt lgkmcnt(0)
    s_barrier
    v_mfma_f32_16x16x32_bf16 v[128:131], v[32:35], v[48:51], v[128:131]
    v_mfma_f32_16x16x32_bf16 v[132:135], v[32:35], v[52:55], v[132:135]
    ds_read_b64_tr_b16 v[40:41], v6 offset:0
    ds_read_b64_tr_b16 v[42:43], v6 offset:2048
    v_mfma_f32_16x16x32_bf16 v[136:139], v[32:35], v[56:59], v[136:139]
    ds_read_b64_tr_b16 v[44:45], v7 offset:0
    ds_read_b64_tr_b16 v[46:47], v7 offset:2048
    v_mfma_f32_16x16x32_bf16 v[140:143], v[32:35], v[60:63], v[140:143]
    ds_read_b128 v[76:79], v31 offset:28672
    ds_read_b128 v[80:83], v31 offset:30720
    v_mfma_f32_16x16x32_bf16 v[144:147], v[32:35], v[64:67], v[144:147]
    ds_read_b128 v[84:87], v31 offset:32768
    v_mfma_f32_16x16x32_bf16 v[148:151], v[32:35], v[68:71], v[148:151]
    ds_read_b128 v[88:91], v31 offset:34816
    v_mfma_f32_16x16x32_bf16 v[152:155], v[32:35], v[72:75], v[152:155]
    ds_read_b128 v[92:95], v31 offset:36864
    v_mfma_f32_16x16x32_bf16 v[156:159], v[36:39], v[48:51], v[156:159]
    ds_read_b128 v[96:99], v31 offset:38912
    v_mfma_f32_16x16x32_bf16 v[160:163], v[36:39], v[52:55], v[160:163]
    ds_read_b128 v[100:103], v31 offset:40960
    v_mfma_f32_16x16x32_bf16 v[164:167], v[36:39], v[56:59], v[164:167]
    v_mfma_f32_16x16x32_bf16 v[168:171], v[36:39], v[60:63], v[168:171]
    v_mfma_f32_16x16x32_bf16 v[172:175], v[36:39], v[64:67], v[172:175]
    v_mfma_f32_16x16x32_bf16 v[176:179], v[36:39], v[68:71], v[176:179]
    v_mfma_f32_16x16x32_bf16 v[180:183], v[36:39], v[72:75], v[180:183]
    s_waitcnt lgkmcnt(0)
    s_barrier
    v_mfma_f32_16x16x32_bf16 v[128:131], v[40:43], v[76:79], v[128:131]
    v_lshrrev_b32 v11, 4, v2
    v_and_b32 v12, 15, v2
    s_lshr_b32 s46, s45, 2
    v_mfma_f32_16x16x32_bf16 v[132:135], v[40:43], v[80:83], v[132:135]
    s_mul_i32 s46, s46, 28672
    v_lshlrev_b32 v13, 8, v12
    v_add_u32 v13, s46, v13
    v_mfma_f32_16x16x32_bf16 v[136:139], v[40:43], v[84:87], v[136:139]
    v_and_b32 v14, 1, v11
    v_lshlrev_b32 v14, 3, v14
    v_add_u32 v13, v13, v14
    v_mfma_f32_16x16x32_bf16 v[140:143], v[40:43], v[88:91], v[140:143]
    v_lshrrev_b32 v14, 1, v11
    s_and_b32 s46, s45, 3
    s_lshl_b32 s46, s46, 2
    v_mfma_f32_16x16x32_bf16 v[144:147], v[40:43], v[92:95], v[144:147]
    v_add_u32 v14, s46, v14
    v_add_u32 v15, 0, v14
    v_xor_b32 v15, v15, v12
    v_mfma_f32_16x16x32_bf16 v[148:151], v[40:43], v[96:99], v[148:151]
    v_lshlrev_b32 v15, 4, v15
    v_add_u32 v16, v13, v15
    v_add_u32 v15, 2, v14
    v_mfma_f32_16x16x32_bf16 v[152:155], v[40:43], v[100:103], v[152:155]
    v_xor_b32 v15, v15, v12
    v_lshlrev_b32 v15, 4, v15
    v_add_u32 v17, v13, v15
    v_mfma_f32_16x16x32_bf16 v[156:159], v[44:47], v[76:79], v[156:159]
    v_mfma_f32_16x16x32_bf16 v[160:163], v[44:47], v[80:83], v[160:163]
    v_cvt_pk_bf16_f32 v128, v128, v129
    v_cvt_pk_bf16_f32 v129, v130, v131
    ds_write_b64 v16, v[128:129] offset:0
    v_mfma_f32_16x16x32_bf16 v[164:167], v[44:47], v[84:87], v[164:167]
    v_cvt_pk_bf16_f32 v132, v132, v133
    v_cvt_pk_bf16_f32 v133, v134, v135
    ds_write_b64 v16, v[132:133] offset:4096
    v_mfma_f32_16x16x32_bf16 v[168:171], v[44:47], v[88:91], v[168:171]
    v_cvt_pk_bf16_f32 v136, v136, v137
    v_cvt_pk_bf16_f32 v137, v138, v139
    ds_write_b64 v16, v[136:137] offset:8192
    v_mfma_f32_16x16x32_bf16 v[172:175], v[44:47], v[92:95], v[172:175]
    v_cvt_pk_bf16_f32 v140, v140, v141
    v_cvt_pk_bf16_f32 v141, v142, v143
    ds_write_b64 v16, v[140:141] offset:12288
    v_mfma_f32_16x16x32_bf16 v[176:179], v[44:47], v[96:99], v[176:179]
    v_cvt_pk_bf16_f32 v144, v144, v145
    v_cvt_pk_bf16_f32 v145, v146, v147
    ds_write_b64 v16, v[144:145] offset:16384
    v_mfma_f32_16x16x32_bf16 v[180:183], v[44:47], v[100:103], v[180:183]
    v_cvt_pk_bf16_f32 v148, v148, v149
    v_cvt_pk_bf16_f32 v149, v150, v151
    ds_write_b64 v16, v[148:149] offset:20480
    v_cvt_pk_bf16_f32 v152, v152, v153
    v_cvt_pk_bf16_f32 v153, v154, v155
    ds_write_b64 v16, v[152:153] offset:24576
    v_cvt_pk_bf16_f32 v156, v156, v157
    v_cvt_pk_bf16_f32 v157, v158, v159
    ds_write_b64 v17, v[156:157] offset:0
    v_cvt_pk_bf16_f32 v160, v160, v161
    v_cvt_pk_bf16_f32 v161, v162, v163
    ds_write_b64 v17, v[160:161] offset:4096
    v_cvt_pk_bf16_f32 v164, v164, v165
    v_cvt_pk_bf16_f32 v165, v166, v167
    ds_write_b64 v17, v[164:165] offset:8192
    v_cvt_pk_bf16_f32 v168, v168, v169
    v_cvt_pk_bf16_f32 v169, v170, v171
    ds_write_b64 v17, v[168:169] offset:12288
    v_cvt_pk_bf16_f32 v172, v172, v173
    v_cvt_pk_bf16_f32 v173, v174, v175
    ds_write_b64 v17, v[172:173] offset:16384
    v_cvt_pk_bf16_f32 v176, v176, v177
    v_cvt_pk_bf16_f32 v177, v178, v179
    ds_write_b64 v17, v[176:177] offset:20480
    v_cvt_pk_bf16_f32 v180, v180, v181
    v_cvt_pk_bf16_f32 v181, v182, v183
    ds_write_b64 v17, v[180:181] offset:24576
    s_waitcnt lgkmcnt(0)
    s_barrier
    v_and_b32 v11, 31, v2
    v_lshrrev_b32 v12, 5, v2
    v_and_b32 v13, 15, v2
    v_xor_b32 v13, v13, v12
    v_lshlrev_b32 v14, 8, v11
    s_lshl_b32 s46, s45, 13
    v_xor_b32 v15, 0, v13
    v_lshlrev_b32 v15, 4, v15
    v_add_u32 v15, v15, v14
    v_add_u32 v232, 59392, v15
    v_add_u32 v15, s46, v15
    ds_read_b128 v[96:99], v15
    v_xor_b32 v15, 2, v13
    v_lshlrev_b32 v15, 4, v15
    v_add_u32 v15, v15, v14
    v_add_u32 v233, 59392, v15
    v_add_u32 v15, s46, v15
    ds_read_b128 v[100:103], v15
    v_xor_b32 v15, 4, v13
    v_lshlrev_b32 v15, 4, v15
    v_add_u32 v15, v15, v14
    v_add_u32 v234, 59392, v15
    v_add_u32 v15, s46, v15
    ds_read_b128 v[104:107], v15
    v_xor_b32 v15, 6, v13
    v_lshlrev_b32 v15, 4, v15
    v_add_u32 v15, v15, v14
    v_add_u32 v235, 59392, v15
    v_add_u32 v15, s46, v15
    ds_read_b128 v[108:111], v15
    v_xor_b32 v15, 8, v13
    v_lshlrev_b32 v15, 4, v15
    v_add_u32 v15, v15, v14
    v_add_u32 v236, 59392, v15
    v_add_u32 v15, s46, v15
    ds_read_b128 v[112:115], v15
    v_xor_b32 v15, 10, v13
    v_lshlrev_b32 v15, 4, v15
    v_add_u32 v15, v15, v14
    v_add_u32 v237, 59392, v15
    v_add_u32 v15, s46, v15
    ds_read_b128 v[116:119], v15
    v_xor_b32 v15, 12, v13
    v_lshlrev_b32 v15, 4, v15
    v_add_u32 v15, v15, v14
    v_add_u32 v238, 59392, v15
    v_add_u32 v15, s46, v15
    ds_read_b128 v[120:123], v15
    v_xor_b32 v15, 14, v13
    v_lshlrev_b32 v15, 4, v15
    v_add_u32 v15, v15, v14
    v_add_u32 v239, 59392, v15
    v_add_u32 v15, s46, v15
    ds_read_b128 v[124:127], v15
    ds_read_b128 v[64:67], v232 offset:0
    ds_read_b128 v[68:71], v233 offset:0
    ds_read_b128 v[72:75], v234 offset:0
    ds_read_b128 v[76:79], v235 offset:0
    ds_read_b128 v[80:83], v236 offset:0
    ds_read_b128 v[84:87], v237 offset:0
    ds_read_b128 v[88:91], v238 offset:0
    ds_read_b128 v[92:95], v239 offset:0
    v_bfe_u32 v11, v2, 2, 2
    v_lshlrev_b32 v13, 2, v12
    v_add_u32 v13, v13, v11
    v_lshlrev_b32 v13, 8, v13
    v_and_b32 v14, 3, v2
    v_lshlrev_b32 v14, 3, v14
    v_add_u32 v13, v13, v14
    v_add_u32 v13, 92160, v13
    v_bfe_u32 v14, v2, 4, 1
    v_lshlrev_b32 v15, 1, v11
    v_xor_b32 v14, v14, v15
    v_xor_b32 v15, 0, v14
    v_lshlrev_b32 v15, 5, v15
    v_add_u32 v240, v13, v15
    v_xor_b32 v15, 2, v14
    v_lshlrev_b32 v15, 5, v15
    v_add_u32 v241, v13, v15
    v_xor_b32 v15, 4, v14
    v_lshlrev_b32 v15, 5, v15
    v_add_u32 v242, v13, v15
    v_xor_b32 v15, 6, v14
    v_lshlrev_b32 v15, 5, v15
    v_add_u32 v243, v13, v15
    v_mov_b32 v128, 0
    v_mov_b32 v129, 0
    v_mov_b32 v130, 0
    v_mov_b32 v131, 0
    v_mov_b32 v132, 0
    v_mov_b32 v133, 0
    v_mov_b32 v134, 0
    v_mov_b32 v135, 0
    v_mov_b32 v136, 0
    v_mov_b32 v137, 0
    v_mov_b32 v138, 0
    v_mov_b32 v139, 0
    v_mov_b32 v140, 0
    v_mov_b32 v141, 0
    v_mov_b32 v142, 0
    v_mov_b32 v143, 0
    v_mov_b32 v144, 0
    v_mov_b32 v145, 0
    v_mov_b32 v146, 0
    v_mov_b32 v147, 0
    v_mov_b32 v148, 0
    v_mov_b32 v149, 0
    v_mov_b32 v150, 0
    v_mov_b32 v151, 0
    v_mov_b32 v152, 0
    v_mov_b32 v153, 0
    v_mov_b32 v154, 0
    v_mov_b32 v155, 0
    v_mov_b32 v156, 0
    v_mov_b32 v157, 0
    v_mov_b32 v158, 0
    v_mov_b32 v159, 0
    v_mov_b32 v160, 0
    v_mov_b32 v161, 0
    v_mov_b32 v162, 0
    v_mov_b32 v163, 0
    v_mov_b32 v164, 0
    v_mov_b32 v165, 0
    v_mov_b32 v166, 0
    v_mov_b32 v167, 0
    v_mov_b32 v168, 0
    v_mov_b32 v169, 0
    v_mov_b32 v170, 0
    v_mov_b32 v171, 0
    v_mov_b32 v172, 0
    v_mov_b32 v173, 0
    v_mov_b32 v174, 0
    v_mov_b32 v175, 0
    v_mov_b32 v176, 0
    v_mov_b32 v177, 0
    v_mov_b32 v178, 0
    v_mov_b32 v179, 0
    v_mov_b32 v180, 0
    v_mov_b32 v181, 0
    v_mov_b32 v182, 0
    v_mov_b32 v183, 0
    v_mov_b32 v184, 0
    v_mov_b32 v185, 0
    v_mov_b32 v186, 0
    v_mov_b32 v187, 0
    v_mov_b32 v188, 0
    v_mov_b32 v189, 0
    v_mov_b32 v190, 0
    v_mov_b32 v191, 0
    v_mov_b32 v24, 0
    v_mov_b32 v25, 0
    s_mov_b32 s56, 0
    v_mul_u32_u24 v19, 4608, v2
    s_cmp_eq_u32 s45, 0
    s_cselect_b32 s47, 0, 0x7ff00000
    buffer_load_dword v18, v19, s[72:75], s47 offen
    v_lshlrev_b32 v19, 7, v2
    s_lshl_b32 s95, s45, 13
    s_lshl_b32 s95, s45, 3
    s_add_u32 s95, s95, s42
    s_lshl_b32 s95, s95, 13
    s_waitcnt lgkmcnt(0)
    v_mfma_f32_32x32x16_bf16 v[192:207], v[64:67], v[96:99], 0
    ds_read_b128 v[64:67], v232 offset:8192
    v_mfma_f32_32x32x16_bf16 v[192:207], v[68:71], v[100:103], v[192:207]
    ds_read_b128 v[68:71], v233 offset:8192
    v_mfma_f32_32x32x16_bf16 v[192:207], v[72:75], v[104:107], v[192:207]
    ds_read_b128 v[72:75], v234 offset:8192
    v_mfma_f32_32x32x16_bf16 v[192:207], v[76:79], v[108:111], v[192:207]
    ds_read_b128 v[76:79], v235 offset:8192
    v_mfma_f32_32x32x16_bf16 v[192:207], v[80:83], v[112:115], v[192:207]
    ds_read_b128 v[80:83], v236 offset:8192
    v_mfma_f32_32x32x16_bf16 v[192:207], v[84:87], v[116:119], v[192:207]
    ds_read_b128 v[84:87], v237 offset:8192
    v_mfma_f32_32x32x16_bf16 v[192:207], v[88:91], v[120:123], v[192:207]
    ds_read_b128 v[88:91], v238 offset:8192
    v_mfma_f32_32x32x16_bf16 v[192:207], v[92:95], v[124:127], v[192:207]
    ds_read_b128 v[92:95], v239 offset:8192
    s_waitcnt lgkmcnt(0)
    s_barrier
    v_mfma_f32_32x32x16_bf16 v[208:223], v[64:67], v[96:99], 0
    v_max3_f32 v11, v192, v193, v194
    v_max3_f32 v12, v195, v196, v197
    v_max3_f32 v13, v198, v199, v200
    v_max3_f32 v14, v201, v202, v203
    v_max3_f32 v15, v204, v205, v206
    v_max3_f32 v11, v11, v12, v207
    v_max3_f32 v13, v13, v14, v15
    v_max_f32 v11, v11, v13
    v_mfma_f32_32x32x16_bf16 v[208:223], v[68:71], v[100:103], v[208:223]
    v_mov_b32 v12, v11
    s_nop 1
    v_permlane32_swap_b32 v11, v12
    s_nop 1
    v_max_f32 v11, v11, v12
    v_mov_b32 v20, v11
    v_mul_f32 v22, s50, v11
    v_add_f32 v21, s51, v11
    v_fma_f32 v192, v192, s48, v22
    v_fma_f32 v193, v193, s48, v22
    v_fma_f32 v194, v194, s48, v22
    v_fma_f32 v195, v195, s48, v22
    v_exp_f32 v192, v192
    v_exp_f32 v193, v193
    v_fma_f32 v196, v196, s48, v22
    v_mfma_f32_32x32x16_bf16 v[208:223], v[72:75], v[104:107], v[208:223]
    v_fma_f32 v197, v197, s48, v22
    v_exp_f32 v194, v194
    v_exp_f32 v195, v195
    v_fma_f32 v198, v198, s48, v22
    v_fma_f32 v199, v199, s48, v22
    v_add_f32 v24, v24, v192
    v_add_f32 v25, v25, v193
    v_cvt_pk_bf16_f32 v224, v192, v193
    v_mfma_f32_32x32x16_bf16 v[208:223], v[76:79], v[108:111], v[208:223]
    v_exp_f32 v196, v196
    v_exp_f32 v197, v197
    v_fma_f32 v200, v200, s48, v22
    v_fma_f32 v201, v201, s48, v22
    v_add_f32 v24, v24, v194
    v_add_f32 v25, v25, v195
    v_cvt_pk_bf16_f32 v225, v194, v195
    v_exp_f32 v198, v198
    v_exp_f32 v199, v199
    v_mfma_f32_32x32x16_bf16 v[208:223], v[80:83], v[112:115], v[208:223]
    v_fma_f32 v202, v202, s48, v22
    v_fma_f32 v203, v203, s48, v22
    v_add_f32 v24, v24, v196
    v_add_f32 v25, v25, v197
    v_cvt_pk_bf16_f32 v226, v196, v197
    v_exp_f32 v200, v200
    v_exp_f32 v201, v201
    v_fma_f32 v204, v204, s48, v22
    v_mfma_f32_32x32x16_bf16 v[208:223], v[84:87], v[116:119], v[208:223]
    v_fma_f32 v205, v205, s48, v22
    v_add_f32 v24, v24, v198
    v_add_f32 v25, v25, v199
    v_cvt_pk_bf16_f32 v227, v198, v199
    v_exp_f32 v202, v202
    v_exp_f32 v203, v203
    v_fma_f32 v206, v206, s48, v22
    v_fma_f32 v207, v207, s48, v22
    v_mfma_f32_32x32x16_bf16 v[208:223], v[88:91], v[120:123], v[208:223]
    v_add_f32 v24, v24, v200
    v_add_f32 v25, v25, v201
    v_cvt_pk_bf16_f32 v228, v200, v201
    v_exp_f32 v204, v204
    v_exp_f32 v205, v205
    v_add_f32 v24, v24, v202
    v_add_f32 v25, v25, v203
    v_cvt_pk_bf16_f32 v229, v202, v203
    v_mfma_f32_32x32x16_bf16 v[208:223], v[92:95], v[124:127], v[208:223]
    v_exp_f32 v206, v206
    v_exp_f32 v207, v207
    v_add_f32 v24, v24, v204
    v_add_f32 v25, v25, v205
    v_cvt_pk_bf16_f32 v230, v204, v205
    s_nop 0
    v_add_f32 v24, v24, v206
    v_add_f32 v25, v25, v207
    v_cvt_pk_bf16_f32 v231, v206, v207
    ds_read_b64_tr_b16 v[32:33], v240 offset:57344
    ds_read_b64_tr_b16 v[34:35], v240 offset:59392
    ds_read_b128 v[64:67], v232 offset:16384
    ds_read_b64_tr_b16 v[36:37], v240 offset:61440
    ds_read_b64_tr_b16 v[38:39], v240 offset:63488
    ds_read_b128 v[68:71], v233 offset:16384
    ds_read_b64_tr_b16 v[40:41], v241 offset:57344
    ds_read_b64_tr_b16 v[42:43], v241 offset:59392
    ds_read_b128 v[72:75], v234 offset:16384
    ds_read_b64_tr_b16 v[44:45], v241 offset:61440
    ds_read_b64_tr_b16 v[46:47], v241 offset:63488
    ds_read_b128 v[76:79], v235 offset:16384
    ds_read_b64_tr_b16 v[48:49], v242 offset:57344
    ds_read_b64_tr_b16 v[50:51], v242 offset:59392
    ds_read_b128 v[80:83], v236 offset:16384
    ds_read_b64_tr_b16 v[52:53], v242 offset:61440
    ds_read_b64_tr_b16 v[54:55], v242 offset:63488
    ds_read_b128 v[84:87], v237 offset:16384
    ds_read_b64_tr_b16 v[56:57], v243 offset:57344
    ds_read_b64_tr_b16 v[58:59], v243 offset:59392
    ds_read_b128 v[88:91], v238 offset:16384
    ds_read_b64_tr_b16 v[60:61], v243 offset:61440
    ds_read_b64_tr_b16 v[62:63], v243 offset:63488
    ds_read_b128 v[92:95], v239 offset:16384
    s_waitcnt lgkmcnt(0)
    s_barrier
    v_mfma_f32_32x32x16_bf16 v[192:207], v[64:67], v[96:99], 0
    v_max3_f32 v11, v208, v209, v210
    v_max3_f32 v12, v211, v212, v213
    v_max3_f32 v13, v214, v215, v216
    v_max3_f32 v14, v217, v218, v219
    v_mfma_f32_32x32x16_bf16 v[192:207], v[68:71], v[100:103], v[192:207]
    v_max3_f32 v15, v220, v221, v222
    v_max3_f32 v11, v11, v12, v223
    v_max3_f32 v13, v13, v14, v15
    v_max_f32 v11, v11, v13
    v_mfma_f32_32x32x16_bf16 v[192:207], v[72:75], v[104:107], v[192:207]
    v_cmp_gt_f32 vcc, v11, v21
    s_cbranch_vccnz concat_heads__gqa_block_cached__gqa_block_cached__near_ridge_kernel_slow1
concat_heads__gqa_block_cached__gqa_block_cached__near_ridge_kernel_ret1:
    v_fma_f32 v208, v208, s48, v22
    v_fma_f32 v209, v209, s48, v22
    v_fma_f32 v210, v210, s48, v22
    v_mfma_f32_32x32x16_bf16 v[192:207], v[76:79], v[108:111], v[192:207]
    v_fma_f32 v211, v211, s48, v22
    v_exp_f32 v208, v208
    v_exp_f32 v209, v209
    v_fma_f32 v212, v212, s48, v22
    v_mfma_f32_32x32x16_bf16 v[192:207], v[80:83], v[112:115], v[192:207]
    v_fma_f32 v213, v213, s48, v22
    v_exp_f32 v210, v210
    v_exp_f32 v211, v211
    v_fma_f32 v214, v214, s48, v22
    v_mfma_f32_32x32x16_bf16 v[192:207], v[84:87], v[116:119], v[192:207]
    v_fma_f32 v215, v215, s48, v22
    v_add_f32 v24, v24, v208
    v_add_f32 v25, v25, v209
    v_cvt_pk_bf16_f32 v244, v208, v209
    v_mfma_f32_32x32x16_bf16 v[192:207], v[88:91], v[120:123], v[192:207]
    v_exp_f32 v212, v212
    v_exp_f32 v213, v213
    v_fma_f32 v216, v216, s48, v22
    v_fma_f32 v217, v217, s48, v22
    v_mfma_f32_32x32x16_bf16 v[192:207], v[92:95], v[124:127], v[192:207]
    v_add_f32 v24, v24, v210
    v_add_f32 v25, v25, v211
    v_cvt_pk_bf16_f32 v245, v210, v211
    v_exp_f32 v214, v214
    v_exp_f32 v215, v215
    v_mfma_f32_32x32x16_bf16 v[128:143], v[32:35], v[224:227], v[128:143]
    ds_read_b64_tr_b16 v[32:33], v240 offset:0
    ds_read_b64_tr_b16 v[34:35], v240 offset:2048
    ds_read_b128 v[64:67], v232 offset:24576
    v_fma_f32 v218, v218, s48, v22
    v_fma_f32 v219, v219, s48, v22
    v_add_f32 v24, v24, v212
    v_add_f32 v25, v25, v213
    v_mfma_f32_32x32x16_bf16 v[128:143], v[36:39], v[228:231], v[128:143]
    ds_read_b64_tr_b16 v[36:37], v240 offset:4096
    ds_read_b64_tr_b16 v[38:39], v240 offset:6144
    ds_read_b128 v[68:71], v233 offset:24576
    v_cvt_pk_bf16_f32 v246, v212, v213
    v_exp_f32 v216, v216
    v_exp_f32 v217, v217
    v_fma_f32 v220, v220, s48, v22
    v_mfma_f32_32x32x16_bf16 v[144:159], v[40:43], v[224:227], v[144:159]
    ds_read_b64_tr_b16 v[40:41], v241 offset:0
    ds_read_b64_tr_b16 v[42:43], v241 offset:2048
    ds_read_b128 v[72:75], v234 offset:24576
    v_fma_f32 v221, v221, s48, v22
    v_add_f32 v24, v24, v214
    v_add_f32 v25, v25, v215
    v_cvt_pk_bf16_f32 v247, v214, v215
    v_mfma_f32_32x32x16_bf16 v[144:159], v[44:47], v[228:231], v[144:159]
    ds_read_b64_tr_b16 v[44:45], v241 offset:4096
    ds_read_b64_tr_b16 v[46:47], v241 offset:6144
    ds_read_b128 v[76:79], v235 offset:24576
    v_exp_f32 v218, v218
    v_exp_f32 v219, v219
    v_fma_f32 v222, v222, s48, v22
    v_fma_f32 v223, v223, s48, v22
    v_mfma_f32_32x32x16_bf16 v[160:175], v[48:51], v[224:227], v[160:175]
    ds_read_b64_tr_b16 v[48:49], v242 offset:0
    ds_read_b64_tr_b16 v[50:51], v242 offset:2048
    ds_read_b128 v[80:83], v236 offset:24576
    v_add_f32 v24, v24, v216
    v_add_f32 v25, v25, v217
    v_cvt_pk_bf16_f32 v248, v216, v217
    v_exp_f32 v220, v220
    v_mfma_f32_32x32x16_bf16 v[160:175], v[52:55], v[228:231], v[160:175]
    ds_read_b64_tr_b16 v[52:53], v242 offset:4096
    ds_read_b64_tr_b16 v[54:55], v242 offset:6144
    ds_read_b128 v[84:87], v237 offset:24576
    v_exp_f32 v221, v221
    v_add_f32 v24, v24, v218
    v_add_f32 v25, v25, v219
    v_cvt_pk_bf16_f32 v249, v218, v219
    v_mfma_f32_32x32x16_bf16 v[176:191], v[56:59], v[224:227], v[176:191]
    ds_read_b64_tr_b16 v[56:57], v243 offset:0
    ds_read_b64_tr_b16 v[58:59], v243 offset:2048
    ds_read_b128 v[88:91], v238 offset:24576
    v_exp_f32 v222, v222
    v_exp_f32 v223, v223
    v_add_f32 v24, v24, v220
    v_add_f32 v25, v25, v221
    v_mfma_f32_32x32x16_bf16 v[176:191], v[60:63], v[228:231], v[176:191]
    ds_read_b64_tr_b16 v[60:61], v243 offset:4096
    ds_read_b64_tr_b16 v[62:63], v243 offset:6144
    ds_read_b128 v[92:95], v239 offset:24576
    v_cvt_pk_bf16_f32 v250, v220, v221
    s_nop 0
    v_add_f32 v24, v24, v222
    v_add_f32 v25, v25, v223
    v_cvt_pk_bf16_f32 v251, v222, v223
    s_cmp_lg_u32 s56, 0
    s_cbranch_scc1 concat_heads__gqa_block_cached__gqa_block_cached__near_ridge_kernel_resc1
concat_heads__gqa_block_cached__gqa_block_cached__near_ridge_kernel_rr1:
    s_waitcnt lgkmcnt(0)
    s_barrier
    v_mfma_f32_32x32x16_bf16 v[208:223], v[64:67], v[96:99], 0
    v_max3_f32 v11, v192, v193, v194
    v_max3_f32 v12, v195, v196, v197
    v_max3_f32 v13, v198, v199, v200
    v_max3_f32 v14, v201, v202, v203
    v_mfma_f32_32x32x16_bf16 v[208:223], v[68:71], v[100:103], v[208:223]
    v_max3_f32 v15, v204, v205, v206
    v_max3_f32 v11, v11, v12, v207
    v_max3_f32 v13, v13, v14, v15
    v_max_f32 v11, v11, v13
    v_mfma_f32_32x32x16_bf16 v[208:223], v[72:75], v[104:107], v[208:223]
    v_cmp_gt_f32 vcc, v11, v21
    s_cbranch_vccnz concat_heads__gqa_block_cached__gqa_block_cached__near_ridge_kernel_slow2
concat_heads__gqa_block_cached__gqa_block_cached__near_ridge_kernel_ret2:
    v_fma_f32 v192, v192, s48, v22
    v_fma_f32 v193, v193, s48, v22
    v_fma_f32 v194, v194, s48, v22
    v_mfma_f32_32x32x16_bf16 v[208:223], v[76:79], v[108:111], v[208:223]
    v_fma_f32 v195, v195, s48, v22
    v_exp_f32 v192, v192
    v_exp_f32 v193, v193
    v_fma_f32 v196, v196, s48, v22
    v_mfma_f32_32x32x16_bf16 v[208:223], v[80:83], v[112:115], v[208:223]
    v_fma_f32 v197, v197, s48, v22
    v_exp_f32 v194, v194
    v_exp_f32 v195, v195
    v_fma_f32 v198, v198, s48, v22
    v_mfma_f32_32x32x16_bf16 v[208:223], v[84:87], v[116:119], v[208:223]
    v_fma_f32 v199, v199, s48, v22
    v_add_f32 v24, v24, v192
    v_add_f32 v25, v25, v193
    v_cvt_pk_bf16_f32 v224, v192, v193
    v_mfma_f32_32x32x16_bf16 v[208:223], v[88:91], v[120:123], v[208:223]
    v_exp_f32 v196, v196
    v_exp_f32 v197, v197
    v_fma_f32 v200, v200, s48, v22
    v_fma_f32 v201, v201, s48, v22
    v_mfma_f32_32x32x16_bf16 v[208:223], v[92:95], v[124:127], v[208:223]
    v_add_f32 v24, v24, v194
    v_add_f32 v25, v25, v195
    v_cvt_pk_bf16_f32 v225, v194, v195
    v_exp_f32 v198, v198
    v_exp_f32 v199, v199
    v_mfma_f32_32x32x16_bf16 v[128:143], v[32:35], v[244:247], v[128:143]
    ds_read_b64_tr_b16 v[32:33], v240 offset:16384
    ds_read_b64_tr_b16 v[34:35], v240 offset:18432
    ds_read_b128 v[64:67], v232 offset:40960
    v_fma_f32 v202, v202, s48, v22
    v_fma_f32 v203, v203, s48, v22
    v_add_f32 v24, v24, v196
    v_add_f32 v25, v25, v197
    v_mfma_f32_32x32x16_bf16 v[128:143], v[36:39], v[248:251], v[128:143]
    ds_read_b64_tr_b16 v[36:37], v240 offset:20480
    ds_read_b64_tr_b16 v[38:39], v240 offset:22528
    ds_read_b128 v[68:71], v233 offset:40960
    v_cvt_pk_bf16_f32 v226, v196, v197
    v_exp_f32 v200, v200
    v_exp_f32 v201, v201
    v_fma_f32 v204, v204, s48, v22
    v_mfma_f32_32x32x16_bf16 v[144:159], v[40:43], v[244:247], v[144:159]
    ds_read_b64_tr_b16 v[40:41], v241 offset:16384
    ds_read_b64_tr_b16 v[42:43], v241 offset:18432
    ds_read_b128 v[72:75], v234 offset:40960
    v_fma_f32 v205, v205, s48, v22
    v_add_f32 v24, v24, v198
    v_add_f32 v25, v25, v199
    v_cvt_pk_bf16_f32 v227, v198, v199
    v_mfma_f32_32x32x16_bf16 v[144:159], v[44:47], v[248:251], v[144:159]
    ds_read_b64_tr_b16 v[44:45], v241 offset:20480
    ds_read_b64_tr_b16 v[46:47], v241 offset:22528
    ds_read_b128 v[76:79], v235 offset:40960
    v_exp_f32 v202, v202
    v_exp_f32 v203, v203
    v_fma_f32 v206, v206, s48, v22
    v_fma_f32 v207, v207, s48, v22
    v_mfma_f32_32x32x16_bf16 v[160:175], v[48:51], v[244:247], v[160:175]
    ds_read_b64_tr_b16 v[48:49], v242 offset:16384
    ds_read_b64_tr_b16 v[50:51], v242 offset:18432
    ds_read_b128 v[80:83], v236 offset:40960
    v_add_f32 v24, v24, v200
    v_add_f32 v25, v25, v201
    v_cvt_pk_bf16_f32 v228, v200, v201
    v_exp_f32 v204, v204
    v_mfma_f32_32x32x16_bf16 v[160:175], v[52:55], v[248:251], v[160:175]
    ds_read_b64_tr_b16 v[52:53], v242 offset:20480
    ds_read_b64_tr_b16 v[54:55], v242 offset:22528
    ds_read_b128 v[84:87], v237 offset:40960
    v_exp_f32 v205, v205
    v_add_f32 v24, v24, v202
    v_add_f32 v25, v25, v203
    v_cvt_pk_bf16_f32 v229, v202, v203
    v_mfma_f32_32x32x16_bf16 v[176:191], v[56:59], v[244:247], v[176:191]
    ds_read_b64_tr_b16 v[56:57], v243 offset:16384
    ds_read_b64_tr_b16 v[58:59], v243 offset:18432
    ds_read_b128 v[88:91], v238 offset:40960
    v_exp_f32 v206, v206
    v_exp_f32 v207, v207
    v_add_f32 v24, v24, v204
    v_add_f32 v25, v25, v205
    v_mfma_f32_32x32x16_bf16 v[176:191], v[60:63], v[248:251], v[176:191]
    ds_read_b64_tr_b16 v[60:61], v243 offset:20480
    ds_read_b64_tr_b16 v[62:63], v243 offset:22528
    ds_read_b128 v[92:95], v239 offset:40960
    v_cvt_pk_bf16_f32 v230, v204, v205
    s_nop 0
    v_add_f32 v24, v24, v206
    v_add_f32 v25, v25, v207
    v_cvt_pk_bf16_f32 v231, v206, v207
    s_cmp_lg_u32 s56, 0
    s_cbranch_scc1 concat_heads__gqa_block_cached__gqa_block_cached__near_ridge_kernel_resc2
concat_heads__gqa_block_cached__gqa_block_cached__near_ridge_kernel_rr2:
    s_waitcnt lgkmcnt(0)
    s_barrier
    v_mfma_f32_32x32x16_bf16 v[192:207], v[64:67], v[96:99], 0
    v_max3_f32 v11, v208, v209, v210
    v_max3_f32 v12, v211, v212, v213
    v_max3_f32 v13, v214, v215, v216
    v_max3_f32 v14, v217, v218, v219
    v_mfma_f32_32x32x16_bf16 v[192:207], v[68:71], v[100:103], v[192:207]
    v_max3_f32 v15, v220, v221, v222
    v_max3_f32 v11, v11, v12, v223
    v_max3_f32 v13, v13, v14, v15
    v_max_f32 v11, v11, v13
    v_mfma_f32_32x32x16_bf16 v[192:207], v[72:75], v[104:107], v[192:207]
    v_cmp_gt_f32 vcc, v11, v21
    s_cbranch_vccnz concat_heads__gqa_block_cached__gqa_block_cached__near_ridge_kernel_slow3
concat_heads__gqa_block_cached__gqa_block_cached__near_ridge_kernel_ret3:
    v_fma_f32 v208, v208, s48, v22
    v_fma_f32 v209, v209, s48, v22
    v_fma_f32 v210, v210, s48, v22
    v_mfma_f32_32x32x16_bf16 v[192:207], v[76:79], v[108:111], v[192:207]
    v_fma_f32 v211, v211, s48, v22
    v_exp_f32 v208, v208
    v_exp_f32 v209, v209
    v_fma_f32 v212, v212, s48, v22
    v_mfma_f32_32x32x16_bf16 v[192:207], v[80:83], v[112:115], v[192:207]
    v_fma_f32 v213, v213, s48, v22
    v_exp_f32 v210, v210
    v_exp_f32 v211, v211
    v_fma_f32 v214, v214, s48, v22
    v_mfma_f32_32x32x16_bf16 v[192:207], v[84:87], v[116:119], v[192:207]
    v_fma_f32 v215, v215, s48, v22
    v_add_f32 v24, v24, v208
    v_add_f32 v25, v25, v209
    v_cvt_pk_bf16_f32 v244, v208, v209
    v_mfma_f32_32x32x16_bf16 v[192:207], v[88:91], v[120:123], v[192:207]
    v_exp_f32 v212, v212
    v_exp_f32 v213, v213
    v_fma_f32 v216, v216, s48, v22
    v_fma_f32 v217, v217, s48, v22
    v_mfma_f32_32x32x16_bf16 v[192:207], v[92:95], v[124:127], v[192:207]
    v_add_f32 v24, v24, v210
    v_add_f32 v25, v25, v211
    v_cvt_pk_bf16_f32 v245, v210, v211
    v_exp_f32 v214, v214
    v_exp_f32 v215, v215
    v_mfma_f32_32x32x16_bf16 v[128:143], v[32:35], v[224:227], v[128:143]
    ds_read_b64_tr_b16 v[32:33], v240 offset:32768
    ds_read_b64_tr_b16 v[34:35], v240 offset:34816
    ds_read_b128 v[64:67], v232 offset:57344
    v_fma_f32 v218, v218, s48, v22
    v_fma_f32 v219, v219, s48, v22
    v_add_f32 v24, v24, v212
    v_add_f32 v25, v25, v213
    v_mfma_f32_32x32x16_bf16 v[128:143], v[36:39], v[228:231], v[128:143]
    ds_read_b64_tr_b16 v[36:37], v240 offset:36864
    ds_read_b64_tr_b16 v[38:39], v240 offset:38912
    ds_read_b128 v[68:71], v233 offset:57344
    v_cvt_pk_bf16_f32 v246, v212, v213
    v_exp_f32 v216, v216
    v_exp_f32 v217, v217
    v_fma_f32 v220, v220, s48, v22
    v_mfma_f32_32x32x16_bf16 v[144:159], v[40:43], v[224:227], v[144:159]
    ds_read_b64_tr_b16 v[40:41], v241 offset:32768
    ds_read_b64_tr_b16 v[42:43], v241 offset:34816
    ds_read_b128 v[72:75], v234 offset:57344
    v_fma_f32 v221, v221, s48, v22
    v_add_f32 v24, v24, v214
    v_add_f32 v25, v25, v215
    v_cvt_pk_bf16_f32 v247, v214, v215
    v_mfma_f32_32x32x16_bf16 v[144:159], v[44:47], v[228:231], v[144:159]
    ds_read_b64_tr_b16 v[44:45], v241 offset:36864
    ds_read_b64_tr_b16 v[46:47], v241 offset:38912
    ds_read_b128 v[76:79], v235 offset:57344
    v_exp_f32 v218, v218
    v_exp_f32 v219, v219
    v_fma_f32 v222, v222, s48, v22
    v_fma_f32 v223, v223, s48, v22
    v_mfma_f32_32x32x16_bf16 v[160:175], v[48:51], v[224:227], v[160:175]
    ds_read_b64_tr_b16 v[48:49], v242 offset:32768
    ds_read_b64_tr_b16 v[50:51], v242 offset:34816
    ds_read_b128 v[80:83], v236 offset:57344
    v_add_f32 v24, v24, v216
    v_add_f32 v25, v25, v217
    v_cvt_pk_bf16_f32 v248, v216, v217
    v_exp_f32 v220, v220
    v_mfma_f32_32x32x16_bf16 v[160:175], v[52:55], v[228:231], v[160:175]
    ds_read_b64_tr_b16 v[52:53], v242 offset:36864
    ds_read_b64_tr_b16 v[54:55], v242 offset:38912
    ds_read_b128 v[84:87], v237 offset:57344
    v_exp_f32 v221, v221
    v_add_f32 v24, v24, v218
    v_add_f32 v25, v25, v219
    v_cvt_pk_bf16_f32 v249, v218, v219
    v_mfma_f32_32x32x16_bf16 v[176:191], v[56:59], v[224:227], v[176:191]
    ds_read_b64_tr_b16 v[56:57], v243 offset:32768
    ds_read_b64_tr_b16 v[58:59], v243 offset:34816
    ds_read_b128 v[88:91], v238 offset:57344
    v_exp_f32 v222, v222
    v_exp_f32 v223, v223
    v_add_f32 v24, v24, v220
    v_add_f32 v25, v25, v221
    v_mfma_f32_32x32x16_bf16 v[176:191], v[60:63], v[228:231], v[176:191]
    ds_read_b64_tr_b16 v[60:61], v243 offset:36864
    ds_read_b64_tr_b16 v[62:63], v243 offset:38912
    ds_read_b128 v[92:95], v239 offset:57344
    v_cvt_pk_bf16_f32 v250, v220, v221
    s_nop 0
    v_add_f32 v24, v24, v222
    v_add_f32 v25, v25, v223
    v_cvt_pk_bf16_f32 v251, v222, v223
    s_cmp_lg_u32 s56, 0
    s_cbranch_scc1 concat_heads__gqa_block_cached__gqa_block_cached__near_ridge_kernel_resc3
concat_heads__gqa_block_cached__gqa_block_cached__near_ridge_kernel_rr3:
    s_waitcnt lgkmcnt(0)
    s_barrier
    v_mfma_f32_32x32x16_bf16 v[208:223], v[64:67], v[96:99], 0
    v_max3_f32 v11, v192, v193, v194
    v_max3_f32 v12, v195, v196, v197
    v_max3_f32 v13, v198, v199, v200
    v_max3_f32 v14, v201, v202, v203
    v_mfma_f32_32x32x16_bf16 v[208:223], v[68:71], v[100:103], v[208:223]
    v_max3_f32 v15, v204, v205, v206
    v_max3_f32 v11, v11, v12, v207
    v_max3_f32 v13, v13, v14, v15
    v_max_f32 v11, v11, v13
    v_mfma_f32_32x32x16_bf16 v[208:223], v[72:75], v[104:107], v[208:223]
    v_cmp_gt_f32 vcc, v11, v21
    s_cbranch_vccnz concat_heads__gqa_block_cached__gqa_block_cached__near_ridge_kernel_slow4
concat_heads__gqa_block_cached__gqa_block_cached__near_ridge_kernel_ret4:
    v_fma_f32 v192, v192, s48, v22
    v_fma_f32 v193, v193, s48, v22
    v_fma_f32 v194, v194, s48, v22
    v_mfma_f32_32x32x16_bf16 v[208:223], v[76:79], v[108:111], v[208:223]
    v_fma_f32 v195, v195, s48, v22
    v_exp_f32 v192, v192
    v_exp_f32 v193, v193
    v_fma_f32 v196, v196, s48, v22
    v_mfma_f32_32x32x16_bf16 v[208:223], v[80:83], v[112:115], v[208:223]
    v_fma_f32 v197, v197, s48, v22
    v_exp_f32 v194, v194
    v_exp_f32 v195, v195
    v_fma_f32 v198, v198, s48, v22
    v_mfma_f32_32x32x16_bf16 v[208:223], v[84:87], v[116:119], v[208:223]
    v_fma_f32 v199, v199, s48, v22
    v_add_f32 v24, v24, v192
    v_add_f32 v25, v25, v193
    v_cvt_pk_bf16_f32 v224, v192, v193
    v_mfma_f32_32x32x16_bf16 v[208:223], v[88:91], v[120:123], v[208:223]
    v_exp_f32 v196, v196
    v_exp_f32 v197, v197
    v_fma_f32 v200, v200, s48, v22
    v_fma_f32 v201, v201, s48, v22
    v_mfma_f32_32x32x16_bf16 v[208:223], v[92:95], v[124:127], v[208:223]
    v_add_f32 v24, v24, v194
    v_add_f32 v25, v25, v195
    v_cvt_pk_bf16_f32 v225, v194, v195
    v_exp_f32 v198, v198
    v_exp_f32 v199, v199
    v_mfma_f32_32x32x16_bf16 v[128:143], v[32:35], v[244:247], v[128:143]
    ds_read_b64_tr_b16 v[32:33], v240 offset:40960
    ds_read_b64_tr_b16 v[34:35], v240 offset:43008
    ds_read_b128 v[64:67], v232 offset:0
    v_fma_f32 v202, v202, s48, v22
    v_fma_f32 v203, v203, s48, v22
    v_add_f32 v24, v24, v196
    v_add_f32 v25, v25, v197
    v_mfma_f32_32x32x16_bf16 v[128:143], v[36:39], v[248:251], v[128:143]
    ds_read_b64_tr_b16 v[36:37], v240 offset:45056
    ds_read_b64_tr_b16 v[38:39], v240 offset:47104
    ds_read_b128 v[68:71], v233 offset:0
    v_cvt_pk_bf16_f32 v226, v196, v197
    v_exp_f32 v200, v200
    v_exp_f32 v201, v201
    v_fma_f32 v204, v204, s48, v22
    v_mfma_f32_32x32x16_bf16 v[144:159], v[40:43], v[244:247], v[144:159]
    ds_read_b64_tr_b16 v[40:41], v241 offset:40960
    ds_read_b64_tr_b16 v[42:43], v241 offset:43008
    ds_read_b128 v[72:75], v234 offset:0
    v_fma_f32 v205, v205, s48, v22
    v_add_f32 v24, v24, v198
    v_add_f32 v25, v25, v199
    v_cvt_pk_bf16_f32 v227, v198, v199
    v_mfma_f32_32x32x16_bf16 v[144:159], v[44:47], v[248:251], v[144:159]
    ds_read_b64_tr_b16 v[44:45], v241 offset:45056
    ds_read_b64_tr_b16 v[46:47], v241 offset:47104
    ds_read_b128 v[76:79], v235 offset:0
    v_exp_f32 v202, v202
    v_exp_f32 v203, v203
    v_fma_f32 v206, v206, s48, v22
    v_fma_f32 v207, v207, s48, v22
    v_mfma_f32_32x32x16_bf16 v[160:175], v[48:51], v[244:247], v[160:175]
    ds_read_b64_tr_b16 v[48:49], v242 offset:40960
    ds_read_b64_tr_b16 v[50:51], v242 offset:43008
    ds_read_b128 v[80:83], v236 offset:0
    v_add_f32 v24, v24, v200
    v_add_f32 v25, v25, v201
    v_cvt_pk_bf16_f32 v228, v200, v201
    v_exp_f32 v204, v204
    v_mfma_f32_32x32x16_bf16 v[160:175], v[52:55], v[248:251], v[160:175]
    ds_read_b64_tr_b16 v[52:53], v242 offset:45056
    ds_read_b64_tr_b16 v[54:55], v242 offset:47104
    ds_read_b128 v[84:87], v237 offset:0
    v_exp_f32 v205, v205
    v_add_f32 v24, v24, v202
    v_add_f32 v25, v25, v203
    v_cvt_pk_bf16_f32 v229, v202, v203
    v_mfma_f32_32x32x16_bf16 v[176:191], v[56:59], v[244:247], v[176:191]
    ds_read_b64_tr_b16 v[56:57], v243 offset:40960
    ds_read_b64_tr_b16 v[58:59], v243 offset:43008
    ds_read_b128 v[88:91], v238 offset:0
    v_exp_f32 v206, v206
    v_exp_f32 v207, v207
    v_add_f32 v24, v24, v204
    v_add_f32 v25, v25, v205
    v_mfma_f32_32x32x16_bf16 v[176:191], v[60:63], v[248:251], v[176:191]
    ds_read_b64_tr_b16 v[60:61], v243 offset:45056
    ds_read_b64_tr_b16 v[62:63], v243 offset:47104
    ds_read_b128 v[92:95], v239 offset:0
    v_cvt_pk_bf16_f32 v230, v204, v205
    s_nop 0
    v_add_f32 v24, v24, v206
    v_add_f32 v25, v25, v207
    v_cvt_pk_bf16_f32 v231, v206, v207
    s_cmp_lg_u32 s56, 0
    s_cbranch_scc1 concat_heads__gqa_block_cached__gqa_block_cached__near_ridge_kernel_resc4
concat_heads__gqa_block_cached__gqa_block_cached__near_ridge_kernel_rr4:
    s_waitcnt lgkmcnt(0)
    s_barrier
    v_mfma_f32_32x32x16_bf16 v[192:207], v[64:67], v[96:99], 0
    v_max3_f32 v11, v208, v209, v210
    v_max3_f32 v12, v211, v212, v213
    v_max3_f32 v13, v214, v215, v216
    v_max3_f32 v14, v217, v218, v219
    v_mfma_f32_32x32x16_bf16 v[192:207], v[68:71], v[100:103], v[192:207]
    v_max3_f32 v15, v220, v221, v222
    v_max3_f32 v11, v11, v12, v223
    v_max3_f32 v13, v13, v14, v15
    v_max_f32 v11, v11, v13
    v_mfma_f32_32x32x16_bf16 v[192:207], v[72:75], v[104:107], v[192:207]
    v_cmp_gt_f32 vcc, v11, v21
    s_cbranch_vccnz concat_heads__gqa_block_cached__gqa_block_cached__near_ridge_kernel_slow5
concat_heads__gqa_block_cached__gqa_block_cached__near_ridge_kernel_ret5:
    v_fma_f32 v208, v208, s48, v22
    v_fma_f32 v209, v209, s48, v22
    v_fma_f32 v210, v210, s48, v22
    v_mfma_f32_32x32x16_bf16 v[192:207], v[76:79], v[108:111], v[192:207]
    v_fma_f32 v211, v211, s48, v22
    v_exp_f32 v208, v208
    v_exp_f32 v209, v209
    v_fma_f32 v212, v212, s48, v22
    v_mfma_f32_32x32x16_bf16 v[192:207], v[80:83], v[112:115], v[192:207]
    v_fma_f32 v213, v213, s48, v22
    v_exp_f32 v210, v210
    v_exp_f32 v211, v211
    v_fma_f32 v214, v214, s48, v22
    v_mfma_f32_32x32x16_bf16 v[192:207], v[84:87], v[116:119], v[192:207]
    v_fma_f32 v215, v215, s48, v22
    v_add_f32 v24, v24, v208
    v_add_f32 v25, v25, v209
    v_cvt_pk_bf16_f32 v244, v208, v209
    v_mfma_f32_32x32x16_bf16 v[192:207], v[88:91], v[120:123], v[192:207]
    v_exp_f32 v212, v212
    v_exp_f32 v213, v213
    v_fma_f32 v216, v216, s48, v22
    v_fma_f32 v217, v217, s48, v22
    v_mfma_f32_32x32x16_bf16 v[192:207], v[92:95], v[124:127], v[192:207]
    v_add_f32 v24, v24, v210
    v_add_f32 v25, v25, v211
    v_cvt_pk_bf16_f32 v245, v210, v211
    v_exp_f32 v214, v214
    v_exp_f32 v215, v215
    v_mfma_f32_32x32x16_bf16 v[128:143], v[32:35], v[224:227], v[128:143]
    ds_read_b64_tr_b16 v[32:33], v240 offset:57344
    ds_read_b64_tr_b16 v[34:35], v240 offset:59392
    ds_read_b128 v[64:67], v232 offset:8192
    v_fma_f32 v218, v218, s48, v22
    v_fma_f32 v219, v219, s48, v22
    v_add_f32 v24, v24, v212
    v_add_f32 v25, v25, v213
    v_mfma_f32_32x32x16_bf16 v[128:143], v[36:39], v[228:231], v[128:143]
    ds_read_b64_tr_b16 v[36:37], v240 offset:61440
    ds_read_b64_tr_b16 v[38:39], v240 offset:63488
    ds_read_b128 v[68:71], v233 offset:8192
    v_cvt_pk_bf16_f32 v246, v212, v213
    v_exp_f32 v216, v216
    v_exp_f32 v217, v217
    v_fma_f32 v220, v220, s48, v22
    v_mfma_f32_32x32x16_bf16 v[144:159], v[40:43], v[224:227], v[144:159]
    ds_read_b64_tr_b16 v[40:41], v241 offset:57344
    ds_read_b64_tr_b16 v[42:43], v241 offset:59392
    ds_read_b128 v[72:75], v234 offset:8192
    v_fma_f32 v221, v221, s48, v22
    v_add_f32 v24, v24, v214
    v_add_f32 v25, v25, v215
    v_cvt_pk_bf16_f32 v247, v214, v215
    v_mfma_f32_32x32x16_bf16 v[144:159], v[44:47], v[228:231], v[144:159]
    ds_read_b64_tr_b16 v[44:45], v241 offset:61440
    ds_read_b64_tr_b16 v[46:47], v241 offset:63488
    ds_read_b128 v[76:79], v235 offset:8192
    v_exp_f32 v218, v218
    v_exp_f32 v219, v219
    v_fma_f32 v222, v222, s48, v22
    v_fma_f32 v223, v223, s48, v22
    v_mfma_f32_32x32x16_bf16 v[160:175], v[48:51], v[224:227], v[160:175]
    ds_read_b64_tr_b16 v[48:49], v242 offset:57344
    ds_read_b64_tr_b16 v[50:51], v242 offset:59392
    ds_read_b128 v[80:83], v236 offset:8192
    v_add_f32 v24, v24, v216
    v_add_f32 v25, v25, v217
    v_cvt_pk_bf16_f32 v248, v216, v217
    v_exp_f32 v220, v220
    v_mfma_f32_32x32x16_bf16 v[160:175], v[52:55], v[228:231], v[160:175]
    ds_read_b64_tr_b16 v[52:53], v242 offset:61440
    ds_read_b64_tr_b16 v[54:55], v242 offset:63488
    ds_read_b128 v[84:87], v237 offset:8192
    v_exp_f32 v221, v221
    v_add_f32 v24, v24, v218
    v_add_f32 v25, v25, v219
    v_cvt_pk_bf16_f32 v249, v218, v219
    v_mfma_f32_32x32x16_bf16 v[176:191], v[56:59], v[224:227], v[176:191]
    ds_read_b64_tr_b16 v[56:57], v243 offset:57344
    ds_read_b64_tr_b16 v[58:59], v243 offset:59392
    ds_read_b128 v[88:91], v238 offset:8192
    v_exp_f32 v222, v222
    v_exp_f32 v223, v223
    v_add_f32 v24, v24, v220
    v_add_f32 v25, v25, v221
    v_mfma_f32_32x32x16_bf16 v[176:191], v[60:63], v[228:231], v[176:191]
    ds_read_b64_tr_b16 v[60:61], v243 offset:61440
    ds_read_b64_tr_b16 v[62:63], v243 offset:63488
    ds_read_b128 v[92:95], v239 offset:8192
    v_cvt_pk_bf16_f32 v250, v220, v221
    s_nop 0
    v_add_f32 v24, v24, v222
    v_add_f32 v25, v25, v223
    v_cvt_pk_bf16_f32 v251, v222, v223
    s_cmp_lg_u32 s56, 0
    s_cbranch_scc1 concat_heads__gqa_block_cached__gqa_block_cached__near_ridge_kernel_resc5
concat_heads__gqa_block_cached__gqa_block_cached__near_ridge_kernel_rr5:
    s_waitcnt lgkmcnt(0)
    s_barrier
    s_add_u32 m0, s54, 0
    s_add_u32 s47, s92, 0
    buffer_load_dwordx4 v26, s[72:75], s47 offen lds
    s_add_u32 m0, s54, 1024
    s_add_u32 s47, s92, 0
    buffer_load_dwordx4 v27, s[72:75], s47 offen lds
    s_add_u32 s46, s94, 0
    s_cmp_lt_u32 s45, 4
    s_cselect_b32 m0, s46, s57
    s_add_u32 s47, s93, 512
    buffer_load_dwordx4 v28, s[72:75], s47 offen lds
    v_mfma_f32_32x32x16_bf16 v[208:223], v[64:67], v[96:99], 0
    v_max3_f32 v11, v192, v193, v194
    v_max3_f32 v12, v195, v196, v197
    v_max3_f32 v13, v198, v199, v200
    v_max3_f32 v14, v201, v202, v203
    v_mfma_f32_32x32x16_bf16 v[208:223], v[68:71], v[100:103], v[208:223]
    v_max3_f32 v15, v204, v205, v206
    v_max3_f32 v11, v11, v12, v207
    v_max3_f32 v13, v13, v14, v15
    v_max_f32 v11, v11, v13
    v_mfma_f32_32x32x16_bf16 v[208:223], v[72:75], v[104:107], v[208:223]
    v_cmp_gt_f32 vcc, v11, v21
    s_cbranch_vccnz concat_heads__gqa_block_cached__gqa_block_cached__near_ridge_kernel_slow6
concat_heads__gqa_block_cached__gqa_block_cached__near_ridge_kernel_ret6:
    v_fma_f32 v192, v192, s48, v22
    v_fma_f32 v193, v193, s48, v22
    v_fma_f32 v194, v194, s48, v22
    v_mfma_f32_32x32x16_bf16 v[208:223], v[76:79], v[108:111], v[208:223]
    v_fma_f32 v195, v195, s48, v22
    v_exp_f32 v192, v192
    v_exp_f32 v193, v193
    v_fma_f32 v196, v196, s48, v22
    v_mfma_f32_32x32x16_bf16 v[208:223], v[80:83], v[112:115], v[208:223]
    v_fma_f32 v197, v197, s48, v22
    v_exp_f32 v194, v194
    v_exp_f32 v195, v195
    v_fma_f32 v198, v198, s48, v22
    v_mfma_f32_32x32x16_bf16 v[208:223], v[84:87], v[116:119], v[208:223]
    v_fma_f32 v199, v199, s48, v22
    v_add_f32 v24, v24, v192
    v_add_f32 v25, v25, v193
    v_cvt_pk_bf16_f32 v224, v192, v193
    v_mfma_f32_32x32x16_bf16 v[208:223], v[88:91], v[120:123], v[208:223]
    v_exp_f32 v196, v196
    v_exp_f32 v197, v197
    v_fma_f32 v200, v200, s48, v22
    v_fma_f32 v201, v201, s48, v22
    v_mfma_f32_32x32x16_bf16 v[208:223], v[92:95], v[124:127], v[208:223]
    v_add_f32 v24, v24, v194
    v_add_f32 v25, v25, v195
    v_cvt_pk_bf16_f32 v225, v194, v195
    v_exp_f32 v198, v198
    v_exp_f32 v199, v199
    v_mfma_f32_32x32x16_bf16 v[128:143], v[32:35], v[244:247], v[128:143]
    ds_read_b64_tr_b16 v[32:33], v240 offset:0
    ds_read_b64_tr_b16 v[34:35], v240 offset:2048
    ds_read_b128 v[64:67], v232 offset:16384
    v_fma_f32 v202, v202, s48, v22
    v_fma_f32 v203, v203, s48, v22
    v_add_f32 v24, v24, v196
    v_add_f32 v25, v25, v197
    v_mfma_f32_32x32x16_bf16 v[128:143], v[36:39], v[248:251], v[128:143]
    ds_read_b64_tr_b16 v[36:37], v240 offset:4096
    ds_read_b64_tr_b16 v[38:39], v240 offset:6144
    ds_read_b128 v[68:71], v233 offset:16384
    v_cvt_pk_bf16_f32 v226, v196, v197
    v_exp_f32 v200, v200
    v_exp_f32 v201, v201
    v_fma_f32 v204, v204, s48, v22
    v_mfma_f32_32x32x16_bf16 v[144:159], v[40:43], v[244:247], v[144:159]
    ds_read_b64_tr_b16 v[40:41], v241 offset:0
    ds_read_b64_tr_b16 v[42:43], v241 offset:2048
    ds_read_b128 v[72:75], v234 offset:16384
    v_fma_f32 v205, v205, s48, v22
    v_add_f32 v24, v24, v198
    v_add_f32 v25, v25, v199
    v_cvt_pk_bf16_f32 v227, v198, v199
    v_mfma_f32_32x32x16_bf16 v[144:159], v[44:47], v[248:251], v[144:159]
    ds_read_b64_tr_b16 v[44:45], v241 offset:4096
    ds_read_b64_tr_b16 v[46:47], v241 offset:6144
    ds_read_b128 v[76:79], v235 offset:16384
    v_exp_f32 v202, v202
    v_exp_f32 v203, v203
    v_fma_f32 v206, v206, s48, v22
    v_fma_f32 v207, v207, s48, v22
    v_mfma_f32_32x32x16_bf16 v[160:175], v[48:51], v[244:247], v[160:175]
    ds_read_b64_tr_b16 v[48:49], v242 offset:0
    ds_read_b64_tr_b16 v[50:51], v242 offset:2048
    ds_read_b128 v[80:83], v236 offset:16384
    v_add_f32 v24, v24, v200
    v_add_f32 v25, v25, v201
    v_cvt_pk_bf16_f32 v228, v200, v201
    v_exp_f32 v204, v204
    v_mfma_f32_32x32x16_bf16 v[160:175], v[52:55], v[248:251], v[160:175]
    ds_read_b64_tr_b16 v[52:53], v242 offset:4096
    ds_read_b64_tr_b16 v[54:55], v242 offset:6144
    ds_read_b128 v[84:87], v237 offset:16384
    v_exp_f32 v205, v205
    v_add_f32 v24, v24, v202
    v_add_f32 v25, v25, v203
    v_cvt_pk_bf16_f32 v229, v202, v203
    v_mfma_f32_32x32x16_bf16 v[176:191], v[56:59], v[244:247], v[176:191]
    ds_read_b64_tr_b16 v[56:57], v243 offset:0
    ds_read_b64_tr_b16 v[58:59], v243 offset:2048
    ds_read_b128 v[88:91], v238 offset:16384
    v_exp_f32 v206, v206
    v_exp_f32 v207, v207
    v_add_f32 v24, v24, v204
    v_add_f32 v25, v25, v205
    v_mfma_f32_32x32x16_bf16 v[176:191], v[60:63], v[248:251], v[176:191]
    ds_read_b64_tr_b16 v[60:61], v243 offset:4096
    ds_read_b64_tr_b16 v[62:63], v243 offset:6144
    ds_read_b128 v[92:95], v239 offset:16384
    v_cvt_pk_bf16_f32 v230, v204, v205
    s_nop 0
    v_add_f32 v24, v24, v206
    v_add_f32 v25, v25, v207
    v_cvt_pk_bf16_f32 v231, v206, v207
    s_cmp_lg_u32 s56, 0
    s_cbranch_scc1 concat_heads__gqa_block_cached__gqa_block_cached__near_ridge_kernel_resc6
concat_heads__gqa_block_cached__gqa_block_cached__near_ridge_kernel_rr6:
    s_waitcnt lgkmcnt(0)
    s_barrier
    v_mfma_f32_32x32x16_bf16 v[192:207], v[64:67], v[96:99], 0
    v_max3_f32 v11, v208, v209, v210
    v_max3_f32 v12, v211, v212, v213
    v_max3_f32 v13, v214, v215, v216
    v_max3_f32 v14, v217, v218, v219
    v_mfma_f32_32x32x16_bf16 v[192:207], v[68:71], v[100:103], v[192:207]
    v_max3_f32 v15, v220, v221, v222
    v_max3_f32 v11, v11, v12, v223
    v_max3_f32 v13, v13, v14, v15
    v_max_f32 v11, v11, v13
    v_mfma_f32_32x32x16_bf16 v[192:207], v[72:75], v[104:107], v[192:207]
    v_cmp_gt_f32 vcc, v11, v21
    s_cbranch_vccnz concat_heads__gqa_block_cached__gqa_block_cached__near_ridge_kernel_slow7
concat_heads__gqa_block_cached__gqa_block_cached__near_ridge_kernel_ret7:
    v_fma_f32 v208, v208, s48, v22
    v_fma_f32 v209, v209, s48, v22
    v_fma_f32 v210, v210, s48, v22
    v_mfma_f32_32x32x16_bf16 v[192:207], v[76:79], v[108:111], v[192:207]
    v_fma_f32 v211, v211, s48, v22
    v_exp_f32 v208, v208
    v_exp_f32 v209, v209
    v_fma_f32 v212, v212, s48, v22
    v_mfma_f32_32x32x16_bf16 v[192:207], v[80:83], v[112:115], v[192:207]
    v_fma_f32 v213, v213, s48, v22
    v_exp_f32 v210, v210
    v_exp_f32 v211, v211
    v_fma_f32 v214, v214, s48, v22
    v_mfma_f32_32x32x16_bf16 v[192:207], v[84:87], v[116:119], v[192:207]
    v_fma_f32 v215, v215, s48, v22
    v_add_f32 v24, v24, v208
    v_add_f32 v25, v25, v209
    v_cvt_pk_bf16_f32 v244, v208, v209
    v_mfma_f32_32x32x16_bf16 v[192:207], v[88:91], v[120:123], v[192:207]
    v_exp_f32 v212, v212
    v_exp_f32 v213, v213
    v_fma_f32 v216, v216, s48, v22
    v_fma_f32 v217, v217, s48, v22
    v_mfma_f32_32x32x16_bf16 v[192:207], v[92:95], v[124:127], v[192:207]
    v_add_f32 v24, v24, v210
    v_add_f32 v25, v25, v211
    v_cvt_pk_bf16_f32 v245, v210, v211
    v_exp_f32 v214, v214
    v_exp_f32 v215, v215
    v_mfma_f32_32x32x16_bf16 v[128:143], v[32:35], v[224:227], v[128:143]
    ds_read_b64_tr_b16 v[32:33], v240 offset:16384
    ds_read_b64_tr_b16 v[34:35], v240 offset:18432
    ds_read_b128 v[64:67], v232 offset:24576
    v_fma_f32 v218, v218, s48, v22
    v_fma_f32 v219, v219, s48, v22
    v_add_f32 v24, v24, v212
    v_add_f32 v25, v25, v213
    v_mfma_f32_32x32x16_bf16 v[128:143], v[36:39], v[228:231], v[128:143]
    ds_read_b64_tr_b16 v[36:37], v240 offset:20480
    ds_read_b64_tr_b16 v[38:39], v240 offset:22528
    ds_read_b128 v[68:71], v233 offset:24576
    v_cvt_pk_bf16_f32 v246, v212, v213
    v_exp_f32 v216, v216
    v_exp_f32 v217, v217
    v_fma_f32 v220, v220, s48, v22
    v_mfma_f32_32x32x16_bf16 v[144:159], v[40:43], v[224:227], v[144:159]
    ds_read_b64_tr_b16 v[40:41], v241 offset:16384
    ds_read_b64_tr_b16 v[42:43], v241 offset:18432
    ds_read_b128 v[72:75], v234 offset:24576
    v_fma_f32 v221, v221, s48, v22
    v_add_f32 v24, v24, v214
    v_add_f32 v25, v25, v215
    v_cvt_pk_bf16_f32 v247, v214, v215
    v_mfma_f32_32x32x16_bf16 v[144:159], v[44:47], v[228:231], v[144:159]
    ds_read_b64_tr_b16 v[44:45], v241 offset:20480
    ds_read_b64_tr_b16 v[46:47], v241 offset:22528
    ds_read_b128 v[76:79], v235 offset:24576
    v_exp_f32 v218, v218
    v_exp_f32 v219, v219
    v_fma_f32 v222, v222, s48, v22
    v_fma_f32 v223, v223, s48, v22
    v_mfma_f32_32x32x16_bf16 v[160:175], v[48:51], v[224:227], v[160:175]
    ds_read_b64_tr_b16 v[48:49], v242 offset:16384
    ds_read_b64_tr_b16 v[50:51], v242 offset:18432
    ds_read_b128 v[80:83], v236 offset:24576
    v_add_f32 v24, v24, v216
    v_add_f32 v25, v25, v217
    v_cvt_pk_bf16_f32 v248, v216, v217
    v_exp_f32 v220, v220
    v_mfma_f32_32x32x16_bf16 v[160:175], v[52:55], v[228:231], v[160:175]
    ds_read_b64_tr_b16 v[52:53], v242 offset:20480
    ds_read_b64_tr_b16 v[54:55], v242 offset:22528
    ds_read_b128 v[84:87], v237 offset:24576
    v_exp_f32 v221, v221
    v_add_f32 v24, v24, v218
    v_add_f32 v25, v25, v219
    v_cvt_pk_bf16_f32 v249, v218, v219
    v_mfma_f32_32x32x16_bf16 v[176:191], v[56:59], v[224:227], v[176:191]
    ds_read_b64_tr_b16 v[56:57], v243 offset:16384
    ds_read_b64_tr_b16 v[58:59], v243 offset:18432
    ds_read_b128 v[88:91], v238 offset:24576
    v_exp_f32 v222, v222
    v_exp_f32 v223, v223
    v_add_f32 v24, v24, v220
    v_add_f32 v25, v25, v221
    v_mfma_f32_32x32x16_bf16 v[176:191], v[60:63], v[228:231], v[176:191]
    ds_read_b64_tr_b16 v[60:61], v243 offset:20480
    ds_read_b64_tr_b16 v[62:63], v243 offset:22528
    ds_read_b128 v[92:95], v239 offset:24576
    v_cvt_pk_bf16_f32 v250, v220, v221
    s_nop 0
    v_add_f32 v24, v24, v222
    v_add_f32 v25, v25, v223
    v_cvt_pk_bf16_f32 v251, v222, v223
    s_cmp_lg_u32 s56, 0
    s_cbranch_scc1 concat_heads__gqa_block_cached__gqa_block_cached__near_ridge_kernel_resc7
concat_heads__gqa_block_cached__gqa_block_cached__near_ridge_kernel_rr7:
    s_waitcnt lgkmcnt(0)
    s_barrier
    s_add_u32 m0, s54, 20480
    s_add_u32 s47, s92, 36864
    buffer_load_dwordx4 v26, s[72:75], s47 offen lds
    s_add_u32 m0, s54, 21504
    s_add_u32 s47, s92, 36864
    buffer_load_dwordx4 v27, s[72:75], s47 offen lds
    s_add_u32 s46, s94, 20480
    s_cmp_lt_u32 s45, 4
    s_cselect_b32 m0, s46, s57
    s_add_u32 s47, s93, 37376
    buffer_load_dwordx4 v28, s[72:75], s47 offen lds
    v_mfma_f32_32x32x16_bf16 v[208:223], v[64:67], v[96:99], 0
    v_max3_f32 v11, v192, v193, v194
    v_max3_f32 v12, v195, v196, v197
    v_max3_f32 v13, v198, v199, v200
    v_max3_f32 v14, v201, v202, v203
    v_mfma_f32_32x32x16_bf16 v[208:223], v[68:71], v[100:103], v[208:223]
    v_max3_f32 v15, v204, v205, v206
    v_max3_f32 v11, v11, v12, v207
    v_max3_f32 v13, v13, v14, v15
    v_max_f32 v11, v11, v13
    v_mfma_f32_32x32x16_bf16 v[208:223], v[72:75], v[104:107], v[208:223]
    v_cmp_gt_f32 vcc, v11, v21
    s_cbranch_vccnz concat_heads__gqa_block_cached__gqa_block_cached__near_ridge_kernel_slow8
concat_heads__gqa_block_cached__gqa_block_cached__near_ridge_kernel_ret8:
    v_fma_f32 v192, v192, s48, v22
    v_fma_f32 v193, v193, s48, v22
    v_fma_f32 v194, v194, s48, v22
    v_mfma_f32_32x32x16_bf16 v[208:223], v[76:79], v[108:111], v[208:223]
    v_fma_f32 v195, v195, s48, v22
    v_exp_f32 v192, v192
    v_exp_f32 v193, v193
    v_fma_f32 v196, v196, s48, v22
    v_mfma_f32_32x32x16_bf16 v[208:223], v[80:83], v[112:115], v[208:223]
    v_fma_f32 v197, v197, s48, v22
    v_exp_f32 v194, v194
    v_exp_f32 v195, v195
    v_fma_f32 v198, v198, s48, v22
    v_mfma_f32_32x32x16_bf16 v[208:223], v[84:87], v[116:119], v[208:223]
    v_fma_f32 v199, v199, s48, v22
    v_add_f32 v24, v24, v192
    v_add_f32 v25, v25, v193
    v_cvt_pk_bf16_f32 v224, v192, v193
    v_mfma_f32_32x32x16_bf16 v[208:223], v[88:91], v[120:123], v[208:223]
    v_exp_f32 v196, v196
    v_exp_f32 v197, v197
    v_fma_f32 v200, v200, s48, v22
    v_fma_f32 v201, v201, s48, v22
    v_mfma_f32_32x32x16_bf16 v[208:223], v[92:95], v[124:127], v[208:223]
    v_add_f32 v24, v24, v194
    v_add_f32 v25, v25, v195
    v_cvt_pk_bf16_f32 v225, v194, v195
    v_exp_f32 v198, v198
    v_exp_f32 v199, v199
    v_mfma_f32_32x32x16_bf16 v[128:143], v[32:35], v[244:247], v[128:143]
    ds_read_b64_tr_b16 v[32:33], v240 offset:32768
    ds_read_b64_tr_b16 v[34:35], v240 offset:34816
    ds_read_b128 v[64:67], v232 offset:40960
    v_fma_f32 v202, v202, s48, v22
    v_fma_f32 v203, v203, s48, v22
    v_add_f32 v24, v24, v196
    v_add_f32 v25, v25, v197
    v_mfma_f32_32x32x16_bf16 v[128:143], v[36:39], v[248:251], v[128:143]
    ds_read_b64_tr_b16 v[36:37], v240 offset:36864
    ds_read_b64_tr_b16 v[38:39], v240 offset:38912
    ds_read_b128 v[68:71], v233 offset:40960
    v_cvt_pk_bf16_f32 v226, v196, v197
    v_exp_f32 v200, v200
    v_exp_f32 v201, v201
    v_fma_f32 v204, v204, s48, v22
    v_mfma_f32_32x32x16_bf16 v[144:159], v[40:43], v[244:247], v[144:159]
    ds_read_b64_tr_b16 v[40:41], v241 offset:32768
    ds_read_b64_tr_b16 v[42:43], v241 offset:34816
    ds_read_b128 v[72:75], v234 offset:40960
    v_fma_f32 v205, v205, s48, v22
    v_add_f32 v24, v24, v198
    v_add_f32 v25, v25, v199
    v_cvt_pk_bf16_f32 v227, v198, v199
    v_mfma_f32_32x32x16_bf16 v[144:159], v[44:47], v[248:251], v[144:159]
    ds_read_b64_tr_b16 v[44:45], v241 offset:36864
    ds_read_b64_tr_b16 v[46:47], v241 offset:38912
    ds_read_b128 v[76:79], v235 offset:40960
    v_exp_f32 v202, v202
    v_exp_f32 v203, v203
    v_fma_f32 v206, v206, s48, v22
    v_fma_f32 v207, v207, s48, v22
    v_mfma_f32_32x32x16_bf16 v[160:175], v[48:51], v[244:247], v[160:175]
    ds_read_b64_tr_b16 v[48:49], v242 offset:32768
    ds_read_b64_tr_b16 v[50:51], v242 offset:34816
    ds_read_b128 v[80:83], v236 offset:40960
    v_add_f32 v24, v24, v200
    v_add_f32 v25, v25, v201
    v_cvt_pk_bf16_f32 v228, v200, v201
    v_exp_f32 v204, v204
    v_mfma_f32_32x32x16_bf16 v[160:175], v[52:55], v[248:251], v[160:175]
    ds_read_b64_tr_b16 v[52:53], v242 offset:36864
    ds_read_b64_tr_b16 v[54:55], v242 offset:38912
    ds_read_b128 v[84:87], v237 offset:40960
    v_exp_f32 v205, v205
    v_add_f32 v24, v24, v202
    v_add_f32 v25, v25, v203
    v_cvt_pk_bf16_f32 v229, v202, v203
    v_mfma_f32_32x32x16_bf16 v[176:191], v[56:59], v[244:247], v[176:191]
    ds_read_b64_tr_b16 v[56:57], v243 offset:32768
    ds_read_b64_tr_b16 v[58:59], v243 offset:34816
    ds_read_b128 v[88:91], v238 offset:40960
    v_exp_f32 v206, v206
    v_exp_f32 v207, v207
    v_add_f32 v24, v24, v204
    v_add_f32 v25, v25, v205
    v_mfma_f32_32x32x16_bf16 v[176:191], v[60:63], v[248:251], v[176:191]
    ds_read_b64_tr_b16 v[60:61], v243 offset:36864
    ds_read_b64_tr_b16 v[62:63], v243 offset:38912
    ds_read_b128 v[92:95], v239 offset:40960
    v_cvt_pk_bf16_f32 v230, v204, v205
    s_nop 0
    v_add_f32 v24, v24, v206
    v_add_f32 v25, v25, v207
    v_cvt_pk_bf16_f32 v231, v206, v207
    s_cmp_lg_u32 s56, 0
    s_cbranch_scc1 concat_heads__gqa_block_cached__gqa_block_cached__near_ridge_kernel_resc8
concat_heads__gqa_block_cached__gqa_block_cached__near_ridge_kernel_rr8:
    s_waitcnt lgkmcnt(0)
    s_barrier
    v_mfma_f32_32x32x16_bf16 v[192:207], v[64:67], v[96:99], 0
    v_max3_f32 v11, v208, v209, v210
    v_max3_f32 v12, v211, v212, v213
    v_max3_f32 v13, v214, v215, v216
    v_max3_f32 v14, v217, v218, v219
    v_mfma_f32_32x32x16_bf16 v[192:207], v[68:71], v[100:103], v[192:207]
    v_max3_f32 v15, v220, v221, v222
    v_max3_f32 v11, v11, v12, v223
    v_max3_f32 v13, v13, v14, v15
    v_max_f32 v11, v11, v13
    v_mfma_f32_32x32x16_bf16 v[192:207], v[72:75], v[104:107], v[192:207]
    v_cmp_gt_f32 vcc, v11, v21
    s_cbranch_vccnz concat_heads__gqa_block_cached__gqa_block_cached__near_ridge_kernel_slow9
concat_heads__gqa_block_cached__gqa_block_cached__near_ridge_kernel_ret9:
    v_fma_f32 v208, v208, s48, v22
    v_fma_f32 v209, v209, s48, v22
    v_fma_f32 v210, v210, s48, v22
    v_mfma_f32_32x32x16_bf16 v[192:207], v[76:79], v[108:111], v[192:207]
    v_fma_f32 v211, v211, s48, v22
    v_exp_f32 v208, v208
    v_exp_f32 v209, v209
    v_fma_f32 v212, v212, s48, v22
    v_mfma_f32_32x32x16_bf16 v[192:207], v[80:83], v[112:115], v[192:207]
    v_fma_f32 v213, v213, s48, v22
    v_exp_f32 v210, v210
    v_exp_f32 v211, v211
    v_fma_f32 v214, v214, s48, v22
    v_mfma_f32_32x32x16_bf16 v[192:207], v[84:87], v[116:119], v[192:207]
    v_fma_f32 v215, v215, s48, v22
    v_add_f32 v24, v24, v208
    v_add_f32 v25, v25, v209
    v_cvt_pk_bf16_f32 v244, v208, v209
    v_mfma_f32_32x32x16_bf16 v[192:207], v[88:91], v[120:123], v[192:207]
    v_exp_f32 v212, v212
    v_exp_f32 v213, v213
    v_fma_f32 v216, v216, s48, v22
    v_fma_f32 v217, v217, s48, v22
    v_mfma_f32_32x32x16_bf16 v[192:207], v[92:95], v[124:127], v[192:207]
    v_add_f32 v24, v24, v210
    v_add_f32 v25, v25, v211
    v_cvt_pk_bf16_f32 v245, v210, v211
    v_exp_f32 v214, v214
    v_exp_f32 v215, v215
    v_mfma_f32_32x32x16_bf16 v[128:143], v[32:35], v[224:227], v[128:143]
    ds_read_b64_tr_b16 v[32:33], v240 offset:40960
    ds_read_b64_tr_b16 v[34:35], v240 offset:43008
    ds_read_b128 v[64:67], v232 offset:57344
    v_fma_f32 v218, v218, s48, v22
    v_fma_f32 v219, v219, s48, v22
    v_add_f32 v24, v24, v212
    v_add_f32 v25, v25, v213
    v_mfma_f32_32x32x16_bf16 v[128:143], v[36:39], v[228:231], v[128:143]
    ds_read_b64_tr_b16 v[36:37], v240 offset:45056
    ds_read_b64_tr_b16 v[38:39], v240 offset:47104
    ds_read_b128 v[68:71], v233 offset:57344
    v_cvt_pk_bf16_f32 v246, v212, v213
    v_exp_f32 v216, v216
    v_exp_f32 v217, v217
    v_fma_f32 v220, v220, s48, v22
    v_mfma_f32_32x32x16_bf16 v[144:159], v[40:43], v[224:227], v[144:159]
    ds_read_b64_tr_b16 v[40:41], v241 offset:40960
    ds_read_b64_tr_b16 v[42:43], v241 offset:43008
    ds_read_b128 v[72:75], v234 offset:57344
    v_fma_f32 v221, v221, s48, v22
    v_add_f32 v24, v24, v214
    v_add_f32 v25, v25, v215
    v_cvt_pk_bf16_f32 v247, v214, v215
    v_mfma_f32_32x32x16_bf16 v[144:159], v[44:47], v[228:231], v[144:159]
    ds_read_b64_tr_b16 v[44:45], v241 offset:45056
    ds_read_b64_tr_b16 v[46:47], v241 offset:47104
    ds_read_b128 v[76:79], v235 offset:57344
    v_exp_f32 v218, v218
    v_exp_f32 v219, v219
    v_fma_f32 v222, v222, s48, v22
    v_fma_f32 v223, v223, s48, v22
    v_mfma_f32_32x32x16_bf16 v[160:175], v[48:51], v[224:227], v[160:175]
    ds_read_b64_tr_b16 v[48:49], v242 offset:40960
    ds_read_b64_tr_b16 v[50:51], v242 offset:43008
    ds_read_b128 v[80:83], v236 offset:57344
    v_add_f32 v24, v24, v216
    v_add_f32 v25, v25, v217
    v_cvt_pk_bf16_f32 v248, v216, v217
    v_exp_f32 v220, v220
    v_mfma_f32_32x32x16_bf16 v[160:175], v[52:55], v[228:231], v[160:175]
    ds_read_b64_tr_b16 v[52:53], v242 offset:45056
    ds_read_b64_tr_b16 v[54:55], v242 offset:47104
    ds_read_b128 v[84:87], v237 offset:57344
    v_exp_f32 v221, v221
    v_add_f32 v24, v24, v218
    v_add_f32 v25, v25, v219
    v_cvt_pk_bf16_f32 v249, v218, v219
    v_mfma_f32_32x32x16_bf16 v[176:191], v[56:59], v[224:227], v[176:191]
    ds_read_b64_tr_b16 v[56:57], v243 offset:40960
    ds_read_b64_tr_b16 v[58:59], v243 offset:43008
    ds_read_b128 v[88:91], v238 offset:57344
    v_exp_f32 v222, v222
    v_exp_f32 v223, v223
    v_add_f32 v24, v24, v220
    v_add_f32 v25, v25, v221
    v_mfma_f32_32x32x16_bf16 v[176:191], v[60:63], v[228:231], v[176:191]
    ds_read_b64_tr_b16 v[60:61], v243 offset:45056
    ds_read_b64_tr_b16 v[62:63], v243 offset:47104
    ds_read_b128 v[92:95], v239 offset:57344
    v_cvt_pk_bf16_f32 v250, v220, v221
    s_nop 0
    v_add_f32 v24, v24, v222
    v_add_f32 v25, v25, v223
    v_cvt_pk_bf16_f32 v251, v222, v223
    s_cmp_lg_u32 s56, 0
    s_cbranch_scc1 concat_heads__gqa_block_cached__gqa_block_cached__near_ridge_kernel_resc9
concat_heads__gqa_block_cached__gqa_block_cached__near_ridge_kernel_rr9:
    s_waitcnt lgkmcnt(0)
    s_barrier
    v_mfma_f32_32x32x16_bf16 v[208:223], v[64:67], v[96:99], 0
    v_max3_f32 v11, v192, v193, v194
    v_max3_f32 v12, v195, v196, v197
    v_max3_f32 v13, v198, v199, v200
    v_max3_f32 v14, v201, v202, v203
    v_mfma_f32_32x32x16_bf16 v[208:223], v[68:71], v[100:103], v[208:223]
    v_max3_f32 v15, v204, v205, v206
    v_max3_f32 v11, v11, v12, v207
    v_max3_f32 v13, v13, v14, v15
    v_max_f32 v11, v11, v13
    v_mfma_f32_32x32x16_bf16 v[208:223], v[72:75], v[104:107], v[208:223]
    v_cmp_gt_f32 vcc, v11, v21
    s_cbranch_vccnz concat_heads__gqa_block_cached__gqa_block_cached__near_ridge_kernel_slow10
concat_heads__gqa_block_cached__gqa_block_cached__near_ridge_kernel_ret10:
    v_fma_f32 v192, v192, s48, v22
    v_fma_f32 v193, v193, s48, v22
    v_fma_f32 v194, v194, s48, v22
    v_mfma_f32_32x32x16_bf16 v[208:223], v[76:79], v[108:111], v[208:223]
    v_fma_f32 v195, v195, s48, v22
    v_exp_f32 v192, v192
    v_exp_f32 v193, v193
    v_fma_f32 v196, v196, s48, v22
    v_mfma_f32_32x32x16_bf16 v[208:223], v[80:83], v[112:115], v[208:223]
    v_fma_f32 v197, v197, s48, v22
    v_exp_f32 v194, v194
    v_exp_f32 v195, v195
    v_fma_f32 v198, v198, s48, v22
    v_mfma_f32_32x32x16_bf16 v[208:223], v[84:87], v[116:119], v[208:223]
    v_fma_f32 v199, v199, s48, v22
    v_add_f32 v24, v24, v192
    v_add_f32 v25, v25, v193
    v_cvt_pk_bf16_f32 v224, v192, v193
    v_mfma_f32_32x32x16_bf16 v[208:223], v[88:91], v[120:123], v[208:223]
    v_exp_f32 v196, v196
    v_exp_f32 v197, v197
    v_fma_f32 v200, v200, s48, v22
    v_fma_f32 v201, v201, s48, v22
    v_mfma_f32_32x32x16_bf16 v[208:223], v[92:95], v[124:127], v[208:223]
    v_add_f32 v24, v24, v194
    v_add_f32 v25, v25, v195
    v_cvt_pk_bf16_f32 v225, v194, v195
    v_exp_f32 v198, v198
    v_exp_f32 v199, v199
    v_mfma_f32_32x32x16_bf16 v[128:143], v[32:35], v[244:247], v[128:143]
    ds_read_b64_tr_b16 v[32:33], v240 offset:57344
    ds_read_b64_tr_b16 v[34:35], v240 offset:59392
    ds_read_b128 v[64:67], v232 offset:0
    v_fma_f32 v202, v202, s48, v22
    v_fma_f32 v203, v203, s48, v22
    v_add_f32 v24, v24, v196
    v_add_f32 v25, v25, v197
    v_mfma_f32_32x32x16_bf16 v[128:143], v[36:39], v[248:251], v[128:143]
    ds_read_b64_tr_b16 v[36:37], v240 offset:61440
    ds_read_b64_tr_b16 v[38:39], v240 offset:63488
    ds_read_b128 v[68:71], v233 offset:0
    v_cvt_pk_bf16_f32 v226, v196, v197
    v_exp_f32 v200, v200
    v_exp_f32 v201, v201
    v_fma_f32 v204, v204, s48, v22
    v_mfma_f32_32x32x16_bf16 v[144:159], v[40:43], v[244:247], v[144:159]
    ds_read_b64_tr_b16 v[40:41], v241 offset:57344
    ds_read_b64_tr_b16 v[42:43], v241 offset:59392
    ds_read_b128 v[72:75], v234 offset:0
    v_fma_f32 v205, v205, s48, v22
    v_add_f32 v24, v24, v198
    v_add_f32 v25, v25, v199
    v_cvt_pk_bf16_f32 v227, v198, v199
    v_mfma_f32_32x32x16_bf16 v[144:159], v[44:47], v[248:251], v[144:159]
    ds_read_b64_tr_b16 v[44:45], v241 offset:61440
    ds_read_b64_tr_b16 v[46:47], v241 offset:63488
    ds_read_b128 v[76:79], v235 offset:0
    v_exp_f32 v202, v202
    v_exp_f32 v203, v203
    v_fma_f32 v206, v206, s48, v22
    v_fma_f32 v207, v207, s48, v22
    v_mfma_f32_32x32x16_bf16 v[160:175], v[48:51], v[244:247], v[160:175]
    ds_read_b64_tr_b16 v[48:49], v242 offset:57344
    ds_read_b64_tr_b16 v[50:51], v242 offset:59392
    ds_read_b128 v[80:83], v236 offset:0
    v_add_f32 v24, v24, v200
    v_add_f32 v25, v25, v201
    v_cvt_pk_bf16_f32 v228, v200, v201
    v_exp_f32 v204, v204
    v_mfma_f32_32x32x16_bf16 v[160:175], v[52:55], v[248:251], v[160:175]
    ds_read_b64_tr_b16 v[52:53], v242 offset:61440
    ds_read_b64_tr_b16 v[54:55], v242 offset:63488
    ds_read_b128 v[84:87], v237 offset:0
    v_exp_f32 v205, v205
    v_add_f32 v24, v24, v202
    v_add_f32 v25, v25, v203
    v_cvt_pk_bf16_f32 v229, v202, v203
    v_mfma_f32_32x32x16_bf16 v[176:191], v[56:59], v[244:247], v[176:191]
    ds_read_b64_tr_b16 v[56:57], v243 offset:57344
    ds_read_b64_tr_b16 v[58:59], v243 offset:59392
    ds_read_b128 v[88:91], v238 offset:0
    v_exp_f32 v206, v206
    v_exp_f32 v207, v207
    v_add_f32 v24, v24, v204
    v_add_f32 v25, v25, v205
    v_mfma_f32_32x32x16_bf16 v[176:191], v[60:63], v[248:251], v[176:191]
    ds_read_b64_tr_b16 v[60:61], v243 offset:61440
    ds_read_b64_tr_b16 v[62:63], v243 offset:63488
    ds_read_b128 v[92:95], v239 offset:0
    v_cvt_pk_bf16_f32 v230, v204, v205
    s_nop 0
    v_add_f32 v24, v24, v206
    v_add_f32 v25, v25, v207
    v_cvt_pk_bf16_f32 v231, v206, v207
    s_cmp_lg_u32 s56, 0
    s_cbranch_scc1 concat_heads__gqa_block_cached__gqa_block_cached__near_ridge_kernel_resc10
concat_heads__gqa_block_cached__gqa_block_cached__near_ridge_kernel_rr10:
    s_waitcnt lgkmcnt(0)
    s_barrier
    s_add_u32 m0, s54, 40960
    s_add_u32 s47, s92, 73728
    buffer_load_dwordx4 v26, s[72:75], s47 offen lds
    s_add_u32 m0, s54, 41984
    s_add_u32 s47, s92, 73728
    buffer_load_dwordx4 v27, s[72:75], s47 offen lds
    s_add_u32 s46, s94, 40960
    s_cmp_lt_u32 s45, 4
    s_cselect_b32 m0, s46, s57
    s_add_u32 s47, s93, 74240
    buffer_load_dwordx4 v28, s[72:75], s47 offen lds
    v_mfma_f32_32x32x16_bf16 v[192:207], v[64:67], v[96:99], 0
    v_max3_f32 v11, v208, v209, v210
    v_max3_f32 v12, v211, v212, v213
    v_max3_f32 v13, v214, v215, v216
    v_max3_f32 v14, v217, v218, v219
    v_mfma_f32_32x32x16_bf16 v[192:207], v[68:71], v[100:103], v[192:207]
    v_max3_f32 v15, v220, v221, v222
    v_max3_f32 v11, v11, v12, v223
    v_max3_f32 v13, v13, v14, v15
    v_max_f32 v11, v11, v13
    v_mfma_f32_32x32x16_bf16 v[192:207], v[72:75], v[104:107], v[192:207]
    v_cmp_gt_f32 vcc, v11, v21
    s_cbranch_vccnz concat_heads__gqa_block_cached__gqa_block_cached__near_ridge_kernel_slow11
concat_heads__gqa_block_cached__gqa_block_cached__near_ridge_kernel_ret11:
    v_fma_f32 v208, v208, s48, v22
    v_fma_f32 v209, v209, s48, v22
    v_fma_f32 v210, v210, s48, v22
    v_mfma_f32_32x32x16_bf16 v[192:207], v[76:79], v[108:111], v[192:207]
    v_fma_f32 v211, v211, s48, v22
    v_exp_f32 v208, v208
    v_exp_f32 v209, v209
    v_fma_f32 v212, v212, s48, v22
    v_mfma_f32_32x32x16_bf16 v[192:207], v[80:83], v[112:115], v[192:207]
    v_fma_f32 v213, v213, s48, v22
    v_exp_f32 v210, v210
    v_exp_f32 v211, v211
    v_fma_f32 v214, v214, s48, v22
    v_mfma_f32_32x32x16_bf16 v[192:207], v[84:87], v[116:119], v[192:207]
    v_fma_f32 v215, v215, s48, v22
    v_add_f32 v24, v24, v208
    v_add_f32 v25, v25, v209
    v_cvt_pk_bf16_f32 v244, v208, v209
    v_mfma_f32_32x32x16_bf16 v[192:207], v[88:91], v[120:123], v[192:207]
    v_exp_f32 v212, v212
    v_exp_f32 v213, v213
    v_fma_f32 v216, v216, s48, v22
    v_fma_f32 v217, v217, s48, v22
    v_mfma_f32_32x32x16_bf16 v[192:207], v[92:95], v[124:127], v[192:207]
    v_add_f32 v24, v24, v210
    v_add_f32 v25, v25, v211
    v_cvt_pk_bf16_f32 v245, v210, v211
    v_exp_f32 v214, v214
    v_exp_f32 v215, v215
    v_mfma_f32_32x32x16_bf16 v[128:143], v[32:35], v[224:227], v[128:143]
    ds_read_b64_tr_b16 v[32:33], v240 offset:0
    ds_read_b64_tr_b16 v[34:35], v240 offset:2048
    ds_read_b128 v[64:67], v232 offset:8192
    v_fma_f32 v218, v218, s48, v22
    v_fma_f32 v219, v219, s48, v22
    v_add_f32 v24, v24, v212
    v_add_f32 v25, v25, v213
    v_mfma_f32_32x32x16_bf16 v[128:143], v[36:39], v[228:231], v[128:143]
    ds_read_b64_tr_b16 v[36:37], v240 offset:4096
    ds_read_b64_tr_b16 v[38:39], v240 offset:6144
    ds_read_b128 v[68:71], v233 offset:8192
    v_cvt_pk_bf16_f32 v246, v212, v213
    v_exp_f32 v216, v216
    v_exp_f32 v217, v217
    v_fma_f32 v220, v220, s48, v22
    v_mfma_f32_32x32x16_bf16 v[144:159], v[40:43], v[224:227], v[144:159]
    ds_read_b64_tr_b16 v[40:41], v241 offset:0
    ds_read_b64_tr_b16 v[42:43], v241 offset:2048
    ds_read_b128 v[72:75], v234 offset:8192
    v_fma_f32 v221, v221, s48, v22
    v_add_f32 v24, v24, v214
    v_add_f32 v25, v25, v215
    v_cvt_pk_bf16_f32 v247, v214, v215
    v_mfma_f32_32x32x16_bf16 v[144:159], v[44:47], v[228:231], v[144:159]
    ds_read_b64_tr_b16 v[44:45], v241 offset:4096
    ds_read_b64_tr_b16 v[46:47], v241 offset:6144
    ds_read_b128 v[76:79], v235 offset:8192
    v_exp_f32 v218, v218
    v_exp_f32 v219, v219
    v_fma_f32 v222, v222, s48, v22
    v_fma_f32 v223, v223, s48, v22
    v_mfma_f32_32x32x16_bf16 v[160:175], v[48:51], v[224:227], v[160:175]
    ds_read_b64_tr_b16 v[48:49], v242 offset:0
    ds_read_b64_tr_b16 v[50:51], v242 offset:2048
    ds_read_b128 v[80:83], v236 offset:8192
    v_add_f32 v24, v24, v216
    v_add_f32 v25, v25, v217
    v_cvt_pk_bf16_f32 v248, v216, v217
    v_exp_f32 v220, v220
    v_mfma_f32_32x32x16_bf16 v[160:175], v[52:55], v[228:231], v[160:175]
    ds_read_b64_tr_b16 v[52:53], v242 offset:4096
    ds_read_b64_tr_b16 v[54:55], v242 offset:6144
    ds_read_b128 v[84:87], v237 offset:8192
    v_exp_f32 v221, v221
    v_add_f32 v24, v24, v218
    v_add_f32 v25, v25, v219
    v_cvt_pk_bf16_f32 v249, v218, v219
    v_mfma_f32_32x32x16_bf16 v[176:191], v[56:59], v[224:227], v[176:191]
    ds_read_b64_tr_b16 v[56:57], v243 offset:0
    ds_read_b64_tr_b16 v[58:59], v243 offset:2048
    ds_read_b128 v[88:91], v238 offset:8192
    v_exp_f32 v222, v222
    v_exp_f32 v223, v223
    v_add_f32 v24, v24, v220
    v_add_f32 v25, v25, v221
    v_mfma_f32_32x32x16_bf16 v[176:191], v[60:63], v[228:231], v[176:191]
    ds_read_b64_tr_b16 v[60:61], v243 offset:4096
    ds_read_b64_tr_b16 v[62:63], v243 offset:6144
    ds_read_b128 v[92:95], v239 offset:8192
    v_cvt_pk_bf16_f32 v250, v220, v221
    s_nop 0
    v_add_f32 v24, v24, v222
    v_add_f32 v25, v25, v223
    v_cvt_pk_bf16_f32 v251, v222, v223
    s_cmp_lg_u32 s56, 0
    s_cbranch_scc1 concat_heads__gqa_block_cached__gqa_block_cached__near_ridge_kernel_resc11
concat_heads__gqa_block_cached__gqa_block_cached__near_ridge_kernel_rr11:
    s_waitcnt lgkmcnt(0)
    s_barrier
    s_add_u32 s47, s95, 0
    buffer_load_dword v18, v19, s[72:75], s47 offen
    v_mfma_f32_32x32x16_bf16 v[208:223], v[64:67], v[96:99], 0
    v_max3_f32 v11, v192, v193, v194
    v_max3_f32 v12, v195, v196, v197
    v_max3_f32 v13, v198, v199, v200
    v_max3_f32 v14, v201, v202, v203
    v_mfma_f32_32x32x16_bf16 v[208:223], v[68:71], v[100:103], v[208:223]
    v_max3_f32 v15, v204, v205, v206
    v_max3_f32 v11, v11, v12, v207
    v_max3_f32 v13, v13, v14, v15
    v_max_f32 v11, v11, v13
    v_mfma_f32_32x32x16_bf16 v[208:223], v[72:75], v[104:107], v[208:223]
    v_cmp_gt_f32 vcc, v11, v21
    s_cbranch_vccnz concat_heads__gqa_block_cached__gqa_block_cached__near_ridge_kernel_slow12
concat_heads__gqa_block_cached__gqa_block_cached__near_ridge_kernel_ret12:
    v_fma_f32 v192, v192, s48, v22
    v_fma_f32 v193, v193, s48, v22
    v_fma_f32 v194, v194, s48, v22
    v_mfma_f32_32x32x16_bf16 v[208:223], v[76:79], v[108:111], v[208:223]
    v_fma_f32 v195, v195, s48, v22
    v_exp_f32 v192, v192
    v_exp_f32 v193, v193
    v_fma_f32 v196, v196, s48, v22
    v_mfma_f32_32x32x16_bf16 v[208:223], v[80:83], v[112:115], v[208:223]
    v_fma_f32 v197, v197, s48, v22
    v_exp_f32 v194, v194
    v_exp_f32 v195, v195
    v_fma_f32 v198, v198, s48, v22
    v_mfma_f32_32x32x16_bf16 v[208:223], v[84:87], v[116:119], v[208:223]
    v_fma_f32 v199, v199, s48, v22
    v_add_f32 v24, v24, v192
    v_add_f32 v25, v25, v193
    v_cvt_pk_bf16_f32 v224, v192, v193
    v_mfma_f32_32x32x16_bf16 v[208:223], v[88:91], v[120:123], v[208:223]
    v_exp_f32 v196, v196
    v_exp_f32 v197, v197
    v_fma_f32 v200, v200, s48, v22
    v_fma_f32 v201, v201, s48, v22
    v_mfma_f32_32x32x16_bf16 v[208:223], v[92:95], v[124:127], v[208:223]
    v_add_f32 v24, v24, v194
    v_add_f32 v25, v25, v195
    v_cvt_pk_bf16_f32 v225, v194, v195
    v_exp_f32 v198, v198
    v_exp_f32 v199, v199
    v_mfma_f32_32x32x16_bf16 v[128:143], v[32:35], v[244:247], v[128:143]
    ds_read_b64_tr_b16 v[32:33], v240 offset:16384
    ds_read_b64_tr_b16 v[34:35], v240 offset:18432
    ds_read_b128 v[64:67], v232 offset:16384
    v_fma_f32 v202, v202, s48, v22
    v_fma_f32 v203, v203, s48, v22
    v_add_f32 v24, v24, v196
    v_add_f32 v25, v25, v197
    v_mfma_f32_32x32x16_bf16 v[128:143], v[36:39], v[248:251], v[128:143]
    ds_read_b64_tr_b16 v[36:37], v240 offset:20480
    ds_read_b64_tr_b16 v[38:39], v240 offset:22528
    ds_read_b128 v[68:71], v233 offset:16384
    v_cvt_pk_bf16_f32 v226, v196, v197
    v_exp_f32 v200, v200
    v_exp_f32 v201, v201
    v_fma_f32 v204, v204, s48, v22
    v_mfma_f32_32x32x16_bf16 v[144:159], v[40:43], v[244:247], v[144:159]
    ds_read_b64_tr_b16 v[40:41], v241 offset:16384
    ds_read_b64_tr_b16 v[42:43], v241 offset:18432
    ds_read_b128 v[72:75], v234 offset:16384
    v_fma_f32 v205, v205, s48, v22
    v_add_f32 v24, v24, v198
    v_add_f32 v25, v25, v199
    v_cvt_pk_bf16_f32 v227, v198, v199
    v_mfma_f32_32x32x16_bf16 v[144:159], v[44:47], v[248:251], v[144:159]
    ds_read_b64_tr_b16 v[44:45], v241 offset:20480
    ds_read_b64_tr_b16 v[46:47], v241 offset:22528
    ds_read_b128 v[76:79], v235 offset:16384
    v_exp_f32 v202, v202
    v_exp_f32 v203, v203
    v_fma_f32 v206, v206, s48, v22
    v_fma_f32 v207, v207, s48, v22
    v_mfma_f32_32x32x16_bf16 v[160:175], v[48:51], v[244:247], v[160:175]
    ds_read_b64_tr_b16 v[48:49], v242 offset:16384
    ds_read_b64_tr_b16 v[50:51], v242 offset:18432
    ds_read_b128 v[80:83], v236 offset:16384
    v_add_f32 v24, v24, v200
    v_add_f32 v25, v25, v201
    v_cvt_pk_bf16_f32 v228, v200, v201
    v_exp_f32 v204, v204
    v_mfma_f32_32x32x16_bf16 v[160:175], v[52:55], v[248:251], v[160:175]
    ds_read_b64_tr_b16 v[52:53], v242 offset:20480
    ds_read_b64_tr_b16 v[54:55], v242 offset:22528
    ds_read_b128 v[84:87], v237 offset:16384
    v_exp_f32 v205, v205
    v_add_f32 v24, v24, v202
    v_add_f32 v25, v25, v203
    v_cvt_pk_bf16_f32 v229, v202, v203
    v_mfma_f32_32x32x16_bf16 v[176:191], v[56:59], v[244:247], v[176:191]
    ds_read_b64_tr_b16 v[56:57], v243 offset:16384
    ds_read_b64_tr_b16 v[58:59], v243 offset:18432
    ds_read_b128 v[88:91], v238 offset:16384
    v_exp_f32 v206, v206
    v_exp_f32 v207, v207
    v_add_f32 v24, v24, v204
    v_add_f32 v25, v25, v205
    v_mfma_f32_32x32x16_bf16 v[176:191], v[60:63], v[248:251], v[176:191]
    ds_read_b64_tr_b16 v[60:61], v243 offset:20480
    ds_read_b64_tr_b16 v[62:63], v243 offset:22528
    ds_read_b128 v[92:95], v239 offset:16384
    v_cvt_pk_bf16_f32 v230, v204, v205
    s_nop 0
    v_add_f32 v24, v24, v206
    v_add_f32 v25, v25, v207
    v_cvt_pk_bf16_f32 v231, v206, v207
    s_cmp_lg_u32 s56, 0
    s_cbranch_scc1 concat_heads__gqa_block_cached__gqa_block_cached__near_ridge_kernel_resc12
concat_heads__gqa_block_cached__gqa_block_cached__near_ridge_kernel_rr12:
    s_waitcnt lgkmcnt(0)
    s_barrier
    s_add_u32 m0, s54, 61440
    s_add_u32 s47, s92, 110592
    buffer_load_dwordx4 v26, s[72:75], s47 offen lds
    s_add_u32 m0, s54, 62464
    s_add_u32 s47, s92, 110592
    buffer_load_dwordx4 v27, s[72:75], s47 offen lds
    s_add_u32 s46, s94, 61440
    s_cmp_lt_u32 s45, 4
    s_cselect_b32 m0, s46, s57
    s_add_u32 s47, s93, 111104
    buffer_load_dwordx4 v28, s[72:75], s47 offen lds
    v_mfma_f32_32x32x16_bf16 v[192:207], v[64:67], v[96:99], 0
    v_max3_f32 v11, v208, v209, v210
    v_max3_f32 v12, v211, v212, v213
    v_max3_f32 v13, v214, v215, v216
    v_max3_f32 v14, v217, v218, v219
    v_mfma_f32_32x32x16_bf16 v[192:207], v[68:71], v[100:103], v[192:207]
    v_max3_f32 v15, v220, v221, v222
    v_max3_f32 v11, v11, v12, v223
    v_max3_f32 v13, v13, v14, v15
    v_max_f32 v11, v11, v13
    v_mfma_f32_32x32x16_bf16 v[192:207], v[72:75], v[104:107], v[192:207]
    v_cmp_gt_f32 vcc, v11, v21
    s_cbranch_vccnz concat_heads__gqa_block_cached__gqa_block_cached__near_ridge_kernel_slow13
concat_heads__gqa_block_cached__gqa_block_cached__near_ridge_kernel_ret13:
    v_fma_f32 v208, v208, s48, v22
    v_fma_f32 v209, v209, s48, v22
    v_fma_f32 v210, v210, s48, v22
    v_mfma_f32_32x32x16_bf16 v[192:207], v[76:79], v[108:111], v[192:207]
    v_fma_f32 v211, v211, s48, v22
    v_exp_f32 v208, v208
    v_exp_f32 v209, v209
    v_fma_f32 v212, v212, s48, v22
    v_mfma_f32_32x32x16_bf16 v[192:207], v[80:83], v[112:115], v[192:207]
    v_fma_f32 v213, v213, s48, v22
    v_exp_f32 v210, v210
    v_exp_f32 v211, v211
    v_fma_f32 v214, v214, s48, v22
    v_mfma_f32_32x32x16_bf16 v[192:207], v[84:87], v[116:119], v[192:207]
    v_fma_f32 v215, v215, s48, v22
    v_add_f32 v24, v24, v208
    v_add_f32 v25, v25, v209
    v_cvt_pk_bf16_f32 v244, v208, v209
    v_mfma_f32_32x32x16_bf16 v[192:207], v[88:91], v[120:123], v[192:207]
    v_exp_f32 v212, v212
    v_exp_f32 v213, v213
    v_fma_f32 v216, v216, s48, v22
    v_fma_f32 v217, v217, s48, v22
    v_mfma_f32_32x32x16_bf16 v[192:207], v[92:95], v[124:127], v[192:207]
    v_add_f32 v24, v24, v210
    v_add_f32 v25, v25, v211
    v_cvt_pk_bf16_f32 v245, v210, v211
    v_exp_f32 v214, v214
    v_exp_f32 v215, v215
    v_mfma_f32_32x32x16_bf16 v[128:143], v[32:35], v[224:227], v[128:143]
    ds_read_b64_tr_b16 v[32:33], v240 offset:32768
    ds_read_b64_tr_b16 v[34:35], v240 offset:34816
    ds_read_b128 v[64:67], v232 offset:24576
    v_fma_f32 v218, v218, s48, v22
    v_fma_f32 v219, v219, s48, v22
    v_add_f32 v24, v24, v212
    v_add_f32 v25, v25, v213
    v_mfma_f32_32x32x16_bf16 v[128:143], v[36:39], v[228:231], v[128:143]
    ds_read_b64_tr_b16 v[36:37], v240 offset:36864
    ds_read_b64_tr_b16 v[38:39], v240 offset:38912
    ds_read_b128 v[68:71], v233 offset:24576
    v_cvt_pk_bf16_f32 v246, v212, v213
    v_exp_f32 v216, v216
    v_exp_f32 v217, v217
    v_fma_f32 v220, v220, s48, v22
    v_mfma_f32_32x32x16_bf16 v[144:159], v[40:43], v[224:227], v[144:159]
    ds_read_b64_tr_b16 v[40:41], v241 offset:32768
    ds_read_b64_tr_b16 v[42:43], v241 offset:34816
    ds_read_b128 v[72:75], v234 offset:24576
    v_fma_f32 v221, v221, s48, v22
    v_add_f32 v24, v24, v214
    v_add_f32 v25, v25, v215
    v_cvt_pk_bf16_f32 v247, v214, v215
    v_mfma_f32_32x32x16_bf16 v[144:159], v[44:47], v[228:231], v[144:159]
    ds_read_b64_tr_b16 v[44:45], v241 offset:36864
    ds_read_b64_tr_b16 v[46:47], v241 offset:38912
    ds_read_b128 v[76:79], v235 offset:24576
    v_exp_f32 v218, v218
    v_exp_f32 v219, v219
    v_fma_f32 v222, v222, s48, v22
    v_fma_f32 v223, v223, s48, v22
    v_mfma_f32_32x32x16_bf16 v[160:175], v[48:51], v[224:227], v[160:175]
    ds_read_b64_tr_b16 v[48:49], v242 offset:32768
    ds_read_b64_tr_b16 v[50:51], v242 offset:34816
    ds_read_b128 v[80:83], v236 offset:24576
    v_add_f32 v24, v24, v216
    v_add_f32 v25, v25, v217
    v_cvt_pk_bf16_f32 v248, v216, v217
    v_exp_f32 v220, v220
    v_mfma_f32_32x32x16_bf16 v[160:175], v[52:55], v[228:231], v[160:175]
    ds_read_b64_tr_b16 v[52:53], v242 offset:36864
    ds_read_b64_tr_b16 v[54:55], v242 offset:38912
    ds_read_b128 v[84:87], v237 offset:24576
    v_exp_f32 v221, v221
    v_add_f32 v24, v24, v218
    v_add_f32 v25, v25, v219
    v_cvt_pk_bf16_f32 v249, v218, v219
    v_mfma_f32_32x32x16_bf16 v[176:191], v[56:59], v[224:227], v[176:191]
    ds_read_b64_tr_b16 v[56:57], v243 offset:32768
    ds_read_b64_tr_b16 v[58:59], v243 offset:34816
    ds_read_b128 v[88:91], v238 offset:24576
    v_exp_f32 v222, v222
    v_exp_f32 v223, v223
    v_add_f32 v24, v24, v220
    v_add_f32 v25, v25, v221
    v_mfma_f32_32x32x16_bf16 v[176:191], v[60:63], v[228:231], v[176:191]
    ds_read_b64_tr_b16 v[60:61], v243 offset:36864
    ds_read_b64_tr_b16 v[62:63], v243 offset:38912
    ds_read_b128 v[92:95], v239 offset:24576
    v_cvt_pk_bf16_f32 v250, v220, v221
    s_nop 0
    v_add_f32 v24, v24, v222
    v_add_f32 v25, v25, v223
    v_cvt_pk_bf16_f32 v251, v222, v223
    s_cmp_lg_u32 s56, 0
    s_cbranch_scc1 concat_heads__gqa_block_cached__gqa_block_cached__near_ridge_kernel_resc13
concat_heads__gqa_block_cached__gqa_block_cached__near_ridge_kernel_rr13:
    s_waitcnt lgkmcnt(0)
    s_barrier
    v_mfma_f32_32x32x16_bf16 v[208:223], v[64:67], v[96:99], 0
    v_max3_f32 v11, v192, v193, v194
    v_max3_f32 v12, v195, v196, v197
    v_max3_f32 v13, v198, v199, v200
    v_max3_f32 v14, v201, v202, v203
    v_mfma_f32_32x32x16_bf16 v[208:223], v[68:71], v[100:103], v[208:223]
    v_max3_f32 v15, v204, v205, v206
    v_max3_f32 v11, v11, v12, v207
    v_max3_f32 v13, v13, v14, v15
    v_max_f32 v11, v11, v13
    v_mfma_f32_32x32x16_bf16 v[208:223], v[72:75], v[104:107], v[208:223]
    v_cmp_gt_f32 vcc, v11, v21
    s_cbranch_vccnz concat_heads__gqa_block_cached__gqa_block_cached__near_ridge_kernel_slow14
concat_heads__gqa_block_cached__gqa_block_cached__near_ridge_kernel_ret14:
    v_fma_f32 v192, v192, s48, v22
    v_fma_f32 v193, v193, s48, v22
    v_fma_f32 v194, v194, s48, v22
    v_mfma_f32_32x32x16_bf16 v[208:223], v[76:79], v[108:111], v[208:223]
    v_fma_f32 v195, v195, s48, v22
    v_exp_f32 v192, v192
    v_exp_f32 v193, v193
    v_fma_f32 v196, v196, s48, v22
    v_mfma_f32_32x32x16_bf16 v[208:223], v[80:83], v[112:115], v[208:223]
    v_fma_f32 v197, v197, s48, v22
    v_exp_f32 v194, v194
    v_exp_f32 v195, v195
    v_fma_f32 v198, v198, s48, v22
    v_mfma_f32_32x32x16_bf16 v[208:223], v[84:87], v[116:119], v[208:223]
    v_fma_f32 v199, v199, s48, v22
    v_add_f32 v24, v24, v192
    v_add_f32 v25, v25, v193
    v_cvt_pk_bf16_f32 v224, v192, v193
    v_mfma_f32_32x32x16_bf16 v[208:223], v[88:91], v[120:123], v[208:223]
    v_exp_f32 v196, v196
    v_exp_f32 v197, v197
    v_fma_f32 v200, v200, s48, v22
    v_fma_f32 v201, v201, s48, v22
    v_mfma_f32_32x32x16_bf16 v[208:223], v[92:95], v[124:127], v[208:223]
    v_add_f32 v24, v24, v194
    v_add_f32 v25, v25, v195
    v_cvt_pk_bf16_f32 v225, v194, v195
    v_exp_f32 v198, v198
    v_exp_f32 v199, v199
    v_mfma_f32_32x32x16_bf16 v[128:143], v[32:35], v[244:247], v[128:143]
    ds_read_b64_tr_b16 v[32:33], v240 offset:40960
    ds_read_b64_tr_b16 v[34:35], v240 offset:43008
    v_fma_f32 v202, v202, s48, v22
    v_fma_f32 v203, v203, s48, v22
    v_add_f32 v24, v24, v196
    v_add_f32 v25, v25, v197
    v_mfma_f32_32x32x16_bf16 v[128:143], v[36:39], v[248:251], v[128:143]
    ds_read_b64_tr_b16 v[36:37], v240 offset:45056
    ds_read_b64_tr_b16 v[38:39], v240 offset:47104
    v_cvt_pk_bf16_f32 v226, v196, v197
    v_exp_f32 v200, v200
    v_exp_f32 v201, v201
    v_fma_f32 v204, v204, s48, v22
    v_mfma_f32_32x32x16_bf16 v[144:159], v[40:43], v[244:247], v[144:159]
    ds_read_b64_tr_b16 v[40:41], v241 offset:40960
    ds_read_b64_tr_b16 v[42:43], v241 offset:43008
    v_fma_f32 v205, v205, s48, v22
    v_add_f32 v24, v24, v198
    v_add_f32 v25, v25, v199
    v_cvt_pk_bf16_f32 v227, v198, v199
    v_mfma_f32_32x32x16_bf16 v[144:159], v[44:47], v[248:251], v[144:159]
    ds_read_b64_tr_b16 v[44:45], v241 offset:45056
    ds_read_b64_tr_b16 v[46:47], v241 offset:47104
    v_exp_f32 v202, v202
    v_exp_f32 v203, v203
    v_fma_f32 v206, v206, s48, v22
    v_fma_f32 v207, v207, s48, v22
    v_mfma_f32_32x32x16_bf16 v[160:175], v[48:51], v[244:247], v[160:175]
    ds_read_b64_tr_b16 v[48:49], v242 offset:40960
    ds_read_b64_tr_b16 v[50:51], v242 offset:43008
    v_add_f32 v24, v24, v200
    v_add_f32 v25, v25, v201
    v_cvt_pk_bf16_f32 v228, v200, v201
    v_exp_f32 v204, v204
    v_mfma_f32_32x32x16_bf16 v[160:175], v[52:55], v[248:251], v[160:175]
    ds_read_b64_tr_b16 v[52:53], v242 offset:45056
    ds_read_b64_tr_b16 v[54:55], v242 offset:47104
    v_exp_f32 v205, v205
    v_add_f32 v24, v24, v202
    v_add_f32 v25, v25, v203
    v_cvt_pk_bf16_f32 v229, v202, v203
    v_mfma_f32_32x32x16_bf16 v[176:191], v[56:59], v[244:247], v[176:191]
    ds_read_b64_tr_b16 v[56:57], v243 offset:40960
    ds_read_b64_tr_b16 v[58:59], v243 offset:43008
    v_exp_f32 v206, v206
    v_exp_f32 v207, v207
    v_add_f32 v24, v24, v204
    v_add_f32 v25, v25, v205
    v_mfma_f32_32x32x16_bf16 v[176:191], v[60:63], v[248:251], v[176:191]
    ds_read_b64_tr_b16 v[60:61], v243 offset:45056
    ds_read_b64_tr_b16 v[62:63], v243 offset:47104
    v_cvt_pk_bf16_f32 v230, v204, v205
    s_nop 0
    v_add_f32 v24, v24, v206
    v_add_f32 v25, v25, v207
    v_cvt_pk_bf16_f32 v231, v206, v207
    s_cmp_lg_u32 s56, 0
    s_cbranch_scc1 concat_heads__gqa_block_cached__gqa_block_cached__near_ridge_kernel_resc14
concat_heads__gqa_block_cached__gqa_block_cached__near_ridge_kernel_rr14:
    s_waitcnt lgkmcnt(0)
    s_barrier
    v_mfma_f32_32x32x16_bf16 v[128:143], v[32:35], v[224:227], v[128:143]
    ds_read_b64_tr_b16 v[32:33], v240 offset:57344
    ds_read_b64_tr_b16 v[34:35], v240 offset:59392
    v_max3_f32 v11, v208, v209, v210
    v_max3_f32 v12, v211, v212, v213
    v_max3_f32 v13, v214, v215, v216
    v_max3_f32 v14, v217, v218, v219
    v_max3_f32 v15, v220, v221, v222
    v_max3_f32 v11, v11, v12, v223
    v_max3_f32 v13, v13, v14, v15
    v_max_f32 v11, v11, v13
    v_mfma_f32_32x32x16_bf16 v[128:143], v[36:39], v[228:231], v[128:143]
    ds_read_b64_tr_b16 v[36:37], v240 offset:61440
    ds_read_b64_tr_b16 v[38:39], v240 offset:63488
    v_cmp_gt_f32 vcc, v11, v21
    s_cbranch_vccnz concat_heads__gqa_block_cached__gqa_block_cached__near_ridge_kernel_slow15
concat_heads__gqa_block_cached__gqa_block_cached__near_ridge_kernel_ret15:
    v_fma_f32 v208, v208, s48, v22
    v_fma_f32 v209, v209, s48, v22
    v_fma_f32 v210, v210, s48, v22
    v_fma_f32 v211, v211, s48, v22
    v_exp_f32 v208, v208
    v_exp_f32 v209, v209
    v_fma_f32 v212, v212, s48, v22
    v_mfma_f32_32x32x16_bf16 v[144:159], v[40:43], v[224:227], v[144:159]
    ds_read_b64_tr_b16 v[40:41], v241 offset:57344
    ds_read_b64_tr_b16 v[42:43], v241 offset:59392
    v_fma_f32 v213, v213, s48, v22
    v_exp_f32 v210, v210
    v_exp_f32 v211, v211
    v_fma_f32 v214, v214, s48, v22
    v_fma_f32 v215, v215, s48, v22
    v_add_f32 v24, v24, v208
    v_add_f32 v25, v25, v209
    v_cvt_pk_bf16_f32 v244, v208, v209
    v_mfma_f32_32x32x16_bf16 v[144:159], v[44:47], v[228:231], v[144:159]
    ds_read_b64_tr_b16 v[44:45], v241 offset:61440
    ds_read_b64_tr_b16 v[46:47], v241 offset:63488
    v_exp_f32 v212, v212
    v_exp_f32 v213, v213
    v_fma_f32 v216, v216, s48, v22
    v_fma_f32 v217, v217, s48, v22
    v_add_f32 v24, v24, v210
    v_add_f32 v25, v25, v211
    v_cvt_pk_bf16_f32 v245, v210, v211
    v_exp_f32 v214, v214
    v_exp_f32 v215, v215
    v_mfma_f32_32x32x16_bf16 v[160:175], v[48:51], v[224:227], v[160:175]
    ds_read_b64_tr_b16 v[48:49], v242 offset:57344
    ds_read_b64_tr_b16 v[50:51], v242 offset:59392
    v_fma_f32 v218, v218, s48, v22
    v_fma_f32 v219, v219, s48, v22
    v_add_f32 v24, v24, v212
    v_add_f32 v25, v25, v213
    v_cvt_pk_bf16_f32 v246, v212, v213
    v_exp_f32 v216, v216
    v_exp_f32 v217, v217
    v_fma_f32 v220, v220, s48, v22
    v_mfma_f32_32x32x16_bf16 v[160:175], v[52:55], v[228:231], v[160:175]
    ds_read_b64_tr_b16 v[52:53], v242 offset:61440
    ds_read_b64_tr_b16 v[54:55], v242 offset:63488
    v_fma_f32 v221, v221, s48, v22
    v_add_f32 v24, v24, v214
    v_add_f32 v25, v25, v215
    v_cvt_pk_bf16_f32 v247, v214, v215
    v_exp_f32 v218, v218
    v_exp_f32 v219, v219
    v_fma_f32 v222, v222, s48, v22
    v_fma_f32 v223, v223, s48, v22
    v_mfma_f32_32x32x16_bf16 v[176:191], v[56:59], v[224:227], v[176:191]
    ds_read_b64_tr_b16 v[56:57], v243 offset:57344
    ds_read_b64_tr_b16 v[58:59], v243 offset:59392
    v_add_f32 v24, v24, v216
    v_add_f32 v25, v25, v217
    v_cvt_pk_bf16_f32 v248, v216, v217
    v_exp_f32 v220, v220
    v_exp_f32 v221, v221
    v_add_f32 v24, v24, v218
    v_add_f32 v25, v25, v219
    v_cvt_pk_bf16_f32 v249, v218, v219
    v_mfma_f32_32x32x16_bf16 v[176:191], v[60:63], v[228:231], v[176:191]
    ds_read_b64_tr_b16 v[60:61], v243 offset:61440
    ds_read_b64_tr_b16 v[62:63], v243 offset:63488
    v_exp_f32 v222, v222
    v_exp_f32 v223, v223
    v_add_f32 v24, v24, v220
    v_add_f32 v25, v25, v221
    v_cvt_pk_bf16_f32 v250, v220, v221
    s_nop 0
    v_add_f32 v24, v24, v222
    v_add_f32 v25, v25, v223
    v_cvt_pk_bf16_f32 v251, v222, v223
    s_cmp_lg_u32 s56, 0
    s_cbranch_scc1 concat_heads__gqa_block_cached__gqa_block_cached__near_ridge_kernel_resc15
concat_heads__gqa_block_cached__gqa_block_cached__near_ridge_kernel_rr15:
    s_waitcnt lgkmcnt(0)
    s_barrier
    v_mfma_f32_32x32x16_bf16 v[128:143], v[32:35], v[244:247], v[128:143]
    v_add_f32 v24, v24, v25
    v_mov_b32 v25, v24
    s_nop 1
    v_permlane32_swap_b32 v24, v25
    s_nop 1
    v_add_f32 v24, v24, v25
    v_rcp_f32 v24, v24
    v_mfma_f32_32x32x16_bf16 v[128:143], v[36:39], v[248:251], v[128:143]
    v_and_b32 v11, 31, v2
    s_lshl_b32 s46, s45, 5
    v_add_u32 v11, s46, v11
    v_lshlrev_b32 v11, 8, v11
    v_add_u32 v11, 92160, v11
    v_and_b32 v12, 15, v2
    v_lshrrev_b32 v13, 5, v2
    v_xor_b32 v12, v12, v13
    v_mov_b32 v25, v24
    v_mfma_f32_32x32x16_bf16 v[144:159], v[40:43], v[244:247], v[144:159]
    v_mfma_f32_32x32x16_bf16 v[144:159], v[44:47], v[248:251], v[144:159]
    v_pk_mul_f32 v[128:129], v[128:129], v[24:25]
    v_pk_mul_f32 v[130:131], v[130:131], v[24:25]
    v_pk_mul_f32 v[132:133], v[132:133], v[24:25]
    v_pk_mul_f32 v[134:135], v[134:135], v[24:25]
    v_xor_b32 v13, 0, v12
    v_lshl_add_u32 v13, v13, 4, v11
    v_cvt_pk_bf16_f32 v128, v128, v129
    v_cvt_pk_bf16_f32 v129, v130, v131
    v_cvt_pk_bf16_f32 v130, v132, v133
    v_cvt_pk_bf16_f32 v131, v134, v135
    s_nop 1
    v_permlane32_swap_b32 v128, v130
    v_permlane32_swap_b32 v129, v131
    s_nop 1
    ds_write_b128 v13, v[128:131]
    v_mfma_f32_32x32x16_bf16 v[160:175], v[48:51], v[244:247], v[160:175]
    v_pk_mul_f32 v[136:137], v[136:137], v[24:25]
    v_pk_mul_f32 v[138:139], v[138:139], v[24:25]
    v_pk_mul_f32 v[140:141], v[140:141], v[24:25]
    v_pk_mul_f32 v[142:143], v[142:143], v[24:25]
    v_xor_b32 v14, 2, v12
    v_lshl_add_u32 v14, v14, 4, v11
    v_cvt_pk_bf16_f32 v136, v136, v137
    v_cvt_pk_bf16_f32 v137, v138, v139
    v_cvt_pk_bf16_f32 v138, v140, v141
    v_cvt_pk_bf16_f32 v139, v142, v143
    s_nop 1
    v_permlane32_swap_b32 v136, v138
    v_permlane32_swap_b32 v137, v139
    s_nop 1
    ds_write_b128 v14, v[136:139]
    v_mfma_f32_32x32x16_bf16 v[160:175], v[52:55], v[248:251], v[160:175]
    v_pk_mul_f32 v[144:145], v[144:145], v[24:25]
    v_pk_mul_f32 v[146:147], v[146:147], v[24:25]
    v_pk_mul_f32 v[148:149], v[148:149], v[24:25]
    v_pk_mul_f32 v[150:151], v[150:151], v[24:25]
    v_xor_b32 v13, 4, v12
    v_lshl_add_u32 v13, v13, 4, v11
    v_cvt_pk_bf16_f32 v144, v144, v145
    v_cvt_pk_bf16_f32 v145, v146, v147
    v_cvt_pk_bf16_f32 v146, v148, v149
    v_cvt_pk_bf16_f32 v147, v150, v151
    s_nop 1
    v_permlane32_swap_b32 v144, v146
    v_permlane32_swap_b32 v145, v147
    s_nop 1
    ds_write_b128 v13, v[144:147]
    v_mfma_f32_32x32x16_bf16 v[176:191], v[56:59], v[244:247], v[176:191]
    v_pk_mul_f32 v[152:153], v[152:153], v[24:25]
    v_pk_mul_f32 v[154:155], v[154:155], v[24:25]
    v_pk_mul_f32 v[156:157], v[156:157], v[24:25]
    v_pk_mul_f32 v[158:159], v[158:159], v[24:25]
    v_xor_b32 v14, 6, v12
    v_lshl_add_u32 v14, v14, 4, v11
    v_cvt_pk_bf16_f32 v152, v152, v153
    v_cvt_pk_bf16_f32 v153, v154, v155
    v_cvt_pk_bf16_f32 v154, v156, v157
    v_cvt_pk_bf16_f32 v155, v158, v159
    s_nop 1
    v_permlane32_swap_b32 v152, v154
    v_permlane32_swap_b32 v153, v155
    s_nop 1
    ds_write_b128 v14, v[152:155]
    v_mfma_f32_32x32x16_bf16 v[176:191], v[60:63], v[248:251], v[176:191]
    v_pk_mul_f32 v[160:161], v[160:161], v[24:25]
    v_pk_mul_f32 v[162:163], v[162:163], v[24:25]
    v_pk_mul_f32 v[164:165], v[164:165], v[24:25]
    v_pk_mul_f32 v[166:167], v[166:167], v[24:25]
    v_xor_b32 v13, 8, v12
    v_lshl_add_u32 v13, v13, 4, v11
    v_cvt_pk_bf16_f32 v160, v160, v161
    v_cvt_pk_bf16_f32 v161, v162, v163
    v_cvt_pk_bf16_f32 v162, v164, v165
    v_cvt_pk_bf16_f32 v163, v166, v167
    s_nop 1
    v_permlane32_swap_b32 v160, v162
    v_permlane32_swap_b32 v161, v163
    s_nop 1
    ds_write_b128 v13, v[160:163]
    v_pk_mul_f32 v[168:169], v[168:169], v[24:25]
    v_pk_mul_f32 v[170:171], v[170:171], v[24:25]
    v_pk_mul_f32 v[172:173], v[172:173], v[24:25]
    v_pk_mul_f32 v[174:175], v[174:175], v[24:25]
    v_xor_b32 v14, 10, v12
    v_lshl_add_u32 v14, v14, 4, v11
    v_cvt_pk_bf16_f32 v168, v168, v169
    v_cvt_pk_bf16_f32 v169, v170, v171
    v_cvt_pk_bf16_f32 v170, v172, v173
    v_cvt_pk_bf16_f32 v171, v174, v175
    s_nop 1
    v_permlane32_swap_b32 v168, v170
    v_permlane32_swap_b32 v169, v171
    s_nop 1
    ds_write_b128 v14, v[168:171]
    v_pk_mul_f32 v[176:177], v[176:177], v[24:25]
    v_pk_mul_f32 v[178:179], v[178:179], v[24:25]
    v_pk_mul_f32 v[180:181], v[180:181], v[24:25]
    v_pk_mul_f32 v[182:183], v[182:183], v[24:25]
    v_xor_b32 v13, 12, v12
    v_lshl_add_u32 v13, v13, 4, v11
    v_cvt_pk_bf16_f32 v176, v176, v177
    v_cvt_pk_bf16_f32 v177, v178, v179
    v_cvt_pk_bf16_f32 v178, v180, v181
    v_cvt_pk_bf16_f32 v179, v182, v183
    s_nop 1
    v_permlane32_swap_b32 v176, v178
    v_permlane32_swap_b32 v177, v179
    s_nop 1
    ds_write_b128 v13, v[176:179]
    v_pk_mul_f32 v[184:185], v[184:185], v[24:25]
    v_pk_mul_f32 v[186:187], v[186:187], v[24:25]
    v_pk_mul_f32 v[188:189], v[188:189], v[24:25]
    v_pk_mul_f32 v[190:191], v[190:191], v[24:25]
    v_xor_b32 v14, 14, v12
    v_lshl_add_u32 v14, v14, 4, v11
    v_cvt_pk_bf16_f32 v184, v184, v185
    v_cvt_pk_bf16_f32 v185, v186, v187
    v_cvt_pk_bf16_f32 v186, v188, v189
    v_cvt_pk_bf16_f32 v187, v190, v191
    s_nop 1
    v_permlane32_swap_b32 v184, v186
    v_permlane32_swap_b32 v185, v187
    s_nop 1
    ds_write_b128 v14, v[184:187]
concat_heads__gqa_block_cached__gqa_block_cached__near_ridge_kernel_p3:
    s_waitcnt vmcnt(0) lgkmcnt(0)
    s_barrier
    s_and_b32 s20, s44, 1
    s_xor_b32 s99, s44, 1
    s_mul_i32 s46, s20, 12288
    s_sub_u32 s21, 104448, s46
    s_add_u32 s22, s46, 92160
    s_mul_i32 s23, s20, 28672
    s_sub_u32 s23, s23, 20480
    s_mul_i32 s46, s20, 589824
    s_sub_u32 s24, 294912, s46
    s_sub_u32 s25, 0, s20
    v_lshlrev_b32 v11, 4, v2
    v_add_u32 v9, s52, v11
    v_add_u32 v10, s54, v11
    v_add_u32 v24, s22, v9
    ds_read_b128 v[80:83], v24 offset:0
    ds_read_b128 v[84:87], v24 offset:8192
    ds_read_b128 v[88:91], v24 offset:28672
    ds_read_b128 v[92:95], v24 offset:36864
    v_lshrrev_b32 v18, 4, v2
    v_and_b32 v12, 15, v2
    v_xor_b32 v13, v12, v18
    v_lshlrev_b32 v12, 8, v12
    v_add_u32 v12, s21, v12
    v_xor_b32 v14, 0, v13
    v_lshl_add_u32 v20, v14, 4, v12
    v_xor_b32 v14, 4, v13
    v_lshl_add_u32 v21, v14, 4, v12
    v_xor_b32 v14, 8, v13
    v_lshl_add_u32 v22, v14, 4, v12
    v_xor_b32 v14, 12, v13
    v_lshl_add_u32 v23, v14, 4, v12
    ds_read_b128 v[196:199], v20 offset:0
    ds_read_b128 v[200:203], v20 offset:4096
    ds_read_b128 v[204:207], v20 offset:8192
    ds_read_b128 v[208:211], v20 offset:12288
    v_bfe_u32 v12, v2, 2, 2
    v_and_b32 v13, 3, v2
    v_lshlrev_b32 v13, 3, v13
    v_lshl_add_u32 v14, v18, 3, v12
    v_and_b32 v15, 1, v18
    v_lshl_or_b32 v16, v15, 2, v12
    v_lshl_add_u32 v17, v14, 9, v13
    s_lshl_b32 s46, s45, 1
    s_add_u32 s47, s46, 0
    v_xor_b32 v11, s47, v16
    v_lshl_add_u32 v3, v11, 5, v17
    s_add_u32 s47, s46, 1
    v_xor_b32 v11, s47, v16
    v_lshl_add_u32 v4, v11, 5, v17
    v_lshrrev_b32 v16, 1, v12
    v_lshl_or_b32 v16, v15, 1, v16
    s_and_b32 s46, s45, 3
    v_xor_b32 v16, s46, v16
    v_lshl_add_u32 v17, v14, 7, v13
    v_lshl_add_u32 v5, v16, 5, v17
    v_add_u32 v5, 16384, v5
    s_cmp_eq_u32 s20, 0
    s_cselect_b32 s46, 0x7ff00000, 0
    s_cselect_b32 s47, 0, 0x7ff00000
    v_add_u32 v24, s46, v9
    v_add_u32 v25, s47, v9
    s_lshl_b32 s46, 1, s44
    v_mov_b32 v29, s46
    v_mov_b32 v31, 4
    s_cmp_eq_u32 s45, 0
    s_cselect_b32 s46, 4, 0x7ff00000
    v_mov_b32 v17, s46
    s_mul_i32 s26, s99, 133120
    s_lshl_b32 s27, s20, 14
    s_add_u32 s27, s27, s52
    s_lshr_b32 s28, s44, 1
    s_cmp_ge_u32 s44, 13
    s_cselect_b32 s29, s20, 0
    s_cmp_eq_u32 s29, 1
    s_cselect_b32 s28, 99, s28
    s_cmp_ge_u32 s45, 4
    s_cbranch_scc1 concat_heads__gqa_block_cached__gqa_block_cached__near_ridge_kernel_p3b
    ds_read_b64_tr_b16 v[172:173], v3 offset:0
    ds_read_b64_tr_b16 v[174:175], v3 offset:2048
    ds_read_b64_tr_b16 v[176:177], v4 offset:0
    ds_read_b64_tr_b16 v[178:179], v4 offset:2048
    ds_read_b64_tr_b16 v[180:181], v5 offset:0
    ds_read_b64_tr_b16 v[182:183], v5 offset:512
    s_waitcnt lgkmcnt(13)
    s_mov_b32 s46, 81920
    buffer_store_dwordx4 v[80:83], v9, s[36:39], s46 offen sc1
    s_waitcnt lgkmcnt(12)
    s_mov_b32 s46, 90112
    buffer_store_dwordx4 v[84:87], v9, s[36:39], s46 offen sc1
    s_waitcnt lgkmcnt(11)
    s_mov_b32 s46, 98304
    buffer_store_dwordx4 v[88:91], v9, s[36:39], s46 offen sc1
    s_waitcnt lgkmcnt(10)
    s_mov_b32 s46, 106496
    buffer_store_dwordx4 v[92:95], v9, s[36:39], s46 offen sc1
    s_waitcnt lgkmcnt(0)
    s_barrier
    v_mfma_f32_16x16x32_bf16 v[32:35], v[172:175], v[196:199], 0
    ds_read_b64_tr_b16 v[184:185], v3 offset:20480
    ds_read_b64_tr_b16 v[186:187], v3 offset:22528
    s_add_u32 m0, s54, 0
    s_add_u32 s47, s92, 147456
    buffer_load_dwordx4 v26, s[72:75], s47 offen lds
    v_mfma_f32_16x16x32_bf16 v[36:39], v[172:175], v[200:203], 0
    ds_read_b64_tr_b16 v[188:189], v4 offset:20480
    ds_read_b64_tr_b16 v[190:191], v4 offset:22528
    s_add_u32 m0, s54, 1024
    s_add_u32 s47, s92, 147456
    buffer_load_dwordx4 v27, s[72:75], s47 offen lds
    v_mfma_f32_16x16x32_bf16 v[40:43], v[172:175], v[204:207], 0
    ds_read_b64_tr_b16 v[192:193], v5 offset:20480
    ds_read_b64_tr_b16 v[194:195], v5 offset:20992
    s_add_u32 m0, s94, 0
    s_add_u32 s47, s93, 147968
    buffer_load_dwordx4 v28, s[72:75], s47 offen lds
    v_mfma_f32_16x16x32_bf16 v[44:47], v[172:175], v[208:211], 0
    ds_read_b128 v[224:227], v21 offset:0
    ds_read_b128 v[228:231], v21 offset:4096
    v_mfma_f32_16x16x32_bf16 v[48:51], v[176:179], v[196:199], 0
    ds_read_b128 v[232:235], v21 offset:8192
    ds_read_b128 v[236:239], v21 offset:12288
    v_mfma_f32_16x16x32_bf16 v[52:55], v[176:179], v[200:203], 0
    v_mfma_f32_16x16x32_bf16 v[56:59], v[176:179], v[204:207], 0
    v_mfma_f32_16x16x32_bf16 v[60:63], v[176:179], v[208:211], 0
    v_mfma_f32_16x16x32_bf16 v[64:67], v[180:183], v[196:199], 0
    v_mfma_f32_16x16x32_bf16 v[68:71], v[180:183], v[200:203], 0
    v_mfma_f32_16x16x32_bf16 v[72:75], v[180:183], v[204:207], 0
    v_mfma_f32_16x16x32_bf16 v[76:79], v[180:183], v[208:211], 0
    s_waitcnt lgkmcnt(0)
    s_barrier
    v_mfma_f32_16x16x32_bf16 v[32:35], v[184:187], v[224:227], v[32:35]
    ds_read_b64_tr_b16 v[172:173], v3 offset:40960
    ds_read_b64_tr_b16 v[174:175], v3 offset:43008
    s_add_u32 m0, s54, 20480
    s_add_u32 s47, s92, 184320
    buffer_load_dwordx4 v26, s[72:75], s47 offen lds
    v_mfma_f32_16x16x32_bf16 v[36:39], v[184:187], v[228:231], v[36:39]
    ds_read_b64_tr_b16 v[176:177], v4 offset:40960
    ds_read_b64_tr_b16 v[178:179], v4 offset:43008
    s_add_u32 m0, s54, 21504
    s_add_u32 s47, s92, 184320
    buffer_load_dwordx4 v27, s[72:75], s47 offen lds
    v_mfma_f32_16x16x32_bf16 v[40:43], v[184:187], v[232:235], v[40:43]
    ds_read_b64_tr_b16 v[180:181], v5 offset:40960
    ds_read_b64_tr_b16 v[182:183], v5 offset:41472
    s_add_u32 m0, s94, 20480
    s_add_u32 s47, s93, 184832
    buffer_load_dwordx4 v28, s[72:75], s47 offen lds
    v_mfma_f32_16x16x32_bf16 v[44:47], v[184:187], v[236:239], v[44:47]
    ds_read_b128 v[196:199], v22 offset:0
    ds_read_b128 v[200:203], v22 offset:4096
    v_mfma_f32_16x16x32_bf16 v[48:51], v[188:191], v[224:227], v[48:51]
    ds_read_b128 v[204:207], v22 offset:8192
    ds_read_b128 v[208:211], v22 offset:12288
    v_mfma_f32_16x16x32_bf16 v[52:55], v[188:191], v[228:231], v[52:55]
    v_mfma_f32_16x16x32_bf16 v[56:59], v[188:191], v[232:235], v[56:59]
    v_mfma_f32_16x16x32_bf16 v[60:63], v[188:191], v[236:239], v[60:63]
    v_mfma_f32_16x16x32_bf16 v[64:67], v[192:195], v[224:227], v[64:67]
    v_mfma_f32_16x16x32_bf16 v[68:71], v[192:195], v[228:231], v[68:71]
    v_mfma_f32_16x16x32_bf16 v[72:75], v[192:195], v[232:235], v[72:75]
    v_mfma_f32_16x16x32_bf16 v[76:79], v[192:195], v[236:239], v[76:79]
    s_waitcnt lgkmcnt(0)
    s_barrier
    v_mfma_f32_16x16x32_bf16 v[32:35], v[172:175], v[196:199], v[32:35]
    ds_read_b64_tr_b16 v[184:185], v3 offset:61440
    ds_read_b64_tr_b16 v[186:187], v3 offset:63488
    s_add_u32 m0, s54, 40960
    s_add_u32 s47, s92, 221184
    buffer_load_dwordx4 v26, s[72:75], s47 offen lds
    v_mfma_f32_16x16x32_bf16 v[36:39], v[172:175], v[200:203], v[36:39]
    ds_read_b64_tr_b16 v[188:189], v4 offset:61440
    ds_read_b64_tr_b16 v[190:191], v4 offset:63488
    s_add_u32 m0, s54, 41984
    s_add_u32 s47, s92, 221184
    buffer_load_dwordx4 v27, s[72:75], s47 offen lds
    v_mfma_f32_16x16x32_bf16 v[40:43], v[172:175], v[204:207], v[40:43]
    ds_read_b64_tr_b16 v[192:193], v5 offset:61440
    ds_read_b64_tr_b16 v[194:195], v5 offset:61952
    s_add_u32 m0, s94, 40960
    s_add_u32 s47, s93, 221696
    buffer_load_dwordx4 v28, s[72:75], s47 offen lds
    v_mfma_f32_16x16x32_bf16 v[44:47], v[172:175], v[208:211], v[44:47]
    ds_read_b128 v[224:227], v23 offset:0
    ds_read_b128 v[228:231], v23 offset:4096
    v_mfma_f32_16x16x32_bf16 v[48:51], v[176:179], v[196:199], v[48:51]
    ds_read_b128 v[232:235], v23 offset:8192
    ds_read_b128 v[236:239], v23 offset:12288
    v_mfma_f32_16x16x32_bf16 v[52:55], v[176:179], v[200:203], v[52:55]
    v_mfma_f32_16x16x32_bf16 v[56:59], v[176:179], v[204:207], v[56:59]
    v_mfma_f32_16x16x32_bf16 v[60:63], v[176:179], v[208:211], v[60:63]
    v_mfma_f32_16x16x32_bf16 v[64:67], v[180:183], v[196:199], v[64:67]
    v_mfma_f32_16x16x32_bf16 v[68:71], v[180:183], v[200:203], v[68:71]
    v_mfma_f32_16x16x32_bf16 v[72:75], v[180:183], v[204:207], v[72:75]
    v_mfma_f32_16x16x32_bf16 v[76:79], v[180:183], v[208:211], v[76:79]
    s_waitcnt vmcnt(6) lgkmcnt(0)
    s_barrier
    v_mov_b32 v16, v29
    s_mov_b64 exec, 1
    buffer_atomic_or v16, v17, s[84:87], 0 offen sc0 sc1
    s_mov_b64 exec, -1
    v_mfma_f32_16x16x32_bf16 v[32:35], v[184:187], v[224:227], v[32:35]
    ds_read_b64_tr_b16 v[172:173], v3 offset:0
    ds_read_b64_tr_b16 v[174:175], v3 offset:2048
    s_add_u32 m0, s54, 61440
    s_add_u32 s47, s92, 258048
    buffer_load_dwordx4 v26, s[72:75], s47 offen lds
    v_mfma_f32_16x16x32_bf16 v[36:39], v[184:187], v[228:231], v[36:39]
    ds_read_b64_tr_b16 v[176:177], v4 offset:0
    ds_read_b64_tr_b16 v[178:179], v4 offset:2048
    s_add_u32 m0, s54, 62464
    s_add_u32 s47, s92, 258048
    buffer_load_dwordx4 v27, s[72:75], s47 offen lds
    v_mfma_f32_16x16x32_bf16 v[40:43], v[184:187], v[232:235], v[40:43]
    ds_read_b64_tr_b16 v[180:181], v5 offset:0
    ds_read_b64_tr_b16 v[182:183], v5 offset:512
    s_add_u32 m0, s94, 61440
    s_add_u32 s47, s93, 258560
    buffer_load_dwordx4 v28, s[72:75], s47 offen lds
    v_mfma_f32_16x16x32_bf16 v[44:47], v[184:187], v[236:239], v[44:47]
    ds_read_b128 v[196:199], v20 offset:28672
    ds_read_b128 v[200:203], v20 offset:32768
    v_mfma_f32_16x16x32_bf16 v[48:51], v[188:191], v[224:227], v[48:51]
    ds_read_b128 v[204:207], v20 offset:36864
    ds_read_b128 v[208:211], v20 offset:40960
    v_mfma_f32_16x16x32_bf16 v[52:55], v[188:191], v[228:231], v[52:55]
    v_mfma_f32_16x16x32_bf16 v[56:59], v[188:191], v[232:235], v[56:59]
    v_mfma_f32_16x16x32_bf16 v[60:63], v[188:191], v[236:239], v[60:63]
    v_mfma_f32_16x16x32_bf16 v[64:67], v[192:195], v[224:227], v[64:67]
    v_mfma_f32_16x16x32_bf16 v[68:71], v[192:195], v[228:231], v[68:71]
    v_mfma_f32_16x16x32_bf16 v[72:75], v[192:195], v[232:235], v[72:75]
    v_mfma_f32_16x16x32_bf16 v[76:79], v[192:195], v[236:239], v[76:79]
    s_waitcnt vmcnt(7) lgkmcnt(0)
    s_barrier
    v_mfma_f32_16x16x32_bf16 v[32:35], v[172:175], v[196:199], v[32:35]
    ds_read_b64_tr_b16 v[184:185], v3 offset:20480
    ds_read_b64_tr_b16 v[186:187], v3 offset:22528
    s_add_u32 m0, s54, 0
    s_add_u32 s47, s92, 640
    buffer_load_dwordx4 v26, s[72:75], s47 offen lds
    v_mfma_f32_16x16x32_bf16 v[36:39], v[172:175], v[200:203], v[36:39]
    ds_read_b64_tr_b16 v[188:189], v4 offset:20480
    ds_read_b64_tr_b16 v[190:191], v4 offset:22528
    s_add_u32 m0, s54, 1024
    s_add_u32 s47, s92, 640
    buffer_load_dwordx4 v27, s[72:75], s47 offen lds
    v_mfma_f32_16x16x32_bf16 v[40:43], v[172:175], v[204:207], v[40:43]
    ds_read_b64_tr_b16 v[192:193], v5 offset:20480
    ds_read_b64_tr_b16 v[194:195], v5 offset:20992
    v_mfma_f32_16x16x32_bf16 v[44:47], v[172:175], v[208:211], v[44:47]
    ds_read_b128 v[224:227], v21 offset:28672
    ds_read_b128 v[228:231], v21 offset:32768
    v_mfma_f32_16x16x32_bf16 v[48:51], v[176:179], v[196:199], v[48:51]
    ds_read_b128 v[232:235], v21 offset:36864
    ds_read_b128 v[236:239], v21 offset:40960
    v_mfma_f32_16x16x32_bf16 v[52:55], v[176:179], v[200:203], v[52:55]
    v_mfma_f32_16x16x32_bf16 v[56:59], v[176:179], v[204:207], v[56:59]
    v_mfma_f32_16x16x32_bf16 v[60:63], v[176:179], v[208:211], v[60:63]
    v_mfma_f32_16x16x32_bf16 v[64:67], v[180:183], v[196:199], v[64:67]
    v_mfma_f32_16x16x32_bf16 v[68:71], v[180:183], v[200:203], v[68:71]
    v_mfma_f32_16x16x32_bf16 v[72:75], v[180:183], v[204:207], v[72:75]
    v_mfma_f32_16x16x32_bf16 v[76:79], v[180:183], v[208:211], v[76:79]
    s_waitcnt vmcnt(6) lgkmcnt(0)
    s_barrier
    v_mfma_f32_16x16x32_bf16 v[32:35], v[184:187], v[224:227], v[32:35]
    ds_read_b64_tr_b16 v[172:173], v3 offset:40960
    ds_read_b64_tr_b16 v[174:175], v3 offset:43008
    s_add_u32 m0, s54, 20480
    s_add_u32 s47, s92, 37504
    buffer_load_dwordx4 v26, s[72:75], s47 offen lds
    v_mfma_f32_16x16x32_bf16 v[36:39], v[184:187], v[228:231], v[36:39]
    ds_read_b64_tr_b16 v[176:177], v4 offset:40960
    ds_read_b64_tr_b16 v[178:179], v4 offset:43008
    s_add_u32 m0, s54, 21504
    s_add_u32 s47, s92, 37504
    buffer_load_dwordx4 v27, s[72:75], s47 offen lds
    v_mfma_f32_16x16x32_bf16 v[40:43], v[184:187], v[232:235], v[40:43]
    ds_read_b64_tr_b16 v[180:181], v5 offset:40960
    ds_read_b64_tr_b16 v[182:183], v5 offset:41472
    v_mfma_f32_16x16x32_bf16 v[44:47], v[184:187], v[236:239], v[44:47]
    ds_read_b128 v[196:199], v22 offset:28672
    ds_read_b128 v[200:203], v22 offset:32768
    v_mfma_f32_16x16x32_bf16 v[48:51], v[188:191], v[224:227], v[48:51]
    ds_read_b128 v[204:207], v22 offset:36864
    ds_read_b128 v[208:211], v22 offset:40960
    v_mfma_f32_16x16x32_bf16 v[52:55], v[188:191], v[228:231], v[52:55]
    v_mfma_f32_16x16x32_bf16 v[56:59], v[188:191], v[232:235], v[56:59]
    v_mfma_f32_16x16x32_bf16 v[60:63], v[188:191], v[236:239], v[60:63]
    v_mfma_f32_16x16x32_bf16 v[64:67], v[192:195], v[224:227], v[64:67]
    v_mfma_f32_16x16x32_bf16 v[68:71], v[192:195], v[228:231], v[68:71]
    v_mfma_f32_16x16x32_bf16 v[72:75], v[192:195], v[232:235], v[72:75]
    v_mfma_f32_16x16x32_bf16 v[76:79], v[192:195], v[236:239], v[76:79]
    s_waitcnt vmcnt(4) lgkmcnt(0)
    s_barrier
    v_mfma_f32_16x16x32_bf16 v[32:35], v[172:175], v[196:199], v[32:35]
    ds_read_b64_tr_b16 v[184:185], v3 offset:61440
    ds_read_b64_tr_b16 v[186:187], v3 offset:63488
    s_add_u32 m0, s54, 40960
    s_add_u32 s47, s92, 74368
    buffer_load_dwordx4 v26, s[72:75], s47 offen lds
    v_mfma_f32_16x16x32_bf16 v[36:39], v[172:175], v[200:203], v[36:39]
    ds_read_b64_tr_b16 v[188:189], v4 offset:61440
    ds_read_b64_tr_b16 v[190:191], v4 offset:63488
    s_add_u32 m0, s54, 41984
    s_add_u32 s47, s92, 74368
    buffer_load_dwordx4 v27, s[72:75], s47 offen lds
    v_mfma_f32_16x16x32_bf16 v[40:43], v[172:175], v[204:207], v[40:43]
    ds_read_b64_tr_b16 v[192:193], v5 offset:61440
    ds_read_b64_tr_b16 v[194:195], v5 offset:61952
    v_mfma_f32_16x16x32_bf16 v[44:47], v[172:175], v[208:211], v[44:47]
    ds_read_b128 v[224:227], v23 offset:28672
    ds_read_b128 v[228:231], v23 offset:32768
    v_mfma_f32_16x16x32_bf16 v[48:51], v[176:179], v[196:199], v[48:51]
    ds_read_b128 v[232:235], v23 offset:36864
    ds_read_b128 v[236:239], v23 offset:40960
    v_mfma_f32_16x16x32_bf16 v[52:55], v[176:179], v[200:203], v[52:55]
    v_mfma_f32_16x16x32_bf16 v[56:59], v[176:179], v[204:207], v[56:59]
    v_mfma_f32_16x16x32_bf16 v[60:63], v[176:179], v[208:211], v[60:63]
    v_mfma_f32_16x16x32_bf16 v[64:67], v[180:183], v[196:199], v[64:67]
    v_mfma_f32_16x16x32_bf16 v[68:71], v[180:183], v[200:203], v[68:71]
    v_mfma_f32_16x16x32_bf16 v[72:75], v[180:183], v[204:207], v[72:75]
    v_mfma_f32_16x16x32_bf16 v[76:79], v[180:183], v[208:211], v[76:79]
    s_waitcnt vmcnt(4) lgkmcnt(0)
    s_barrier
    v_readfirstlane_b32 s30, v16
    s_bitcmp1_b32 s30, s99
    s_cselect_b32 s46, 0x7ff00000, 0
    v_or_b32 v15, s46, v17
    v_mfma_f32_16x16x32_bf16 v[32:35], v[184:187], v[224:227], v[32:35]
    ds_read_b64_tr_b16 v[172:173], v3 offset:0
    ds_read_b64_tr_b16 v[174:175], v3 offset:2048
    s_add_u32 m0, s54, 61440
    s_add_u32 s47, s92, 111232
    buffer_load_dwordx4 v26, s[72:75], s47 offen lds
    v_mfma_f32_16x16x32_bf16 v[36:39], v[184:187], v[228:231], v[36:39]
    ds_read_b64_tr_b16 v[176:177], v4 offset:0
    ds_read_b64_tr_b16 v[178:179], v4 offset:2048
    s_add_u32 m0, s54, 62464
    s_add_u32 s47, s92, 111232
    buffer_load_dwordx4 v27, s[72:75], s47 offen lds
    buffer_load_dword v19, v15, s[84:87], 0 offen sc1
    v_mfma_f32_16x16x32_bf16 v[40:43], v[184:187], v[232:235], v[40:43]
    ds_read_b128 v[196:199], v20 offset:0
    ds_read_b128 v[200:203], v20 offset:4096
    v_mfma_f32_16x16x32_bf16 v[44:47], v[184:187], v[236:239], v[44:47]
    ds_read_b128 v[204:207], v20 offset:8192
    ds_read_b128 v[208:211], v20 offset:12288
    v_mfma_f32_16x16x32_bf16 v[48:51], v[188:191], v[224:227], v[48:51]
    v_mfma_f32_16x16x32_bf16 v[52:55], v[188:191], v[228:231], v[52:55]
    v_mfma_f32_16x16x32_bf16 v[56:59], v[188:191], v[232:235], v[56:59]
    v_mfma_f32_16x16x32_bf16 v[60:63], v[188:191], v[236:239], v[60:63]
    v_mfma_f32_16x16x32_bf16 v[64:67], v[192:195], v[224:227], v[64:67]
    v_mfma_f32_16x16x32_bf16 v[68:71], v[192:195], v[228:231], v[68:71]
    v_mfma_f32_16x16x32_bf16 v[72:75], v[192:195], v[232:235], v[72:75]
    v_mfma_f32_16x16x32_bf16 v[76:79], v[192:195], v[236:239], v[76:79]
    s_waitcnt vmcnt(5) lgkmcnt(0)
    s_barrier
    v_mfma_f32_16x16x32_bf16 v[116:119], v[172:175], v[196:199], 0
    ds_read_b64_tr_b16 v[184:185], v3 offset:20480
    ds_read_b64_tr_b16 v[186:187], v3 offset:22528
    s_add_u32 m0, s54, 0
    s_add_u32 s47, s92, 148096
    buffer_load_dwordx4 v26, s[72:75], s47 offen lds
    v_mfma_f32_16x16x32_bf16 v[120:123], v[172:175], v[200:203], 0
    ds_read_b64_tr_b16 v[188:189], v4 offset:20480
    ds_read_b64_tr_b16 v[190:191], v4 offset:22528
    s_add_u32 m0, s54, 1024
    s_add_u32 s47, s92, 148096
    buffer_load_dwordx4 v27, s[72:75], s47 offen lds
    v_mfma_f32_16x16x32_bf16 v[124:127], v[172:175], v[204:207], 0
    ds_read_b128 v[224:227], v21 offset:0
    ds_read_b128 v[228:231], v21 offset:4096
    v_mfma_f32_16x16x32_bf16 v[128:131], v[172:175], v[208:211], 0
    ds_read_b128 v[232:235], v21 offset:8192
    ds_read_b128 v[236:239], v21 offset:12288
    v_mfma_f32_16x16x32_bf16 v[132:135], v[176:179], v[196:199], 0
    v_mfma_f32_16x16x32_bf16 v[136:139], v[176:179], v[200:203], 0
    v_mfma_f32_16x16x32_bf16 v[140:143], v[176:179], v[204:207], 0
    v_mfma_f32_16x16x32_bf16 v[144:147], v[176:179], v[208:211], 0
    s_waitcnt vmcnt(5) lgkmcnt(0)
    s_barrier
    v_mfma_f32_16x16x32_bf16 v[116:119], v[184:187], v[224:227], v[116:119]
    ds_read_b64_tr_b16 v[172:173], v3 offset:40960
    ds_read_b64_tr_b16 v[174:175], v3 offset:43008
    s_add_u32 m0, s54, 20480
    s_add_u32 s47, s92, 184960
    buffer_load_dwordx4 v26, s[72:75], s47 offen lds
    v_mfma_f32_16x16x32_bf16 v[120:123], v[184:187], v[228:231], v[120:123]
    ds_read_b64_tr_b16 v[176:177], v4 offset:40960
    ds_read_b64_tr_b16 v[178:179], v4 offset:43008
    s_add_u32 m0, s54, 21504
    s_add_u32 s47, s92, 184960
    buffer_load_dwordx4 v27, s[72:75], s47 offen lds
    v_mfma_f32_16x16x32_bf16 v[124:127], v[184:187], v[232:235], v[124:127]
    ds_read_b128 v[196:199], v22 offset:0
    ds_read_b128 v[200:203], v22 offset:4096
    v_mfma_f32_16x16x32_bf16 v[128:131], v[184:187], v[236:239], v[128:131]
    ds_read_b128 v[204:207], v22 offset:8192
    ds_read_b128 v[208:211], v22 offset:12288
    v_mfma_f32_16x16x32_bf16 v[132:135], v[188:191], v[224:227], v[132:135]
    v_mfma_f32_16x16x32_bf16 v[136:139], v[188:191], v[228:231], v[136:139]
    v_mfma_f32_16x16x32_bf16 v[140:143], v[188:191], v[232:235], v[140:143]
    v_mfma_f32_16x16x32_bf16 v[144:147], v[188:191], v[236:239], v[144:147]
    s_waitcnt vmcnt(5) lgkmcnt(0)
    s_barrier
    v_mfma_f32_16x16x32_bf16 v[116:119], v[172:175], v[196:199], v[116:119]
    ds_read_b64_tr_b16 v[184:185], v3 offset:61440
    ds_read_b64_tr_b16 v[186:187], v3 offset:63488
    s_add_u32 m0, s54, 40960
    s_add_u32 s47, s92, 221824
    buffer_load_dwordx4 v26, s[72:75], s47 offen lds
    v_mfma_f32_16x16x32_bf16 v[120:123], v[172:175], v[200:203], v[120:123]
    ds_read_b64_tr_b16 v[188:189], v4 offset:61440
    ds_read_b64_tr_b16 v[190:191], v4 offset:63488
    s_add_u32 m0, s54, 41984
    s_add_u32 s47, s92, 221824
    buffer_load_dwordx4 v27, s[72:75], s47 offen lds
    v_mfma_f32_16x16x32_bf16 v[124:127], v[172:175], v[204:207], v[124:127]
    ds_read_b128 v[224:227], v23 offset:0
    ds_read_b128 v[228:231], v23 offset:4096
    v_mfma_f32_16x16x32_bf16 v[128:131], v[172:175], v[208:211], v[128:131]
    ds_read_b128 v[232:235], v23 offset:8192
    ds_read_b128 v[236:239], v23 offset:12288
    v_mfma_f32_16x16x32_bf16 v[132:135], v[176:179], v[196:199], v[132:135]
    v_mfma_f32_16x16x32_bf16 v[136:139], v[176:179], v[200:203], v[136:139]
    v_mfma_f32_16x16x32_bf16 v[140:143], v[176:179], v[204:207], v[140:143]
    v_mfma_f32_16x16x32_bf16 v[144:147], v[176:179], v[208:211], v[144:147]
    s_waitcnt vmcnt(4) lgkmcnt(0)
    s_barrier
    s_mov_b32 s47, 0
    s_cmp_lg_u32 s45, 0
    s_cbranch_scc1 concat_heads__gqa_block_cached__gqa_block_cached__near_ridge_kernel_xd0
concat_heads__gqa_block_cached__gqa_block_cached__near_ridge_kernel_xp0:
    v_readfirstlane_b32 s46, v19
    s_or_b32 s46, s46, s30
    s_bitcmp1_b32 s46, s99
    s_cbranch_scc1 concat_heads__gqa_block_cached__gqa_block_cached__near_ridge_kernel_xd0
    s_add_u32 s47, s47, 1
    s_cmp_ge_u32 s47, 0x40000
    s_cbranch_scc1 concat_heads__gqa_block_cached__gqa_block_cached__near_ridge_kernel_xd0
    s_sleep 2
    buffer_load_dword v19, v31, s[84:87], 0 offen sc1
    s_waitcnt vmcnt(0)
    s_branch concat_heads__gqa_block_cached__gqa_block_cached__near_ridge_kernel_xp0
concat_heads__gqa_block_cached__gqa_block_cached__near_ridge_kernel_xd0:
    v_mfma_f32_16x16x32_bf16 v[116:119], v[184:187], v[224:227], v[116:119]
    ds_read_b64_tr_b16 v[172:173], v3 offset:0
    ds_read_b64_tr_b16 v[174:175], v3 offset:2048
    s_add_u32 m0, s54, 61440
    s_add_u32 s47, s92, 258688
    buffer_load_dwordx4 v26, s[72:75], s47 offen lds
    v_mfma_f32_16x16x32_bf16 v[120:123], v[184:187], v[228:231], v[120:123]
    ds_read_b64_tr_b16 v[176:177], v4 offset:0
    ds_read_b64_tr_b16 v[178:179], v4 offset:2048
    s_add_u32 m0, s54, 62464
    s_add_u32 s47, s92, 258688
    buffer_load_dwordx4 v27, s[72:75], s47 offen lds
    v_mfma_f32_16x16x32_bf16 v[124:127], v[184:187], v[232:235], v[124:127]
    ds_read_b128 v[196:199], v20 offset:28672
    ds_read_b128 v[200:203], v20 offset:32768
    v_mfma_f32_16x16x32_bf16 v[128:131], v[184:187], v[236:239], v[128:131]
    ds_read_b128 v[204:207], v20 offset:36864
    ds_read_b128 v[208:211], v20 offset:40960
    v_mfma_f32_16x16x32_bf16 v[132:135], v[188:191], v[224:227], v[132:135]
    v_mfma_f32_16x16x32_bf16 v[136:139], v[188:191], v[228:231], v[136:139]
    v_mfma_f32_16x16x32_bf16 v[140:143], v[188:191], v[232:235], v[140:143]
    v_mfma_f32_16x16x32_bf16 v[144:147], v[188:191], v[236:239], v[144:147]
    s_waitcnt vmcnt(4) lgkmcnt(0)
    s_barrier
    s_add_u32 m0, s27, 92160
    s_add_u32 s47, s26, 81920
    buffer_load_dwordx4 v9, s[88:91], s47 offen sc1 lds
    s_add_u32 m0, s27, 100352
    s_add_u32 s47, s26, 90112
    buffer_load_dwordx4 v9, s[88:91], s47 offen sc1 lds
    s_add_u32 m0, s27, 120832
    s_add_u32 s47, s26, 98304
    buffer_load_dwordx4 v9, s[88:91], s47 offen sc1 lds
    s_add_u32 m0, s27, 129024
    s_add_u32 s47, s26, 106496
    buffer_load_dwordx4 v9, s[88:91], s47 offen sc1 lds
    s_add_u32 s72, s72, s24
    s_addc_u32 s73, s73, s25
    v_mfma_f32_16x16x32_bf16 v[116:119], v[172:175], v[196:199], v[116:119]
    ds_read_b64_tr_b16 v[184:185], v3 offset:20480
    ds_read_b64_tr_b16 v[186:187], v3 offset:22528
    s_add_u32 m0, s54, 0
    s_add_u32 s47, s92, 0
    buffer_load_dwordx4 v26, s[72:75], s47 offen lds
    v_mfma_f32_16x16x32_bf16 v[120:123], v[172:175], v[200:203], v[120:123]
    ds_read_b64_tr_b16 v[188:189], v4 offset:20480
    ds_read_b64_tr_b16 v[190:191], v4 offset:22528
    s_add_u32 m0, s54, 1024
    s_add_u32 s47, s92, 0
    buffer_load_dwordx4 v27, s[72:75], s47 offen lds
    v_mfma_f32_16x16x32_bf16 v[124:127], v[172:175], v[204:207], v[124:127]
    ds_read_b128 v[224:227], v21 offset:28672
    ds_read_b128 v[228:231], v21 offset:32768
    s_add_u32 m0, s94, 0
    s_add_u32 s47, s93, 512
    buffer_load_dwordx4 v28, s[72:75], s47 offen lds
    v_mfma_f32_16x16x32_bf16 v[128:131], v[172:175], v[208:211], v[128:131]
    ds_read_b128 v[232:235], v21 offset:36864
    ds_read_b128 v[236:239], v21 offset:40960
    v_mfma_f32_16x16x32_bf16 v[132:135], v[176:179], v[196:199], v[132:135]
    v_mfma_f32_16x16x32_bf16 v[136:139], v[176:179], v[200:203], v[136:139]
    v_mfma_f32_16x16x32_bf16 v[140:143], v[176:179], v[204:207], v[140:143]
    v_mfma_f32_16x16x32_bf16 v[144:147], v[176:179], v[208:211], v[144:147]
    s_waitcnt vmcnt(9) lgkmcnt(0)
    s_barrier
    v_mfma_f32_16x16x32_bf16 v[116:119], v[184:187], v[224:227], v[116:119]
    ds_read_b64_tr_b16 v[172:173], v3 offset:40960
    ds_read_b64_tr_b16 v[174:175], v3 offset:43008
    s_add_u32 m0, s54, 20480
    s_add_u32 s47, s92, 36864
    buffer_load_dwordx4 v26, s[72:75], s47 offen lds
    v_mfma_f32_16x16x32_bf16 v[120:123], v[184:187], v[228:231], v[120:123]
    ds_read_b64_tr_b16 v[176:177], v4 offset:40960
    ds_read_b64_tr_b16 v[178:179], v4 offset:43008
    s_add_u32 m0, s54, 21504
    s_add_u32 s47, s92, 36864
    buffer_load_dwordx4 v27, s[72:75], s47 offen lds
    v_mfma_f32_16x16x32_bf16 v[124:127], v[184:187], v[232:235], v[124:127]
    ds_read_b128 v[196:199], v22 offset:28672
    ds_read_b128 v[200:203], v22 offset:32768
    s_add_u32 m0, s94, 20480
    s_add_u32 s47, s93, 37376
    buffer_load_dwordx4 v28, s[72:75], s47 offen lds
    v_mfma_f32_16x16x32_bf16 v[128:131], v[184:187], v[236:239], v[128:131]
    ds_read_b128 v[204:207], v22 offset:36864
    ds_read_b128 v[208:211], v22 offset:40960
    v_mfma_f32_16x16x32_bf16 v[132:135], v[188:191], v[224:227], v[132:135]
    v_mfma_f32_16x16x32_bf16 v[136:139], v[188:191], v[228:231], v[136:139]
    v_mfma_f32_16x16x32_bf16 v[140:143], v[188:191], v[232:235], v[140:143]
    v_mfma_f32_16x16x32_bf16 v[144:147], v[188:191], v[236:239], v[144:147]
    s_waitcnt vmcnt(10) lgkmcnt(0)
    s_barrier
    v_mfma_f32_16x16x32_bf16 v[116:119], v[172:175], v[196:199], v[116:119]
    ds_read_b64_tr_b16 v[184:185], v3 offset:61440
    ds_read_b64_tr_b16 v[186:187], v3 offset:63488
    s_add_u32 m0, s54, 40960
    s_add_u32 s47, s92, 73728
    buffer_load_dwordx4 v26, s[72:75], s47 offen lds
    v_mfma_f32_16x16x32_bf16 v[120:123], v[172:175], v[200:203], v[120:123]
    ds_read_b64_tr_b16 v[188:189], v4 offset:61440
    ds_read_b64_tr_b16 v[190:191], v4 offset:63488
    s_add_u32 m0, s54, 41984
    s_add_u32 s47, s92, 73728
    buffer_load_dwordx4 v27, s[72:75], s47 offen lds
    v_mfma_f32_16x16x32_bf16 v[124:127], v[172:175], v[204:207], v[124:127]
    ds_read_b128 v[224:227], v23 offset:28672
    ds_read_b128 v[228:231], v23 offset:32768
    s_add_u32 m0, s94, 40960
    s_add_u32 s47, s93, 74240
    buffer_load_dwordx4 v28, s[72:75], s47 offen lds
    v_mfma_f32_16x16x32_bf16 v[128:131], v[172:175], v[208:211], v[128:131]
    ds_read_b128 v[232:235], v23 offset:36864
    ds_read_b128 v[236:239], v23 offset:40960
    v_mfma_f32_16x16x32_bf16 v[132:135], v[176:179], v[196:199], v[132:135]
    v_mfma_f32_16x16x32_bf16 v[136:139], v[176:179], v[200:203], v[136:139]
    v_mfma_f32_16x16x32_bf16 v[140:143], v[176:179], v[204:207], v[140:143]
    v_mfma_f32_16x16x32_bf16 v[144:147], v[176:179], v[208:211], v[144:147]
    s_waitcnt vmcnt(6) lgkmcnt(0)
    s_barrier
    v_add_u32 v20, s23, v20
    v_add_u32 v21, s23, v21
    v_add_u32 v22, s23, v22
    v_add_u32 v23, s23, v23
    v_mfma_f32_16x16x32_bf16 v[116:119], v[184:187], v[224:227], v[116:119]
    ds_read_b64_tr_b16 v[172:173], v3 offset:0
    ds_read_b64_tr_b16 v[174:175], v3 offset:2048
    s_add_u32 m0, s54, 61440
    s_add_u32 s47, s92, 110592
    buffer_load_dwordx4 v26, s[72:75], s47 offen lds
    v_mfma_f32_16x16x32_bf16 v[120:123], v[184:187], v[228:231], v[120:123]
    ds_read_b64_tr_b16 v[176:177], v4 offset:0
    ds_read_b64_tr_b16 v[178:179], v4 offset:2048
    s_add_u32 m0, s54, 62464
    s_add_u32 s47, s92, 110592
    buffer_load_dwordx4 v27, s[72:75], s47 offen lds
    v_mfma_f32_16x16x32_bf16 v[124:127], v[184:187], v[232:235], v[124:127]
    ds_read_b64_tr_b16 v[180:181], v5 offset:0
    ds_read_b64_tr_b16 v[182:183], v5 offset:512
    s_add_u32 m0, s94, 61440
    s_add_u32 s47, s93, 111104
    buffer_load_dwordx4 v28, s[72:75], s47 offen lds
    v_mfma_f32_16x16x32_bf16 v[128:131], v[184:187], v[236:239], v[128:131]
    ds_read_b128 v[196:199], v20 offset:8192
    ds_read_b128 v[200:203], v20 offset:12288
    v_mfma_f32_16x16x32_bf16 v[132:135], v[188:191], v[224:227], v[132:135]
    ds_read_b128 v[204:207], v20 offset:16384
    ds_read_b128 v[208:211], v20 offset:4096
    v_mfma_f32_16x16x32_bf16 v[136:139], v[188:191], v[228:231], v[136:139]
    v_mfma_f32_16x16x32_bf16 v[140:143], v[188:191], v[232:235], v[140:143]
    v_mfma_f32_16x16x32_bf16 v[144:147], v[188:191], v[236:239], v[144:147]
    s_waitcnt vmcnt(6) lgkmcnt(0)
    s_barrier
    v_mfma_f32_16x16x32_bf16 v[32:35], v[172:175], v[196:199], v[32:35]
    ds_read_b64_tr_b16 v[184:185], v3 offset:20480
    ds_read_b64_tr_b16 v[186:187], v3 offset:22528
    s_add_u32 m0, s54, 0
    s_add_u32 s47, s92, 147456
    buffer_load_dwordx4 v26, s[72:75], s47 offen lds
    v_mfma_f32_16x16x32_bf16 v[36:39], v[172:175], v[200:203], v[36:39]
    ds_read_b64_tr_b16 v[188:189], v4 offset:20480
    ds_read_b64_tr_b16 v[190:191], v4 offset:22528
    s_add_u32 m0, s54, 1024
    s_add_u32 s47, s92, 147456
    buffer_load_dwordx4 v27, s[72:75], s47 offen lds
    v_mfma_f32_16x16x32_bf16 v[40:43], v[172:175], v[204:207], v[40:43]
    ds_read_b64_tr_b16 v[192:193], v5 offset:20480
    ds_read_b64_tr_b16 v[194:195], v5 offset:20992
    s_add_u32 m0, s94, 0
    s_add_u32 s47, s93, 147968
    buffer_load_dwordx4 v28, s[72:75], s47 offen lds
    v_mfma_f32_16x16x32_bf16 v[44:47], v[172:175], v[208:211], v[44:47]
    ds_read_b128 v[224:227], v21 offset:8192
    ds_read_b128 v[228:231], v21 offset:12288
    v_mfma_f32_16x16x32_bf16 v[48:51], v[176:179], v[196:199], v[48:51]
    ds_read_b128 v[232:235], v21 offset:16384
    ds_read_b128 v[236:239], v21 offset:4096
    v_mfma_f32_16x16x32_bf16 v[52:55], v[176:179], v[200:203], v[52:55]
    v_mfma_f32_16x16x32_bf16 v[56:59], v[176:179], v[204:207], v[56:59]
    v_mfma_f32_16x16x32_bf16 v[60:63], v[176:179], v[208:211], v[60:63]
    v_mfma_f32_16x16x32_bf16 v[64:67], v[180:183], v[196:199], v[64:67]
    v_mfma_f32_16x16x32_bf16 v[68:71], v[180:183], v[200:203], v[68:71]
    v_mfma_f32_16x16x32_bf16 v[72:75], v[180:183], v[204:207], v[72:75]
    v_mfma_f32_16x16x32_bf16 v[76:79], v[180:183], v[208:211], v[76:79]
    s_waitcnt vmcnt(6) lgkmcnt(0)
    s_barrier
    v_mfma_f32_16x16x32_bf16 v[32:35], v[184:187], v[224:227], v[32:35]
    ds_read_b64_tr_b16 v[172:173], v3 offset:40960
    ds_read_b64_tr_b16 v[174:175], v3 offset:43008
    s_add_u32 m0, s54, 20480
    s_add_u32 s47, s92, 184320
    buffer_load_dwordx4 v26, s[72:75], s47 offen lds
    v_mfma_f32_16x16x32_bf16 v[36:39], v[184:187], v[228:231], v[36:39]
    ds_read_b64_tr_b16 v[176:177], v4 offset:40960
    ds_read_b64_tr_b16 v[178:179], v4 offset:43008
    s_add_u32 m0, s54, 21504
    s_add_u32 s47, s92, 184320
    buffer_load_dwordx4 v27, s[72:75], s47 offen lds
    v_mfma_f32_16x16x32_bf16 v[40:43], v[184:187], v[232:235], v[40:43]
    ds_read_b64_tr_b16 v[180:181], v5 offset:40960
    ds_read_b64_tr_b16 v[182:183], v5 offset:41472
    s_add_u32 m0, s94, 20480
    s_add_u32 s47, s93, 184832
    buffer_load_dwordx4 v28, s[72:75], s47 offen lds
    v_mfma_f32_16x16x32_bf16 v[44:47], v[184:187], v[236:239], v[44:47]
    ds_read_b128 v[196:199], v22 offset:8192
    ds_read_b128 v[200:203], v22 offset:12288
    v_mfma_f32_16x16x32_bf16 v[48:51], v[188:191], v[224:227], v[48:51]
    ds_read_b128 v[204:207], v22 offset:16384
    ds_read_b128 v[208:211], v22 offset:4096
    v_mfma_f32_16x16x32_bf16 v[52:55], v[188:191], v[228:231], v[52:55]
    v_mfma_f32_16x16x32_bf16 v[56:59], v[188:191], v[232:235], v[56:59]
    v_mfma_f32_16x16x32_bf16 v[60:63], v[188:191], v[236:239], v[60:63]
    v_mfma_f32_16x16x32_bf16 v[64:67], v[192:195], v[224:227], v[64:67]
    v_mfma_f32_16x16x32_bf16 v[68:71], v[192:195], v[228:231], v[68:71]
    v_mfma_f32_16x16x32_bf16 v[72:75], v[192:195], v[232:235], v[72:75]
    v_mfma_f32_16x16x32_bf16 v[76:79], v[192:195], v[236:239], v[76:79]
    s_waitcnt vmcnt(6) lgkmcnt(0)
    s_barrier
    v_mfma_f32_16x16x32_bf16 v[32:35], v[172:175], v[196:199], v[32:35]
    ds_read_b64_tr_b16 v[184:185], v3 offset:61440
    ds_read_b64_tr_b16 v[186:187], v3 offset:63488
    s_add_u32 m0, s54, 40960
    s_add_u32 s47, s92, 221184
    buffer_load_dwordx4 v26, s[72:75], s47 offen lds
    v_mfma_f32_16x16x32_bf16 v[36:39], v[172:175], v[200:203], v[36:39]
    ds_read_b64_tr_b16 v[188:189], v4 offset:61440
    ds_read_b64_tr_b16 v[190:191], v4 offset:63488
    s_add_u32 m0, s54, 41984
    s_add_u32 s47, s92, 221184
    buffer_load_dwordx4 v27, s[72:75], s47 offen lds
    v_mfma_f32_16x16x32_bf16 v[40:43], v[172:175], v[204:207], v[40:43]
    ds_read_b64_tr_b16 v[192:193], v5 offset:61440
    ds_read_b64_tr_b16 v[194:195], v5 offset:61952
    s_add_u32 m0, s94, 40960
    s_add_u32 s47, s93, 221696
    buffer_load_dwordx4 v28, s[72:75], s47 offen lds
    v_mfma_f32_16x16x32_bf16 v[44:47], v[172:175], v[208:211], v[44:47]
    ds_read_b128 v[224:227], v23 offset:8192
    ds_read_b128 v[228:231], v23 offset:12288
    v_mfma_f32_16x16x32_bf16 v[48:51], v[176:179], v[196:199], v[48:51]
    ds_read_b128 v[232:235], v23 offset:16384
    ds_read_b128 v[236:239], v23 offset:4096
    v_mfma_f32_16x16x32_bf16 v[52:55], v[176:179], v[200:203], v[52:55]
    v_mfma_f32_16x16x32_bf16 v[56:59], v[176:179], v[204:207], v[56:59]
    v_mfma_f32_16x16x32_bf16 v[60:63], v[176:179], v[208:211], v[60:63]
    v_mfma_f32_16x16x32_bf16 v[64:67], v[180:183], v[196:199], v[64:67]
    v_mfma_f32_16x16x32_bf16 v[68:71], v[180:183], v[200:203], v[68:71]
    v_mfma_f32_16x16x32_bf16 v[72:75], v[180:183], v[204:207], v[72:75]
    v_mfma_f32_16x16x32_bf16 v[76:79], v[180:183], v[208:211], v[76:79]
    s_waitcnt vmcnt(6) lgkmcnt(0)
    s_barrier
    v_mfma_f32_16x16x32_bf16 v[32:35], v[184:187], v[224:227], v[32:35]
    ds_read_b64_tr_b16 v[172:173], v3 offset:0
    ds_read_b64_tr_b16 v[174:175], v3 offset:2048
    s_add_u32 m0, s54, 61440
    s_add_u32 s47, s92, 258048
    buffer_load_dwordx4 v26, s[72:75], s47 offen lds
    v_mfma_f32_16x16x32_bf16 v[36:39], v[184:187], v[228:231], v[36:39]
    ds_read_b64_tr_b16 v[176:177], v4 offset:0
    ds_read_b64_tr_b16 v[178:179], v4 offset:2048
    s_add_u32 m0, s54, 62464
    s_add_u32 s47, s92, 258048
    buffer_load_dwordx4 v27, s[72:75], s47 offen lds
    v_mfma_f32_16x16x32_bf16 v[40:43], v[184:187], v[232:235], v[40:43]
    ds_read_b64_tr_b16 v[180:181], v5 offset:0
    ds_read_b64_tr_b16 v[182:183], v5 offset:512
    s_add_u32 m0, s94, 61440
    s_add_u32 s47, s93, 258560
    buffer_load_dwordx4 v28, s[72:75], s47 offen lds
    v_mfma_f32_16x16x32_bf16 v[44:47], v[184:187], v[236:239], v[44:47]
    ds_read_b128 v[196:199], v20 offset:36864
    ds_read_b128 v[200:203], v20 offset:40960
    v_mfma_f32_16x16x32_bf16 v[48:51], v[188:191], v[224:227], v[48:51]
    ds_read_b128 v[204:207], v20 offset:45056
    ds_read_b128 v[208:211], v20 offset:0
    v_mfma_f32_16x16x32_bf16 v[52:55], v[188:191], v[228:231], v[52:55]
    v_mfma_f32_16x16x32_bf16 v[56:59], v[188:191], v[232:235], v[56:59]
    v_mfma_f32_16x16x32_bf16 v[60:63], v[188:191], v[236:239], v[60:63]
    v_mfma_f32_16x16x32_bf16 v[64:67], v[192:195], v[224:227], v[64:67]
    v_mfma_f32_16x16x32_bf16 v[68:71], v[192:195], v[228:231], v[68:71]
    v_mfma_f32_16x16x32_bf16 v[72:75], v[192:195], v[232:235], v[72:75]
    v_mfma_f32_16x16x32_bf16 v[76:79], v[192:195], v[236:239], v[76:79]
    s_waitcnt vmcnt(6) lgkmcnt(0)
    s_barrier
    v_mov_b32 v80, 0
    v_mov_b32 v81, 0
    v_mov_b32 v82, 0
    v_mov_b32 v83, 0
    v_mfma_f32_16x16x32_bf16 v[32:35], v[172:175], v[196:199], v[32:35]
    ds_read_b64_tr_b16 v[184:185], v3 offset:20480
    ds_read_b64_tr_b16 v[186:187], v3 offset:22528
    s_add_u32 m0, s54, 0
    s_add_u32 s47, s92, 640
    buffer_load_dwordx4 v26, s[72:75], s47 offen lds
    v_mfma_f32_16x16x32_bf16 v[36:39], v[172:175], v[200:203], v[36:39]
    ds_read_b64_tr_b16 v[188:189], v4 offset:20480
    ds_read_b64_tr_b16 v[190:191], v4 offset:22528
    s_add_u32 m0, s54, 1024
    s_add_u32 s47, s92, 640
    buffer_load_dwordx4 v27, s[72:75], s47 offen lds
    v_mfma_f32_16x16x32_bf16 v[40:43], v[172:175], v[204:207], v[40:43]
    ds_read_b64_tr_b16 v[192:193], v5 offset:20480
    ds_read_b64_tr_b16 v[194:195], v5 offset:20992
    v_mfma_f32_16x16x32_bf16 v[44:47], v[172:175], v[208:211], v[44:47]
    ds_read_b128 v[224:227], v21 offset:36864
    ds_read_b128 v[228:231], v21 offset:40960
    v_mfma_f32_16x16x32_bf16 v[48:51], v[176:179], v[196:199], v[48:51]
    ds_read_b128 v[232:235], v21 offset:45056
    ds_read_b128 v[236:239], v21 offset:0
    v_mfma_f32_16x16x32_bf16 v[52:55], v[176:179], v[200:203], v[52:55]
    v_mfma_f32_16x16x32_bf16 v[56:59], v[176:179], v[204:207], v[56:59]
    v_mfma_f32_16x16x32_bf16 v[60:63], v[176:179], v[208:211], v[60:63]
    v_mfma_f32_16x16x32_bf16 v[64:67], v[180:183], v[196:199], v[64:67]
    v_mfma_f32_16x16x32_bf16 v[68:71], v[180:183], v[200:203], v[68:71]
    v_mfma_f32_16x16x32_bf16 v[72:75], v[180:183], v[204:207], v[72:75]
    v_mfma_f32_16x16x32_bf16 v[76:79], v[180:183], v[208:211], v[76:79]
    s_waitcnt vmcnt(5) lgkmcnt(0)
    s_barrier
    v_mfma_f32_16x16x32_bf16 v[32:35], v[184:187], v[224:227], v[32:35]
    ds_read_b64_tr_b16 v[172:173], v3 offset:40960
    ds_read_b64_tr_b16 v[174:175], v3 offset:43008
    s_add_u32 m0, s54, 20480
    s_add_u32 s47, s92, 37504
    buffer_load_dwordx4 v26, s[72:75], s47 offen lds
    v_mfma_f32_16x16x32_bf16 v[36:39], v[184:187], v[228:231], v[36:39]
    ds_read_b64_tr_b16 v[176:177], v4 offset:40960
    ds_read_b64_tr_b16 v[178:179], v4 offset:43008
    s_add_u32 m0, s54, 21504
    s_add_u32 s47, s92, 37504
    buffer_load_dwordx4 v27, s[72:75], s47 offen lds
    v_mfma_f32_16x16x32_bf16 v[40:43], v[184:187], v[232:235], v[40:43]
    ds_read_b64_tr_b16 v[180:181], v5 offset:40960
    ds_read_b64_tr_b16 v[182:183], v5 offset:41472
    v_mfma_f32_16x16x32_bf16 v[44:47], v[184:187], v[236:239], v[44:47]
    ds_read_b128 v[196:199], v22 offset:36864
    ds_read_b128 v[200:203], v22 offset:40960
    v_mfma_f32_16x16x32_bf16 v[48:51], v[188:191], v[224:227], v[48:51]
    ds_read_b128 v[204:207], v22 offset:45056
    ds_read_b128 v[208:211], v22 offset:0
    v_mfma_f32_16x16x32_bf16 v[52:55], v[188:191], v[228:231], v[52:55]
    v_mfma_f32_16x16x32_bf16 v[56:59], v[188:191], v[232:235], v[56:59]
    v_mfma_f32_16x16x32_bf16 v[60:63], v[188:191], v[236:239], v[60:63]
    v_mfma_f32_16x16x32_bf16 v[64:67], v[192:195], v[224:227], v[64:67]
    v_mfma_f32_16x16x32_bf16 v[68:71], v[192:195], v[228:231], v[68:71]
    v_mfma_f32_16x16x32_bf16 v[72:75], v[192:195], v[232:235], v[72:75]
    v_mfma_f32_16x16x32_bf16 v[76:79], v[192:195], v[236:239], v[76:79]
    s_waitcnt vmcnt(4) lgkmcnt(0)
    s_barrier
    v_mfma_f32_16x16x32_bf16 v[32:35], v[172:175], v[196:199], v[32:35]
    ds_read_b64_tr_b16 v[184:185], v3 offset:61440
    ds_read_b64_tr_b16 v[186:187], v3 offset:63488
    s_add_u32 m0, s54, 40960
    s_add_u32 s47, s92, 74368
    buffer_load_dwordx4 v26, s[72:75], s47 offen lds
    v_mfma_f32_16x16x32_bf16 v[36:39], v[172:175], v[200:203], v[36:39]
    ds_read_b64_tr_b16 v[188:189], v4 offset:61440
    ds_read_b64_tr_b16 v[190:191], v4 offset:63488
    s_add_u32 m0, s54, 41984
    s_add_u32 s47, s92, 74368
    buffer_load_dwordx4 v27, s[72:75], s47 offen lds
    v_mfma_f32_16x16x32_bf16 v[40:43], v[172:175], v[204:207], v[40:43]
    ds_read_b64_tr_b16 v[192:193], v5 offset:61440
    ds_read_b64_tr_b16 v[194:195], v5 offset:61952
    v_mfma_f32_16x16x32_bf16 v[44:47], v[172:175], v[208:211], v[44:47]
    ds_read_b128 v[224:227], v23 offset:36864
    ds_read_b128 v[228:231], v23 offset:40960
    v_mfma_f32_16x16x32_bf16 v[48:51], v[176:179], v[196:199], v[48:51]
    ds_read_b128 v[232:235], v23 offset:45056
    ds_read_b128 v[236:239], v23 offset:0
    v_mfma_f32_16x16x32_bf16 v[52:55], v[176:179], v[200:203], v[52:55]
    v_mfma_f32_16x16x32_bf16 v[56:59], v[176:179], v[204:207], v[56:59]
    v_mfma_f32_16x16x32_bf16 v[60:63], v[176:179], v[208:211], v[60:63]
    v_mfma_f32_16x16x32_bf16 v[64:67], v[180:183], v[196:199], v[64:67]
    v_mfma_f32_16x16x32_bf16 v[68:71], v[180:183], v[200:203], v[68:71]
    v_mfma_f32_16x16x32_bf16 v[72:75], v[180:183], v[204:207], v[72:75]
    v_mfma_f32_16x16x32_bf16 v[76:79], v[180:183], v[208:211], v[76:79]
    s_waitcnt vmcnt(4) lgkmcnt(0)
    s_barrier
    v_mfma_f32_16x16x32_bf16 v[32:35], v[184:187], v[224:227], v[32:35]
    ds_read_b64_tr_b16 v[172:173], v3 offset:0
    ds_read_b64_tr_b16 v[174:175], v3 offset:2048
    s_add_u32 m0, s54, 61440
    s_add_u32 s47, s92, 111232
    buffer_load_dwordx4 v26, s[72:75], s47 offen lds
    v_mfma_f32_16x16x32_bf16 v[36:39], v[184:187], v[228:231], v[36:39]
    ds_read_b64_tr_b16 v[176:177], v4 offset:0
    ds_read_b64_tr_b16 v[178:179], v4 offset:2048
    s_add_u32 m0, s54, 62464
    s_add_u32 s47, s92, 111232
    buffer_load_dwordx4 v27, s[72:75], s47 offen lds
    v_mfma_f32_16x16x32_bf16 v[40:43], v[184:187], v[232:235], v[40:43]
    ds_read_b128 v[196:199], v20 offset:8192
    ds_read_b128 v[200:203], v20 offset:12288
    v_mfma_f32_16x16x32_bf16 v[44:47], v[184:187], v[236:239], v[44:47]
    ds_read_b128 v[204:207], v20 offset:16384
    ds_read_b128 v[208:211], v20 offset:4096
    v_mfma_f32_16x16x32_bf16 v[48:51], v[188:191], v[224:227], v[48:51]
    v_mfma_f32_16x16x32_bf16 v[52:55], v[188:191], v[228:231], v[52:55]
    v_mfma_f32_16x16x32_bf16 v[56:59], v[188:191], v[232:235], v[56:59]
    v_mfma_f32_16x16x32_bf16 v[60:63], v[188:191], v[236:239], v[60:63]
    v_mfma_f32_16x16x32_bf16 v[64:67], v[192:195], v[224:227], v[64:67]
    v_mfma_f32_16x16x32_bf16 v[68:71], v[192:195], v[228:231], v[68:71]
    v_mfma_f32_16x16x32_bf16 v[72:75], v[192:195], v[232:235], v[72:75]
    v_mfma_f32_16x16x32_bf16 v[76:79], v[192:195], v[236:239], v[76:79]
    s_waitcnt vmcnt(4) lgkmcnt(0)
    s_barrier
    v_mfma_f32_16x16x32_bf16 v[116:119], v[172:175], v[196:199], v[116:119]
    ds_read_b64_tr_b16 v[184:185], v3 offset:20480
    ds_read_b64_tr_b16 v[186:187], v3 offset:22528
    s_add_u32 m0, s54, 0
    s_add_u32 s47, s92, 148096
    buffer_load_dwordx4 v26, s[72:75], s47 offen lds
    v_mfma_f32_16x16x32_bf16 v[120:123], v[172:175], v[200:203], v[120:123]
    ds_read_b64_tr_b16 v[188:189], v4 offset:20480
    ds_read_b64_tr_b16 v[190:191], v4 offset:22528
    s_add_u32 m0, s54, 1024
    s_add_u32 s47, s92, 148096
    buffer_load_dwordx4 v27, s[72:75], s47 offen lds
    v_mfma_f32_16x16x32_bf16 v[124:127], v[172:175], v[204:207], v[124:127]
    ds_read_b128 v[224:227], v21 offset:8192
    ds_read_b128 v[228:231], v21 offset:12288
    v_mfma_f32_16x16x32_bf16 v[128:131], v[172:175], v[208:211], v[128:131]
    ds_read_b128 v[232:235], v21 offset:16384
    ds_read_b128 v[236:239], v21 offset:4096
    v_mfma_f32_16x16x32_bf16 v[132:135], v[176:179], v[196:199], v[132:135]
    v_mfma_f32_16x16x32_bf16 v[136:139], v[176:179], v[200:203], v[136:139]
    v_mfma_f32_16x16x32_bf16 v[140:143], v[176:179], v[204:207], v[140:143]
    v_mfma_f32_16x16x32_bf16 v[144:147], v[176:179], v[208:211], v[144:147]
    s_waitcnt vmcnt(4) lgkmcnt(0)
    s_barrier
    v_mfma_f32_16x16x32_bf16 v[116:119], v[184:187], v[224:227], v[116:119]
    ds_read_b64_tr_b16 v[172:173], v3 offset:40960
    ds_read_b64_tr_b16 v[174:175], v3 offset:43008
    s_add_u32 m0, s54, 20480
    s_add_u32 s47, s92, 184960
    buffer_load_dwordx4 v26, s[72:75], s47 offen lds
    v_mfma_f32_16x16x32_bf16 v[120:123], v[184:187], v[228:231], v[120:123]
    ds_read_b64_tr_b16 v[176:177], v4 offset:40960
    ds_read_b64_tr_b16 v[178:179], v4 offset:43008
    s_add_u32 m0, s54, 21504
    s_add_u32 s47, s92, 184960
    buffer_load_dwordx4 v27, s[72:75], s47 offen lds
    v_mfma_f32_16x16x32_bf16 v[124:127], v[184:187], v[232:235], v[124:127]
    ds_read_b128 v[196:199], v22 offset:8192
    ds_read_b128 v[200:203], v22 offset:12288
    v_mfma_f32_16x16x32_bf16 v[128:131], v[184:187], v[236:239], v[128:131]
    ds_read_b128 v[204:207], v22 offset:16384
    ds_read_b128 v[208:211], v22 offset:4096
    v_mfma_f32_16x16x32_bf16 v[132:135], v[188:191], v[224:227], v[132:135]
    v_mfma_f32_16x16x32_bf16 v[136:139], v[188:191], v[228:231], v[136:139]
    v_mfma_f32_16x16x32_bf16 v[140:143], v[188:191], v[232:235], v[140:143]
    v_mfma_f32_16x16x32_bf16 v[144:147], v[188:191], v[236:239], v[144:147]
    s_waitcnt vmcnt(4) lgkmcnt(0)
    s_barrier
    v_mfma_f32_16x16x32_bf16 v[116:119], v[172:175], v[196:199], v[116:119]
    ds_read_b64_tr_b16 v[184:185], v3 offset:61440
    ds_read_b64_tr_b16 v[186:187], v3 offset:63488
    s_add_u32 m0, s54, 40960
    s_add_u32 s47, s92, 221824
    buffer_load_dwordx4 v26, s[72:75], s47 offen lds
    v_mfma_f32_16x16x32_bf16 v[120:123], v[172:175], v[200:203], v[120:123]
    ds_read_b64_tr_b16 v[188:189], v4 offset:61440
    ds_read_b64_tr_b16 v[190:191], v4 offset:63488
    s_add_u32 m0, s54, 41984
    s_add_u32 s47, s92, 221824
    buffer_load_dwordx4 v27, s[72:75], s47 offen lds
    v_mfma_f32_16x16x32_bf16 v[124:127], v[172:175], v[204:207], v[124:127]
    ds_read_b128 v[224:227], v23 offset:8192
    ds_read_b128 v[228:231], v23 offset:12288
    v_mfma_f32_16x16x32_bf16 v[128:131], v[172:175], v[208:211], v[128:131]
    ds_read_b128 v[232:235], v23 offset:16384
    ds_read_b128 v[236:239], v23 offset:4096
    v_mfma_f32_16x16x32_bf16 v[132:135], v[176:179], v[196:199], v[132:135]
    v_mfma_f32_16x16x32_bf16 v[136:139], v[176:179], v[200:203], v[136:139]
    v_mfma_f32_16x16x32_bf16 v[140:143], v[176:179], v[204:207], v[140:143]
    v_mfma_f32_16x16x32_bf16 v[144:147], v[176:179], v[208:211], v[144:147]
    s_waitcnt vmcnt(4) lgkmcnt(0)
    s_barrier
    v_mfma_f32_16x16x32_bf16 v[116:119], v[184:187], v[224:227], v[116:119]
    ds_read_b64_tr_b16 v[172:173], v3 offset:0
    ds_read_b64_tr_b16 v[174:175], v3 offset:2048
    s_add_u32 m0, s54, 61440
    s_add_u32 s47, s92, 258688
    buffer_load_dwordx4 v26, s[72:75], s47 offen lds
    v_mfma_f32_16x16x32_bf16 v[120:123], v[184:187], v[228:231], v[120:123]
    ds_read_b64_tr_b16 v[176:177], v4 offset:0
    ds_read_b64_tr_b16 v[178:179], v4 offset:2048
    s_add_u32 m0, s54, 62464
    s_add_u32 s47, s92, 258688
    buffer_load_dwordx4 v27, s[72:75], s47 offen lds
    v_mfma_f32_16x16x32_bf16 v[124:127], v[184:187], v[232:235], v[124:127]
    ds_read_b128 v[196:199], v20 offset:36864
    ds_read_b128 v[200:203], v20 offset:40960
    v_mfma_f32_16x16x32_bf16 v[128:131], v[184:187], v[236:239], v[128:131]
    ds_read_b128 v[204:207], v20 offset:45056
    ds_read_b128 v[208:211], v20 offset:0
    v_mfma_f32_16x16x32_bf16 v[132:135], v[188:191], v[224:227], v[132:135]
    v_mfma_f32_16x16x32_bf16 v[136:139], v[188:191], v[228:231], v[136:139]
    v_mfma_f32_16x16x32_bf16 v[140:143], v[188:191], v[232:235], v[140:143]
    v_mfma_f32_16x16x32_bf16 v[144:147], v[188:191], v[236:239], v[144:147]
    s_waitcnt vmcnt(4) lgkmcnt(0)
    s_barrier
    v_mfma_f32_16x16x32_bf16 v[116:119], v[172:175], v[196:199], v[116:119]
    ds_read_b64_tr_b16 v[184:185], v3 offset:20480
    ds_read_b64_tr_b16 v[186:187], v3 offset:22528
    v_mfma_f32_16x16x32_bf16 v[120:123], v[172:175], v[200:203], v[120:123]
    ds_read_b64_tr_b16 v[188:189], v4 offset:20480
    ds_read_b64_tr_b16 v[190:191], v4 offset:22528
    v_mfma_f32_16x16x32_bf16 v[124:127], v[172:175], v[204:207], v[124:127]
    ds_read_b128 v[224:227], v21 offset:36864
    ds_read_b128 v[228:231], v21 offset:40960
    v_mfma_f32_16x16x32_bf16 v[128:131], v[172:175], v[208:211], v[128:131]
    ds_read_b128 v[232:235], v21 offset:45056
    ds_read_b128 v[236:239], v21 offset:0
    v_mfma_f32_16x16x32_bf16 v[132:135], v[176:179], v[196:199], v[132:135]
    v_mfma_f32_16x16x32_bf16 v[136:139], v[176:179], v[200:203], v[136:139]
    v_mfma_f32_16x16x32_bf16 v[140:143], v[176:179], v[204:207], v[140:143]
    v_mfma_f32_16x16x32_bf16 v[144:147], v[176:179], v[208:211], v[144:147]
    s_waitcnt vmcnt(2) lgkmcnt(0)
    s_barrier
    v_mfma_f32_16x16x32_bf16 v[116:119], v[184:187], v[224:227], v[116:119]
    ds_read_b64_tr_b16 v[172:173], v3 offset:40960
    ds_read_b64_tr_b16 v[174:175], v3 offset:43008
    v_mfma_f32_16x16x32_bf16 v[120:123], v[184:187], v[228:231], v[120:123]
    ds_read_b64_tr_b16 v[176:177], v4 offset:40960
    ds_read_b64_tr_b16 v[178:179], v4 offset:43008
    v_mfma_f32_16x16x32_bf16 v[124:127], v[184:187], v[232:235], v[124:127]
    ds_read_b128 v[196:199], v22 offset:36864
    ds_read_b128 v[200:203], v22 offset:40960
    v_mfma_f32_16x16x32_bf16 v[128:131], v[184:187], v[236:239], v[128:131]
    ds_read_b128 v[204:207], v22 offset:45056
    ds_read_b128 v[208:211], v22 offset:0
    v_mfma_f32_16x16x32_bf16 v[132:135], v[188:191], v[224:227], v[132:135]
    v_mfma_f32_16x16x32_bf16 v[136:139], v[188:191], v[228:231], v[136:139]
    v_mfma_f32_16x16x32_bf16 v[140:143], v[188:191], v[232:235], v[140:143]
    v_mfma_f32_16x16x32_bf16 v[144:147], v[188:191], v[236:239], v[144:147]
    s_waitcnt vmcnt(0) lgkmcnt(0)
    s_barrier
    v_mfma_f32_16x16x32_bf16 v[116:119], v[172:175], v[196:199], v[116:119]
    ds_read_b64_tr_b16 v[184:185], v3 offset:61440
    ds_read_b64_tr_b16 v[186:187], v3 offset:63488
    v_mfma_f32_16x16x32_bf16 v[120:123], v[172:175], v[200:203], v[120:123]
    ds_read_b64_tr_b16 v[188:189], v4 offset:61440
    ds_read_b64_tr_b16 v[190:191], v4 offset:63488
    v_mfma_f32_16x16x32_bf16 v[124:127], v[172:175], v[204:207], v[124:127]
    ds_read_b128 v[224:227], v23 offset:36864
    ds_read_b128 v[228:231], v23 offset:40960
    v_mfma_f32_16x16x32_bf16 v[128:131], v[172:175], v[208:211], v[128:131]
    ds_read_b128 v[232:235], v23 offset:45056
    ds_read_b128 v[236:239], v23 offset:0
    v_mfma_f32_16x16x32_bf16 v[132:135], v[176:179], v[196:199], v[132:135]
    v_mfma_f32_16x16x32_bf16 v[136:139], v[176:179], v[200:203], v[136:139]
    v_mfma_f32_16x16x32_bf16 v[140:143], v[176:179], v[204:207], v[140:143]
    v_mfma_f32_16x16x32_bf16 v[144:147], v[176:179], v[208:211], v[144:147]
    s_waitcnt lgkmcnt(0)
    s_barrier
    v_mfma_f32_16x16x32_bf16 v[116:119], v[184:187], v[224:227], v[116:119]
    v_mfma_f32_16x16x32_bf16 v[120:123], v[184:187], v[228:231], v[120:123]
    v_mfma_f32_16x16x32_bf16 v[124:127], v[184:187], v[232:235], v[124:127]
    v_mfma_f32_16x16x32_bf16 v[128:131], v[184:187], v[236:239], v[128:131]
    v_mfma_f32_16x16x32_bf16 v[132:135], v[188:191], v[224:227], v[132:135]
    v_mfma_f32_16x16x32_bf16 v[136:139], v[188:191], v[228:231], v[136:139]
    v_mfma_f32_16x16x32_bf16 v[140:143], v[188:191], v[232:235], v[140:143]
    v_mfma_f32_16x16x32_bf16 v[144:147], v[188:191], v[236:239], v[144:147]
    v_cvt_pk_bf16_f32 v32, v32, v33
    v_cvt_pk_bf16_f32 v33, v34, v35
    v_cvt_pk_bf16_f32 v34, v48, v49
    v_cvt_pk_bf16_f32 v35, v50, v51
    s_cmp_eq_u32 s28, 0
    s_cselect_b32 s47, 0x7ff00000, 0
    v_or_b32 v12, s47, v9
    s_cbranch_scc0 concat_heads__gqa_block_cached__gqa_block_cached__near_ridge_kernel_os0
    v_mov_b32 v80, v32
    v_mov_b32 v81, v33
    v_mov_b32 v82, v34
    v_mov_b32 v83, v35
    concat_heads__gqa_block_cached__gqa_block_cached__near_ridge_kernel_os0:
    s_mov_b32 s46, 0
    buffer_store_dwordx4 v[32:35], v12, s[36:39], s46 offen sc1
    v_cvt_pk_bf16_f32 v36, v36, v37
    v_cvt_pk_bf16_f32 v37, v38, v39
    v_cvt_pk_bf16_f32 v38, v52, v53
    v_cvt_pk_bf16_f32 v39, v54, v55
    s_cmp_eq_u32 s28, 2
    s_cselect_b32 s47, 0x7ff00000, 0
    v_or_b32 v13, s47, v9
    s_cbranch_scc0 concat_heads__gqa_block_cached__gqa_block_cached__near_ridge_kernel_os1
    v_mov_b32 v80, v36
    v_mov_b32 v81, v37
    v_mov_b32 v82, v38
    v_mov_b32 v83, v39
    concat_heads__gqa_block_cached__gqa_block_cached__near_ridge_kernel_os1:
    s_mov_b32 s46, 16384
    buffer_store_dwordx4 v[36:39], v13, s[36:39], s46 offen sc1
    v_cvt_pk_bf16_f32 v40, v40, v41
    v_cvt_pk_bf16_f32 v41, v42, v43
    v_cvt_pk_bf16_f32 v42, v56, v57
    v_cvt_pk_bf16_f32 v43, v58, v59
    s_cmp_eq_u32 s28, 4
    s_cselect_b32 s47, 0x7ff00000, 0
    v_or_b32 v14, s47, v9
    s_cbranch_scc0 concat_heads__gqa_block_cached__gqa_block_cached__near_ridge_kernel_os2
    v_mov_b32 v80, v40
    v_mov_b32 v81, v41
    v_mov_b32 v82, v42
    v_mov_b32 v83, v43
    concat_heads__gqa_block_cached__gqa_block_cached__near_ridge_kernel_os2:
    s_mov_b32 s46, 32768
    buffer_store_dwordx4 v[40:43], v14, s[36:39], s46 offen sc1
    v_cvt_pk_bf16_f32 v44, v44, v45
    v_cvt_pk_bf16_f32 v45, v46, v47
    v_cvt_pk_bf16_f32 v46, v60, v61
    v_cvt_pk_bf16_f32 v47, v62, v63
    s_cmp_eq_u32 s28, 6
    s_cselect_b32 s47, 0x7ff00000, 0
    v_or_b32 v15, s47, v25
    s_cbranch_scc0 concat_heads__gqa_block_cached__gqa_block_cached__near_ridge_kernel_os3
    v_mov_b32 v80, v44
    v_mov_b32 v81, v45
    v_mov_b32 v82, v46
    v_mov_b32 v83, v47
    concat_heads__gqa_block_cached__gqa_block_cached__near_ridge_kernel_os3:
    s_mov_b32 s46, 49152
    buffer_store_dwordx4 v[44:47], v15, s[36:39], s46 offen sc1
    v_cvt_pk_bf16_f32 v64, v64, v65
    v_cvt_pk_bf16_f32 v65, v66, v67
    v_cvt_pk_bf16_f32 v66, v68, v69
    v_cvt_pk_bf16_f32 v67, v70, v71
    s_mov_b32 s46, 65536
    buffer_store_dwordx4 v[64:67], v10, s[36:39], s46 offen sc1
    v_cvt_pk_bf16_f32 v72, v72, v73
    v_cvt_pk_bf16_f32 v73, v74, v75
    v_cvt_pk_bf16_f32 v74, v76, v77
    v_cvt_pk_bf16_f32 v75, v78, v79
    s_mov_b32 s46, 66560
    buffer_store_dwordx4 v[72:75], v10, s[36:39], s46 offen sc1
    s_nop 7
    v_cvt_pk_bf16_f32 v116, v116, v117
    v_cvt_pk_bf16_f32 v117, v118, v119
    v_cvt_pk_bf16_f32 v118, v132, v133
    v_cvt_pk_bf16_f32 v119, v134, v135
    s_cmp_eq_u32 s28, 1
    s_cselect_b32 s47, 0x7ff00000, 0
    v_or_b32 v12, s47, v9
    s_cbranch_scc0 concat_heads__gqa_block_cached__gqa_block_cached__near_ridge_kernel_os4
    v_mov_b32 v80, v116
    v_mov_b32 v81, v117
    v_mov_b32 v82, v118
    v_mov_b32 v83, v119
    concat_heads__gqa_block_cached__gqa_block_cached__near_ridge_kernel_os4:
    s_mov_b32 s46, 8192
    buffer_store_dwordx4 v[116:119], v12, s[36:39], s46 offen sc1
    v_cvt_pk_bf16_f32 v120, v120, v121
    v_cvt_pk_bf16_f32 v121, v122, v123
    v_cvt_pk_bf16_f32 v122, v136, v137
    v_cvt_pk_bf16_f32 v123, v138, v139
    s_cmp_eq_u32 s28, 3
    s_cselect_b32 s47, 0x7ff00000, 0
    v_or_b32 v13, s47, v9
    s_cbranch_scc0 concat_heads__gqa_block_cached__gqa_block_cached__near_ridge_kernel_os5
    v_mov_b32 v80, v120
    v_mov_b32 v81, v121
    v_mov_b32 v82, v122
    v_mov_b32 v83, v123
    concat_heads__gqa_block_cached__gqa_block_cached__near_ridge_kernel_os5:
    s_mov_b32 s46, 24576
    buffer_store_dwordx4 v[120:123], v13, s[36:39], s46 offen sc1
    v_cvt_pk_bf16_f32 v124, v124, v125
    v_cvt_pk_bf16_f32 v125, v126, v127
    v_cvt_pk_bf16_f32 v126, v140, v141
    v_cvt_pk_bf16_f32 v127, v142, v143
    s_cmp_eq_u32 s28, 5
    s_cselect_b32 s47, 0x7ff00000, 0
    v_or_b32 v14, s47, v9
    s_cbranch_scc0 concat_heads__gqa_block_cached__gqa_block_cached__near_ridge_kernel_os6
    v_mov_b32 v80, v124
    v_mov_b32 v81, v125
    v_mov_b32 v82, v126
    v_mov_b32 v83, v127
    concat_heads__gqa_block_cached__gqa_block_cached__near_ridge_kernel_os6:
    s_mov_b32 s46, 40960
    buffer_store_dwordx4 v[124:127], v14, s[36:39], s46 offen sc1
    v_cvt_pk_bf16_f32 v128, v128, v129
    v_cvt_pk_bf16_f32 v129, v130, v131
    v_cvt_pk_bf16_f32 v130, v144, v145
    v_cvt_pk_bf16_f32 v131, v146, v147
    s_cmp_eq_u32 s28, 7
    s_cselect_b32 s47, 0x7ff00000, 0
    v_or_b32 v15, s47, v25
    s_cbranch_scc0 concat_heads__gqa_block_cached__gqa_block_cached__near_ridge_kernel_os7
    v_mov_b32 v80, v128
    v_mov_b32 v81, v129
    v_mov_b32 v82, v130
    v_mov_b32 v83, v131
    concat_heads__gqa_block_cached__gqa_block_cached__near_ridge_kernel_os7:
    s_mov_b32 s46, 57344
    buffer_store_dwordx4 v[128:131], v15, s[36:39], s46 offen sc1
    s_branch concat_heads__gqa_block_cached__gqa_block_cached__near_ridge_kernel_tail
concat_heads__gqa_block_cached__gqa_block_cached__near_ridge_kernel_p3b:
    ds_read_b64_tr_b16 v[172:173], v3 offset:0
    ds_read_b64_tr_b16 v[174:175], v3 offset:2048
    ds_read_b64_tr_b16 v[176:177], v4 offset:0
    ds_read_b64_tr_b16 v[178:179], v4 offset:2048
    s_waitcnt lgkmcnt(11)
    s_mov_b32 s46, 81920
    buffer_store_dwordx4 v[80:83], v9, s[36:39], s46 offen sc1
    s_waitcnt lgkmcnt(10)
    s_mov_b32 s46, 90112
    buffer_store_dwordx4 v[84:87], v24, s[36:39], s46 offen sc1
    s_waitcnt lgkmcnt(9)
    s_mov_b32 s46, 98304
    buffer_store_dwordx4 v[88:91], v9, s[36:39], s46 offen sc1
    s_waitcnt lgkmcnt(8)
    s_mov_b32 s46, 106496
    buffer_store_dwordx4 v[92:95], v24, s[36:39], s46 offen sc1
    s_waitcnt lgkmcnt(0)
    s_barrier
    v_mfma_f32_16x16x32_bf16 v[32:35], v[172:175], v[196:199], 0
    ds_read_b64_tr_b16 v[184:185], v3 offset:20480
    ds_read_b64_tr_b16 v[186:187], v3 offset:22528
    v_mfma_f32_16x16x32_bf16 v[36:39], v[172:175], v[200:203], 0
    ds_read_b64_tr_b16 v[188:189], v4 offset:20480
    ds_read_b64_tr_b16 v[190:191], v4 offset:22528
    v_mfma_f32_16x16x32_bf16 v[40:43], v[172:175], v[204:207], 0
    ds_read_b128 v[224:227], v21 offset:0
    ds_read_b128 v[228:231], v21 offset:4096
    v_mfma_f32_16x16x32_bf16 v[44:47], v[172:175], v[208:211], 0
    ds_read_b128 v[232:235], v21 offset:8192
    ds_read_b128 v[236:239], v21 offset:12288
    v_mfma_f32_16x16x32_bf16 v[48:51], v[176:179], v[196:199], 0
    s_add_u32 m0, s54, 0
    s_add_u32 s47, s92, 147456
    buffer_load_dwordx4 v26, s[72:75], s47 offen lds
    v_mfma_f32_16x16x32_bf16 v[52:55], v[176:179], v[200:203], 0
    v_mfma_f32_16x16x32_bf16 v[56:59], v[176:179], v[204:207], 0
    s_add_u32 m0, s54, 1024
    s_add_u32 s47, s92, 147456
    buffer_load_dwordx4 v27, s[72:75], s47 offen lds
    v_mfma_f32_16x16x32_bf16 v[60:63], v[176:179], v[208:211], 0
    s_waitcnt lgkmcnt(0)
    s_barrier
    v_mfma_f32_16x16x32_bf16 v[32:35], v[184:187], v[224:227], v[32:35]
    ds_read_b64_tr_b16 v[172:173], v3 offset:40960
    ds_read_b64_tr_b16 v[174:175], v3 offset:43008
    v_mfma_f32_16x16x32_bf16 v[36:39], v[184:187], v[228:231], v[36:39]
    ds_read_b64_tr_b16 v[176:177], v4 offset:40960
    ds_read_b64_tr_b16 v[178:179], v4 offset:43008
    v_mfma_f32_16x16x32_bf16 v[40:43], v[184:187], v[232:235], v[40:43]
    ds_read_b128 v[196:199], v22 offset:0
    ds_read_b128 v[200:203], v22 offset:4096
    v_mfma_f32_16x16x32_bf16 v[44:47], v[184:187], v[236:239], v[44:47]
    ds_read_b128 v[204:207], v22 offset:8192
    ds_read_b128 v[208:211], v22 offset:12288
    v_mfma_f32_16x16x32_bf16 v[48:51], v[188:191], v[224:227], v[48:51]
    s_add_u32 m0, s54, 20480
    s_add_u32 s47, s92, 184320
    buffer_load_dwordx4 v26, s[72:75], s47 offen lds
    v_mfma_f32_16x16x32_bf16 v[52:55], v[188:191], v[228:231], v[52:55]
    v_mfma_f32_16x16x32_bf16 v[56:59], v[188:191], v[232:235], v[56:59]
    s_add_u32 m0, s54, 21504
    s_add_u32 s47, s92, 184320
    buffer_load_dwordx4 v27, s[72:75], s47 offen lds
    v_mfma_f32_16x16x32_bf16 v[60:63], v[188:191], v[236:239], v[60:63]
    s_waitcnt lgkmcnt(0)
    s_barrier
    v_mfma_f32_16x16x32_bf16 v[32:35], v[172:175], v[196:199], v[32:35]
    ds_read_b64_tr_b16 v[184:185], v3 offset:61440
    ds_read_b64_tr_b16 v[186:187], v3 offset:63488
    v_mfma_f32_16x16x32_bf16 v[36:39], v[172:175], v[200:203], v[36:39]
    ds_read_b64_tr_b16 v[188:189], v4 offset:61440
    ds_read_b64_tr_b16 v[190:191], v4 offset:63488
    v_mfma_f32_16x16x32_bf16 v[40:43], v[172:175], v[204:207], v[40:43]
    ds_read_b128 v[224:227], v23 offset:0
    ds_read_b128 v[228:231], v23 offset:4096
    v_mfma_f32_16x16x32_bf16 v[44:47], v[172:175], v[208:211], v[44:47]
    ds_read_b128 v[232:235], v23 offset:8192
    ds_read_b128 v[236:239], v23 offset:12288
    v_mfma_f32_16x16x32_bf16 v[48:51], v[176:179], v[196:199], v[48:51]
    s_add_u32 m0, s54, 40960
    s_add_u32 s47, s92, 221184
    buffer_load_dwordx4 v26, s[72:75], s47 offen lds
    v_mfma_f32_16x16x32_bf16 v[52:55], v[176:179], v[200:203], v[52:55]
    v_mfma_f32_16x16x32_bf16 v[56:59], v[176:179], v[204:207], v[56:59]
    s_add_u32 m0, s54, 41984
    s_add_u32 s47, s92, 221184
    buffer_load_dwordx4 v27, s[72:75], s47 offen lds
    v_mfma_f32_16x16x32_bf16 v[60:63], v[176:179], v[208:211], v[60:63]
    s_waitcnt vmcnt(4) lgkmcnt(0)
    s_barrier
    v_mfma_f32_16x16x32_bf16 v[32:35], v[184:187], v[224:227], v[32:35]
    ds_read_b64_tr_b16 v[172:173], v3 offset:0
    ds_read_b64_tr_b16 v[174:175], v3 offset:2048
    v_mfma_f32_16x16x32_bf16 v[36:39], v[184:187], v[228:231], v[36:39]
    ds_read_b64_tr_b16 v[176:177], v4 offset:0
    ds_read_b64_tr_b16 v[178:179], v4 offset:2048
    v_mfma_f32_16x16x32_bf16 v[40:43], v[184:187], v[232:235], v[40:43]
    ds_read_b128 v[196:199], v20 offset:28672
    ds_read_b128 v[200:203], v20 offset:32768
    v_mfma_f32_16x16x32_bf16 v[44:47], v[184:187], v[236:239], v[44:47]
    ds_read_b128 v[204:207], v20 offset:36864
    ds_read_b128 v[208:211], v20 offset:40960
    v_mfma_f32_16x16x32_bf16 v[48:51], v[188:191], v[224:227], v[48:51]
    s_add_u32 m0, s54, 61440
    s_add_u32 s47, s92, 258048
    buffer_load_dwordx4 v26, s[72:75], s47 offen lds
    v_mfma_f32_16x16x32_bf16 v[52:55], v[188:191], v[228:231], v[52:55]
    v_mfma_f32_16x16x32_bf16 v[56:59], v[188:191], v[232:235], v[56:59]
    s_add_u32 m0, s54, 62464
    s_add_u32 s47, s92, 258048
    buffer_load_dwordx4 v27, s[72:75], s47 offen lds
    v_mfma_f32_16x16x32_bf16 v[60:63], v[188:191], v[236:239], v[60:63]
    s_waitcnt vmcnt(4) lgkmcnt(0)
    s_barrier
    v_mfma_f32_16x16x32_bf16 v[32:35], v[172:175], v[196:199], v[32:35]
    ds_read_b64_tr_b16 v[184:185], v3 offset:20480
    ds_read_b64_tr_b16 v[186:187], v3 offset:22528
    v_mfma_f32_16x16x32_bf16 v[36:39], v[172:175], v[200:203], v[36:39]
    ds_read_b64_tr_b16 v[188:189], v4 offset:20480
    ds_read_b64_tr_b16 v[190:191], v4 offset:22528
    v_mfma_f32_16x16x32_bf16 v[40:43], v[172:175], v[204:207], v[40:43]
    ds_read_b128 v[224:227], v21 offset:28672
    ds_read_b128 v[228:231], v21 offset:32768
    v_mfma_f32_16x16x32_bf16 v[44:47], v[172:175], v[208:211], v[44:47]
    ds_read_b128 v[232:235], v21 offset:36864
    ds_read_b128 v[236:239], v21 offset:40960
    v_mfma_f32_16x16x32_bf16 v[48:51], v[176:179], v[196:199], v[48:51]
    s_add_u32 m0, s54, 0
    s_add_u32 s47, s92, 640
    buffer_load_dwordx4 v26, s[72:75], s47 offen lds
    v_mfma_f32_16x16x32_bf16 v[52:55], v[176:179], v[200:203], v[52:55]
    v_mfma_f32_16x16x32_bf16 v[56:59], v[176:179], v[204:207], v[56:59]
    s_add_u32 m0, s54, 1024
    s_add_u32 s47, s92, 640
    buffer_load_dwordx4 v27, s[72:75], s47 offen lds
    v_mfma_f32_16x16x32_bf16 v[60:63], v[176:179], v[208:211], v[60:63]
    s_waitcnt vmcnt(4) lgkmcnt(0)
    s_barrier
    v_mfma_f32_16x16x32_bf16 v[32:35], v[184:187], v[224:227], v[32:35]
    ds_read_b64_tr_b16 v[172:173], v3 offset:40960
    ds_read_b64_tr_b16 v[174:175], v3 offset:43008
    v_mfma_f32_16x16x32_bf16 v[36:39], v[184:187], v[228:231], v[36:39]
    ds_read_b64_tr_b16 v[176:177], v4 offset:40960
    ds_read_b64_tr_b16 v[178:179], v4 offset:43008
    v_mfma_f32_16x16x32_bf16 v[40:43], v[184:187], v[232:235], v[40:43]
    ds_read_b128 v[196:199], v22 offset:28672
    ds_read_b128 v[200:203], v22 offset:32768
    v_mfma_f32_16x16x32_bf16 v[44:47], v[184:187], v[236:239], v[44:47]
    ds_read_b128 v[204:207], v22 offset:36864
    ds_read_b128 v[208:211], v22 offset:40960
    v_mfma_f32_16x16x32_bf16 v[48:51], v[188:191], v[224:227], v[48:51]
    s_add_u32 m0, s54, 20480
    s_add_u32 s47, s92, 37504
    buffer_load_dwordx4 v26, s[72:75], s47 offen lds
    v_mfma_f32_16x16x32_bf16 v[52:55], v[188:191], v[228:231], v[52:55]
    v_mfma_f32_16x16x32_bf16 v[56:59], v[188:191], v[232:235], v[56:59]
    s_add_u32 m0, s54, 21504
    s_add_u32 s47, s92, 37504
    buffer_load_dwordx4 v27, s[72:75], s47 offen lds
    v_mfma_f32_16x16x32_bf16 v[60:63], v[188:191], v[236:239], v[60:63]
    s_waitcnt vmcnt(4) lgkmcnt(0)
    s_barrier
    v_mfma_f32_16x16x32_bf16 v[32:35], v[172:175], v[196:199], v[32:35]
    ds_read_b64_tr_b16 v[184:185], v3 offset:61440
    ds_read_b64_tr_b16 v[186:187], v3 offset:63488
    v_mfma_f32_16x16x32_bf16 v[36:39], v[172:175], v[200:203], v[36:39]
    ds_read_b64_tr_b16 v[188:189], v4 offset:61440
    ds_read_b64_tr_b16 v[190:191], v4 offset:63488
    v_mfma_f32_16x16x32_bf16 v[40:43], v[172:175], v[204:207], v[40:43]
    ds_read_b128 v[224:227], v23 offset:28672
    ds_read_b128 v[228:231], v23 offset:32768
    v_mfma_f32_16x16x32_bf16 v[44:47], v[172:175], v[208:211], v[44:47]
    ds_read_b128 v[232:235], v23 offset:36864
    ds_read_b128 v[236:239], v23 offset:40960
    v_mfma_f32_16x16x32_bf16 v[48:51], v[176:179], v[196:199], v[48:51]
    s_add_u32 m0, s54, 40960
    s_add_u32 s47, s92, 74368
    buffer_load_dwordx4 v26, s[72:75], s47 offen lds
    v_mfma_f32_16x16x32_bf16 v[52:55], v[176:179], v[200:203], v[52:55]
    v_mfma_f32_16x16x32_bf16 v[56:59], v[176:179], v[204:207], v[56:59]
    s_add_u32 m0, s54, 41984
    s_add_u32 s47, s92, 74368
    buffer_load_dwordx4 v27, s[72:75], s47 offen lds
    v_mfma_f32_16x16x32_bf16 v[60:63], v[176:179], v[208:211], v[60:63]
    s_waitcnt vmcnt(4) lgkmcnt(0)
    s_barrier
    v_mfma_f32_16x16x32_bf16 v[32:35], v[184:187], v[224:227], v[32:35]
    ds_read_b64_tr_b16 v[172:173], v3 offset:0
    ds_read_b64_tr_b16 v[174:175], v3 offset:2048
    v_mfma_f32_16x16x32_bf16 v[36:39], v[184:187], v[228:231], v[36:39]
    ds_read_b64_tr_b16 v[176:177], v4 offset:0
    ds_read_b64_tr_b16 v[178:179], v4 offset:2048
    v_mfma_f32_16x16x32_bf16 v[40:43], v[184:187], v[232:235], v[40:43]
    ds_read_b128 v[196:199], v20 offset:0
    ds_read_b128 v[200:203], v20 offset:4096
    v_mfma_f32_16x16x32_bf16 v[44:47], v[184:187], v[236:239], v[44:47]
    ds_read_b128 v[204:207], v20 offset:8192
    ds_read_b128 v[208:211], v20 offset:12288
    v_mfma_f32_16x16x32_bf16 v[48:51], v[188:191], v[224:227], v[48:51]
    s_add_u32 m0, s54, 61440
    s_add_u32 s47, s92, 111232
    buffer_load_dwordx4 v26, s[72:75], s47 offen lds
    v_mfma_f32_16x16x32_bf16 v[52:55], v[188:191], v[228:231], v[52:55]
    v_mfma_f32_16x16x32_bf16 v[56:59], v[188:191], v[232:235], v[56:59]
    s_add_u32 m0, s54, 62464
    s_add_u32 s47, s92, 111232
    buffer_load_dwordx4 v27, s[72:75], s47 offen lds
    v_mfma_f32_16x16x32_bf16 v[60:63], v[188:191], v[236:239], v[60:63]
    s_waitcnt vmcnt(4) lgkmcnt(0)
    s_barrier
    v_mfma_f32_16x16x32_bf16 v[116:119], v[172:175], v[196:199], 0
    ds_read_b64_tr_b16 v[184:185], v3 offset:20480
    ds_read_b64_tr_b16 v[186:187], v3 offset:22528
    v_mfma_f32_16x16x32_bf16 v[120:123], v[172:175], v[200:203], 0
    ds_read_b64_tr_b16 v[188:189], v4 offset:20480
    ds_read_b64_tr_b16 v[190:191], v4 offset:22528
    v_mfma_f32_16x16x32_bf16 v[124:127], v[172:175], v[204:207], 0
    ds_read_b128 v[224:227], v21 offset:0
    ds_read_b128 v[228:231], v21 offset:4096
    v_mfma_f32_16x16x32_bf16 v[128:131], v[172:175], v[208:211], 0
    ds_read_b128 v[232:235], v21 offset:8192
    ds_read_b128 v[236:239], v21 offset:12288
    v_mfma_f32_16x16x32_bf16 v[132:135], v[176:179], v[196:199], 0
    s_add_u32 m0, s54, 0
    s_add_u32 s47, s92, 148096
    buffer_load_dwordx4 v26, s[72:75], s47 offen lds
    v_mfma_f32_16x16x32_bf16 v[136:139], v[176:179], v[200:203], 0
    v_mfma_f32_16x16x32_bf16 v[140:143], v[176:179], v[204:207], 0
    s_add_u32 m0, s54, 1024
    s_add_u32 s47, s92, 148096
    buffer_load_dwordx4 v27, s[72:75], s47 offen lds
    v_mfma_f32_16x16x32_bf16 v[144:147], v[176:179], v[208:211], 0
    s_waitcnt vmcnt(4) lgkmcnt(0)
    s_barrier
    v_mfma_f32_16x16x32_bf16 v[116:119], v[184:187], v[224:227], v[116:119]
    ds_read_b64_tr_b16 v[172:173], v3 offset:40960
    ds_read_b64_tr_b16 v[174:175], v3 offset:43008
    v_mfma_f32_16x16x32_bf16 v[120:123], v[184:187], v[228:231], v[120:123]
    ds_read_b64_tr_b16 v[176:177], v4 offset:40960
    ds_read_b64_tr_b16 v[178:179], v4 offset:43008
    v_mfma_f32_16x16x32_bf16 v[124:127], v[184:187], v[232:235], v[124:127]
    ds_read_b128 v[196:199], v22 offset:0
    ds_read_b128 v[200:203], v22 offset:4096
    v_mfma_f32_16x16x32_bf16 v[128:131], v[184:187], v[236:239], v[128:131]
    ds_read_b128 v[204:207], v22 offset:8192
    ds_read_b128 v[208:211], v22 offset:12288
    v_mfma_f32_16x16x32_bf16 v[132:135], v[188:191], v[224:227], v[132:135]
    s_add_u32 m0, s54, 20480
    s_add_u32 s47, s92, 184960
    buffer_load_dwordx4 v26, s[72:75], s47 offen lds
    v_mfma_f32_16x16x32_bf16 v[136:139], v[188:191], v[228:231], v[136:139]
    v_mfma_f32_16x16x32_bf16 v[140:143], v[188:191], v[232:235], v[140:143]
    s_add_u32 m0, s54, 21504
    s_add_u32 s47, s92, 184960
    buffer_load_dwordx4 v27, s[72:75], s47 offen lds
    v_mfma_f32_16x16x32_bf16 v[144:147], v[188:191], v[236:239], v[144:147]
    s_waitcnt vmcnt(4) lgkmcnt(0)
    s_barrier
    v_mfma_f32_16x16x32_bf16 v[116:119], v[172:175], v[196:199], v[116:119]
    ds_read_b64_tr_b16 v[184:185], v3 offset:61440
    ds_read_b64_tr_b16 v[186:187], v3 offset:63488
    v_mfma_f32_16x16x32_bf16 v[120:123], v[172:175], v[200:203], v[120:123]
    ds_read_b64_tr_b16 v[188:189], v4 offset:61440
    ds_read_b64_tr_b16 v[190:191], v4 offset:63488
    v_mfma_f32_16x16x32_bf16 v[124:127], v[172:175], v[204:207], v[124:127]
    ds_read_b128 v[224:227], v23 offset:0
    ds_read_b128 v[228:231], v23 offset:4096
    v_mfma_f32_16x16x32_bf16 v[128:131], v[172:175], v[208:211], v[128:131]
    ds_read_b128 v[232:235], v23 offset:8192
    ds_read_b128 v[236:239], v23 offset:12288
    v_mfma_f32_16x16x32_bf16 v[132:135], v[176:179], v[196:199], v[132:135]
    s_add_u32 m0, s54, 40960
    s_add_u32 s47, s92, 221824
    buffer_load_dwordx4 v26, s[72:75], s47 offen lds
    v_mfma_f32_16x16x32_bf16 v[136:139], v[176:179], v[200:203], v[136:139]
    v_mfma_f32_16x16x32_bf16 v[140:143], v[176:179], v[204:207], v[140:143]
    s_add_u32 m0, s54, 41984
    s_add_u32 s47, s92, 221824
    buffer_load_dwordx4 v27, s[72:75], s47 offen lds
    v_mfma_f32_16x16x32_bf16 v[144:147], v[176:179], v[208:211], v[144:147]
    s_waitcnt vmcnt(4) lgkmcnt(0)
    s_barrier
    v_mfma_f32_16x16x32_bf16 v[116:119], v[184:187], v[224:227], v[116:119]
    ds_read_b64_tr_b16 v[172:173], v3 offset:0
    ds_read_b64_tr_b16 v[174:175], v3 offset:2048
    v_mfma_f32_16x16x32_bf16 v[120:123], v[184:187], v[228:231], v[120:123]
    ds_read_b64_tr_b16 v[176:177], v4 offset:0
    ds_read_b64_tr_b16 v[178:179], v4 offset:2048
    v_mfma_f32_16x16x32_bf16 v[124:127], v[184:187], v[232:235], v[124:127]
    ds_read_b128 v[196:199], v20 offset:28672
    ds_read_b128 v[200:203], v20 offset:32768
    v_mfma_f32_16x16x32_bf16 v[128:131], v[184:187], v[236:239], v[128:131]
    ds_read_b128 v[204:207], v20 offset:36864
    ds_read_b128 v[208:211], v20 offset:40960
    v_mfma_f32_16x16x32_bf16 v[132:135], v[188:191], v[224:227], v[132:135]
    s_add_u32 m0, s54, 61440
    s_add_u32 s47, s92, 258688
    buffer_load_dwordx4 v26, s[72:75], s47 offen lds
    v_mfma_f32_16x16x32_bf16 v[136:139], v[188:191], v[228:231], v[136:139]
    v_mfma_f32_16x16x32_bf16 v[140:143], v[188:191], v[232:235], v[140:143]
    s_add_u32 m0, s54, 62464
    s_add_u32 s47, s92, 258688
    buffer_load_dwordx4 v27, s[72:75], s47 offen lds
    v_mfma_f32_16x16x32_bf16 v[144:147], v[188:191], v[236:239], v[144:147]
    s_waitcnt vmcnt(4) lgkmcnt(0)
    s_barrier
    s_add_u32 m0, s27, 92160
    s_add_u32 s47, s26, 81920
    buffer_load_dwordx4 v9, s[88:91], s47 offen sc1 lds
    s_add_u32 m0, s52, 83968
    s_add_u32 s47, s26, 90112
    buffer_load_dwordx4 v25, s[88:91], s47 offen sc1 lds
    s_add_u32 m0, s27, 120832
    s_add_u32 s47, s26, 98304
    buffer_load_dwordx4 v9, s[88:91], s47 offen sc1 lds
    s_add_u32 m0, s52, 79872
    s_add_u32 s47, s26, 106496
    buffer_load_dwordx4 v25, s[88:91], s47 offen sc1 lds
    s_add_u32 s72, s72, s24
    s_addc_u32 s73, s73, s25
    v_mfma_f32_16x16x32_bf16 v[116:119], v[172:175], v[196:199], v[116:119]
    ds_read_b64_tr_b16 v[184:185], v3 offset:20480
    ds_read_b64_tr_b16 v[186:187], v3 offset:22528
    v_mfma_f32_16x16x32_bf16 v[120:123], v[172:175], v[200:203], v[120:123]
    ds_read_b64_tr_b16 v[188:189], v4 offset:20480
    ds_read_b64_tr_b16 v[190:191], v4 offset:22528
    v_mfma_f32_16x16x32_bf16 v[124:127], v[172:175], v[204:207], v[124:127]
    ds_read_b128 v[224:227], v21 offset:28672
    ds_read_b128 v[228:231], v21 offset:32768
    v_mfma_f32_16x16x32_bf16 v[128:131], v[172:175], v[208:211], v[128:131]
    ds_read_b128 v[232:235], v21 offset:36864
    ds_read_b128 v[236:239], v21 offset:40960
    v_mfma_f32_16x16x32_bf16 v[132:135], v[176:179], v[196:199], v[132:135]
    s_add_u32 m0, s54, 0
    s_add_u32 s47, s92, 0
    buffer_load_dwordx4 v26, s[72:75], s47 offen lds
    v_mfma_f32_16x16x32_bf16 v[136:139], v[176:179], v[200:203], v[136:139]
    v_mfma_f32_16x16x32_bf16 v[140:143], v[176:179], v[204:207], v[140:143]
    s_add_u32 m0, s54, 1024
    s_add_u32 s47, s92, 0
    buffer_load_dwordx4 v27, s[72:75], s47 offen lds
    v_mfma_f32_16x16x32_bf16 v[144:147], v[176:179], v[208:211], v[144:147]
    s_waitcnt vmcnt(8) lgkmcnt(0)
    s_barrier
    v_mfma_f32_16x16x32_bf16 v[116:119], v[184:187], v[224:227], v[116:119]
    ds_read_b64_tr_b16 v[172:173], v3 offset:40960
    ds_read_b64_tr_b16 v[174:175], v3 offset:43008
    v_mfma_f32_16x16x32_bf16 v[120:123], v[184:187], v[228:231], v[120:123]
    ds_read_b64_tr_b16 v[176:177], v4 offset:40960
    ds_read_b64_tr_b16 v[178:179], v4 offset:43008
    v_mfma_f32_16x16x32_bf16 v[124:127], v[184:187], v[232:235], v[124:127]
    ds_read_b128 v[196:199], v22 offset:28672
    ds_read_b128 v[200:203], v22 offset:32768
    v_mfma_f32_16x16x32_bf16 v[128:131], v[184:187], v[236:239], v[128:131]
    ds_read_b128 v[204:207], v22 offset:36864
    ds_read_b128 v[208:211], v22 offset:40960
    v_mfma_f32_16x16x32_bf16 v[132:135], v[188:191], v[224:227], v[132:135]
    s_add_u32 m0, s54, 20480
    s_add_u32 s47, s92, 36864
    buffer_load_dwordx4 v26, s[72:75], s47 offen lds
    v_mfma_f32_16x16x32_bf16 v[136:139], v[188:191], v[228:231], v[136:139]
    v_mfma_f32_16x16x32_bf16 v[140:143], v[188:191], v[232:235], v[140:143]
    s_add_u32 m0, s54, 21504
    s_add_u32 s47, s92, 36864
    buffer_load_dwordx4 v27, s[72:75], s47 offen lds
    v_mfma_f32_16x16x32_bf16 v[144:147], v[188:191], v[236:239], v[144:147]
    s_waitcnt vmcnt(8) lgkmcnt(0)
    s_barrier
    v_mfma_f32_16x16x32_bf16 v[116:119], v[172:175], v[196:199], v[116:119]
    ds_read_b64_tr_b16 v[184:185], v3 offset:61440
    ds_read_b64_tr_b16 v[186:187], v3 offset:63488
    v_mfma_f32_16x16x32_bf16 v[120:123], v[172:175], v[200:203], v[120:123]
    ds_read_b64_tr_b16 v[188:189], v4 offset:61440
    ds_read_b64_tr_b16 v[190:191], v4 offset:63488
    v_mfma_f32_16x16x32_bf16 v[124:127], v[172:175], v[204:207], v[124:127]
    ds_read_b128 v[224:227], v23 offset:28672
    ds_read_b128 v[228:231], v23 offset:32768
    v_mfma_f32_16x16x32_bf16 v[128:131], v[172:175], v[208:211], v[128:131]
    ds_read_b128 v[232:235], v23 offset:36864
    ds_read_b128 v[236:239], v23 offset:40960
    v_mfma_f32_16x16x32_bf16 v[132:135], v[176:179], v[196:199], v[132:135]
    s_add_u32 m0, s54, 40960
    s_add_u32 s47, s92, 73728
    buffer_load_dwordx4 v26, s[72:75], s47 offen lds
    v_mfma_f32_16x16x32_bf16 v[136:139], v[176:179], v[200:203], v[136:139]
    v_mfma_f32_16x16x32_bf16 v[140:143], v[176:179], v[204:207], v[140:143]
    s_add_u32 m0, s54, 41984
    s_add_u32 s47, s92, 73728
    buffer_load_dwordx4 v27, s[72:75], s47 offen lds
    v_mfma_f32_16x16x32_bf16 v[144:147], v[176:179], v[208:211], v[144:147]
    s_waitcnt vmcnt(4) lgkmcnt(0)
    s_barrier
    v_add_u32 v20, s23, v20
    v_add_u32 v21, s23, v21
    v_add_u32 v22, s23, v22
    v_add_u32 v23, s23, v23
    v_mfma_f32_16x16x32_bf16 v[116:119], v[184:187], v[224:227], v[116:119]
    ds_read_b64_tr_b16 v[172:173], v3 offset:0
    ds_read_b64_tr_b16 v[174:175], v3 offset:2048
    v_mfma_f32_16x16x32_bf16 v[120:123], v[184:187], v[228:231], v[120:123]
    ds_read_b64_tr_b16 v[176:177], v4 offset:0
    ds_read_b64_tr_b16 v[178:179], v4 offset:2048
    v_mfma_f32_16x16x32_bf16 v[124:127], v[184:187], v[232:235], v[124:127]
    ds_read_b128 v[196:199], v20 offset:8192
    ds_read_b128 v[200:203], v20 offset:12288
    v_mfma_f32_16x16x32_bf16 v[128:131], v[184:187], v[236:239], v[128:131]
    ds_read_b128 v[204:207], v20 offset:16384
    ds_read_b128 v[208:211], v20 offset:4096
    v_mfma_f32_16x16x32_bf16 v[132:135], v[188:191], v[224:227], v[132:135]
    s_add_u32 m0, s54, 61440
    s_add_u32 s47, s92, 110592
    buffer_load_dwordx4 v26, s[72:75], s47 offen lds
    v_mfma_f32_16x16x32_bf16 v[136:139], v[188:191], v[228:231], v[136:139]
    v_mfma_f32_16x16x32_bf16 v[140:143], v[188:191], v[232:235], v[140:143]
    s_add_u32 m0, s54, 62464
    s_add_u32 s47, s92, 110592
    buffer_load_dwordx4 v27, s[72:75], s47 offen lds
    v_mfma_f32_16x16x32_bf16 v[144:147], v[188:191], v[236:239], v[144:147]
    s_waitcnt vmcnt(4) lgkmcnt(0)
    s_barrier
    v_mfma_f32_16x16x32_bf16 v[32:35], v[172:175], v[196:199], v[32:35]
    ds_read_b64_tr_b16 v[184:185], v3 offset:20480
    ds_read_b64_tr_b16 v[186:187], v3 offset:22528
    v_mfma_f32_16x16x32_bf16 v[36:39], v[172:175], v[200:203], v[36:39]
    ds_read_b64_tr_b16 v[188:189], v4 offset:20480
    ds_read_b64_tr_b16 v[190:191], v4 offset:22528
    v_mfma_f32_16x16x32_bf16 v[40:43], v[172:175], v[204:207], v[40:43]
    ds_read_b128 v[224:227], v21 offset:8192
    ds_read_b128 v[228:231], v21 offset:12288
    v_mfma_f32_16x16x32_bf16 v[44:47], v[172:175], v[208:211], v[44:47]
    ds_read_b128 v[232:235], v21 offset:16384
    ds_read_b128 v[236:239], v21 offset:4096
    v_mfma_f32_16x16x32_bf16 v[48:51], v[176:179], v[196:199], v[48:51]
    s_add_u32 m0, s54, 0
    s_add_u32 s47, s92, 147456
    buffer_load_dwordx4 v26, s[72:75], s47 offen lds
    v_mfma_f32_16x16x32_bf16 v[52:55], v[176:179], v[200:203], v[52:55]
    v_mfma_f32_16x16x32_bf16 v[56:59], v[176:179], v[204:207], v[56:59]
    s_add_u32 m0, s54, 1024
    s_add_u32 s47, s92, 147456
    buffer_load_dwordx4 v27, s[72:75], s47 offen lds
    v_mfma_f32_16x16x32_bf16 v[60:63], v[176:179], v[208:211], v[60:63]
    s_waitcnt vmcnt(4) lgkmcnt(0)
    s_barrier
    v_mfma_f32_16x16x32_bf16 v[32:35], v[184:187], v[224:227], v[32:35]
    ds_read_b64_tr_b16 v[172:173], v3 offset:40960
    ds_read_b64_tr_b16 v[174:175], v3 offset:43008
    v_mfma_f32_16x16x32_bf16 v[36:39], v[184:187], v[228:231], v[36:39]
    ds_read_b64_tr_b16 v[176:177], v4 offset:40960
    ds_read_b64_tr_b16 v[178:179], v4 offset:43008
    v_mfma_f32_16x16x32_bf16 v[40:43], v[184:187], v[232:235], v[40:43]
    ds_read_b128 v[196:199], v22 offset:8192
    ds_read_b128 v[200:203], v22 offset:12288
    v_mfma_f32_16x16x32_bf16 v[44:47], v[184:187], v[236:239], v[44:47]
    ds_read_b128 v[204:207], v22 offset:16384
    ds_read_b128 v[208:211], v22 offset:4096
    v_mfma_f32_16x16x32_bf16 v[48:51], v[188:191], v[224:227], v[48:51]
    s_add_u32 m0, s54, 20480
    s_add_u32 s47, s92, 184320
    buffer_load_dwordx4 v26, s[72:75], s47 offen lds
    v_mfma_f32_16x16x32_bf16 v[52:55], v[188:191], v[228:231], v[52:55]
    v_mfma_f32_16x16x32_bf16 v[56:59], v[188:191], v[232:235], v[56:59]
    s_add_u32 m0, s54, 21504
    s_add_u32 s47, s92, 184320
    buffer_load_dwordx4 v27, s[72:75], s47 offen lds
    v_mfma_f32_16x16x32_bf16 v[60:63], v[188:191], v[236:239], v[60:63]
    s_waitcnt vmcnt(4) lgkmcnt(0)
    s_barrier
    v_mfma_f32_16x16x32_bf16 v[32:35], v[172:175], v[196:199], v[32:35]
    ds_read_b64_tr_b16 v[184:185], v3 offset:61440
    ds_read_b64_tr_b16 v[186:187], v3 offset:63488
    v_mfma_f32_16x16x32_bf16 v[36:39], v[172:175], v[200:203], v[36:39]
    ds_read_b64_tr_b16 v[188:189], v4 offset:61440
    ds_read_b64_tr_b16 v[190:191], v4 offset:63488
    v_mfma_f32_16x16x32_bf16 v[40:43], v[172:175], v[204:207], v[40:43]
    ds_read_b128 v[224:227], v23 offset:8192
    ds_read_b128 v[228:231], v23 offset:12288
    v_mfma_f32_16x16x32_bf16 v[44:47], v[172:175], v[208:211], v[44:47]
    ds_read_b128 v[232:235], v23 offset:16384
    ds_read_b128 v[236:239], v23 offset:4096
    v_mfma_f32_16x16x32_bf16 v[48:51], v[176:179], v[196:199], v[48:51]
    s_add_u32 m0, s54, 40960
    s_add_u32 s47, s92, 221184
    buffer_load_dwordx4 v26, s[72:75], s47 offen lds
    v_mfma_f32_16x16x32_bf16 v[52:55], v[176:179], v[200:203], v[52:55]
    v_mfma_f32_16x16x32_bf16 v[56:59], v[176:179], v[204:207], v[56:59]
    s_add_u32 m0, s54, 41984
    s_add_u32 s47, s92, 221184
    buffer_load_dwordx4 v27, s[72:75], s47 offen lds
    v_mfma_f32_16x16x32_bf16 v[60:63], v[176:179], v[208:211], v[60:63]
    s_waitcnt vmcnt(4) lgkmcnt(0)
    s_barrier
    v_mfma_f32_16x16x32_bf16 v[32:35], v[184:187], v[224:227], v[32:35]
    ds_read_b64_tr_b16 v[172:173], v3 offset:0
    ds_read_b64_tr_b16 v[174:175], v3 offset:2048
    v_mfma_f32_16x16x32_bf16 v[36:39], v[184:187], v[228:231], v[36:39]
    ds_read_b64_tr_b16 v[176:177], v4 offset:0
    ds_read_b64_tr_b16 v[178:179], v4 offset:2048
    v_mfma_f32_16x16x32_bf16 v[40:43], v[184:187], v[232:235], v[40:43]
    ds_read_b128 v[196:199], v20 offset:36864
    ds_read_b128 v[200:203], v20 offset:40960
    v_mfma_f32_16x16x32_bf16 v[44:47], v[184:187], v[236:239], v[44:47]
    ds_read_b128 v[204:207], v20 offset:45056
    ds_read_b128 v[208:211], v20 offset:0
    v_mfma_f32_16x16x32_bf16 v[48:51], v[188:191], v[224:227], v[48:51]
    s_add_u32 m0, s54, 61440
    s_add_u32 s47, s92, 258048
    buffer_load_dwordx4 v26, s[72:75], s47 offen lds
    v_mfma_f32_16x16x32_bf16 v[52:55], v[188:191], v[228:231], v[52:55]
    v_mfma_f32_16x16x32_bf16 v[56:59], v[188:191], v[232:235], v[56:59]
    s_add_u32 m0, s54, 62464
    s_add_u32 s47, s92, 258048
    buffer_load_dwordx4 v27, s[72:75], s47 offen lds
    v_mfma_f32_16x16x32_bf16 v[60:63], v[188:191], v[236:239], v[60:63]
    s_waitcnt vmcnt(4) lgkmcnt(0)
    s_barrier
    v_mov_b32 v80, 0
    v_mov_b32 v81, 0
    v_mov_b32 v82, 0
    v_mov_b32 v83, 0
    v_mfma_f32_16x16x32_bf16 v[32:35], v[172:175], v[196:199], v[32:35]
    ds_read_b64_tr_b16 v[184:185], v3 offset:20480
    ds_read_b64_tr_b16 v[186:187], v3 offset:22528
    v_mfma_f32_16x16x32_bf16 v[36:39], v[172:175], v[200:203], v[36:39]
    ds_read_b64_tr_b16 v[188:189], v4 offset:20480
    ds_read_b64_tr_b16 v[190:191], v4 offset:22528
    v_mfma_f32_16x16x32_bf16 v[40:43], v[172:175], v[204:207], v[40:43]
    ds_read_b128 v[224:227], v21 offset:36864
    ds_read_b128 v[228:231], v21 offset:40960
    v_mfma_f32_16x16x32_bf16 v[44:47], v[172:175], v[208:211], v[44:47]
    ds_read_b128 v[232:235], v21 offset:45056
    ds_read_b128 v[236:239], v21 offset:0
    v_mfma_f32_16x16x32_bf16 v[48:51], v[176:179], v[196:199], v[48:51]
    s_add_u32 m0, s54, 0
    s_add_u32 s47, s92, 640
    buffer_load_dwordx4 v26, s[72:75], s47 offen lds
    v_mfma_f32_16x16x32_bf16 v[52:55], v[176:179], v[200:203], v[52:55]
    v_mfma_f32_16x16x32_bf16 v[56:59], v[176:179], v[204:207], v[56:59]
    s_add_u32 m0, s54, 1024
    s_add_u32 s47, s92, 640
    buffer_load_dwordx4 v27, s[72:75], s47 offen lds
    v_mfma_f32_16x16x32_bf16 v[60:63], v[176:179], v[208:211], v[60:63]
    s_waitcnt vmcnt(4) lgkmcnt(0)
    s_barrier
    v_mfma_f32_16x16x32_bf16 v[32:35], v[184:187], v[224:227], v[32:35]
    ds_read_b64_tr_b16 v[172:173], v3 offset:40960
    ds_read_b64_tr_b16 v[174:175], v3 offset:43008
    v_mfma_f32_16x16x32_bf16 v[36:39], v[184:187], v[228:231], v[36:39]
    ds_read_b64_tr_b16 v[176:177], v4 offset:40960
    ds_read_b64_tr_b16 v[178:179], v4 offset:43008
    v_mfma_f32_16x16x32_bf16 v[40:43], v[184:187], v[232:235], v[40:43]
    ds_read_b128 v[196:199], v22 offset:36864
    ds_read_b128 v[200:203], v22 offset:40960
    v_mfma_f32_16x16x32_bf16 v[44:47], v[184:187], v[236:239], v[44:47]
    ds_read_b128 v[204:207], v22 offset:45056
    ds_read_b128 v[208:211], v22 offset:0
    v_mfma_f32_16x16x32_bf16 v[48:51], v[188:191], v[224:227], v[48:51]
    s_add_u32 m0, s54, 20480
    s_add_u32 s47, s92, 37504
    buffer_load_dwordx4 v26, s[72:75], s47 offen lds
    v_mfma_f32_16x16x32_bf16 v[52:55], v[188:191], v[228:231], v[52:55]
    v_mfma_f32_16x16x32_bf16 v[56:59], v[188:191], v[232:235], v[56:59]
    s_add_u32 m0, s54, 21504
    s_add_u32 s47, s92, 37504
    buffer_load_dwordx4 v27, s[72:75], s47 offen lds
    v_mfma_f32_16x16x32_bf16 v[60:63], v[188:191], v[236:239], v[60:63]
    s_waitcnt vmcnt(4) lgkmcnt(0)
    s_barrier
    v_mfma_f32_16x16x32_bf16 v[32:35], v[172:175], v[196:199], v[32:35]
    ds_read_b64_tr_b16 v[184:185], v3 offset:61440
    ds_read_b64_tr_b16 v[186:187], v3 offset:63488
    v_mfma_f32_16x16x32_bf16 v[36:39], v[172:175], v[200:203], v[36:39]
    ds_read_b64_tr_b16 v[188:189], v4 offset:61440
    ds_read_b64_tr_b16 v[190:191], v4 offset:63488
    v_mfma_f32_16x16x32_bf16 v[40:43], v[172:175], v[204:207], v[40:43]
    ds_read_b128 v[224:227], v23 offset:36864
    ds_read_b128 v[228:231], v23 offset:40960
    v_mfma_f32_16x16x32_bf16 v[44:47], v[172:175], v[208:211], v[44:47]
    ds_read_b128 v[232:235], v23 offset:45056
    ds_read_b128 v[236:239], v23 offset:0
    v_mfma_f32_16x16x32_bf16 v[48:51], v[176:179], v[196:199], v[48:51]
    s_add_u32 m0, s54, 40960
    s_add_u32 s47, s92, 74368
    buffer_load_dwordx4 v26, s[72:75], s47 offen lds
    v_mfma_f32_16x16x32_bf16 v[52:55], v[176:179], v[200:203], v[52:55]
    v_mfma_f32_16x16x32_bf16 v[56:59], v[176:179], v[204:207], v[56:59]
    s_add_u32 m0, s54, 41984
    s_add_u32 s47, s92, 74368
    buffer_load_dwordx4 v27, s[72:75], s47 offen lds
    v_mfma_f32_16x16x32_bf16 v[60:63], v[176:179], v[208:211], v[60:63]
    s_waitcnt vmcnt(4) lgkmcnt(0)
    s_barrier
    v_mfma_f32_16x16x32_bf16 v[32:35], v[184:187], v[224:227], v[32:35]
    ds_read_b64_tr_b16 v[172:173], v3 offset:0
    ds_read_b64_tr_b16 v[174:175], v3 offset:2048
    v_mfma_f32_16x16x32_bf16 v[36:39], v[184:187], v[228:231], v[36:39]
    ds_read_b64_tr_b16 v[176:177], v4 offset:0
    ds_read_b64_tr_b16 v[178:179], v4 offset:2048
    v_mfma_f32_16x16x32_bf16 v[40:43], v[184:187], v[232:235], v[40:43]
    ds_read_b128 v[196:199], v20 offset:8192
    ds_read_b128 v[200:203], v20 offset:12288
    v_mfma_f32_16x16x32_bf16 v[44:47], v[184:187], v[236:239], v[44:47]
    ds_read_b128 v[204:207], v20 offset:16384
    ds_read_b128 v[208:211], v20 offset:4096
    v_mfma_f32_16x16x32_bf16 v[48:51], v[188:191], v[224:227], v[48:51]
    s_add_u32 m0, s54, 61440
    s_add_u32 s47, s92, 111232
    buffer_load_dwordx4 v26, s[72:75], s47 offen lds
    v_mfma_f32_16x16x32_bf16 v[52:55], v[188:191], v[228:231], v[52:55]
    v_mfma_f32_16x16x32_bf16 v[56:59], v[188:191], v[232:235], v[56:59]
    s_add_u32 m0, s54, 62464
    s_add_u32 s47, s92, 111232
    buffer_load_dwordx4 v27, s[72:75], s47 offen lds
    v_mfma_f32_16x16x32_bf16 v[60:63], v[188:191], v[236:239], v[60:63]
    s_waitcnt vmcnt(4) lgkmcnt(0)
    s_barrier
    v_mfma_f32_16x16x32_bf16 v[116:119], v[172:175], v[196:199], v[116:119]
    ds_read_b64_tr_b16 v[184:185], v3 offset:20480
    ds_read_b64_tr_b16 v[186:187], v3 offset:22528
    v_mfma_f32_16x16x32_bf16 v[120:123], v[172:175], v[200:203], v[120:123]
    ds_read_b64_tr_b16 v[188:189], v4 offset:20480
    ds_read_b64_tr_b16 v[190:191], v4 offset:22528
    v_mfma_f32_16x16x32_bf16 v[124:127], v[172:175], v[204:207], v[124:127]
    ds_read_b128 v[224:227], v21 offset:8192
    ds_read_b128 v[228:231], v21 offset:12288
    v_mfma_f32_16x16x32_bf16 v[128:131], v[172:175], v[208:211], v[128:131]
    ds_read_b128 v[232:235], v21 offset:16384
    ds_read_b128 v[236:239], v21 offset:4096
    v_mfma_f32_16x16x32_bf16 v[132:135], v[176:179], v[196:199], v[132:135]
    s_add_u32 m0, s54, 0
    s_add_u32 s47, s92, 148096
    buffer_load_dwordx4 v26, s[72:75], s47 offen lds
    v_mfma_f32_16x16x32_bf16 v[136:139], v[176:179], v[200:203], v[136:139]
    v_mfma_f32_16x16x32_bf16 v[140:143], v[176:179], v[204:207], v[140:143]
    s_add_u32 m0, s54, 1024
    s_add_u32 s47, s92, 148096
    buffer_load_dwordx4 v27, s[72:75], s47 offen lds
    v_mfma_f32_16x16x32_bf16 v[144:147], v[176:179], v[208:211], v[144:147]
    s_waitcnt vmcnt(4) lgkmcnt(0)
    s_barrier
    v_mfma_f32_16x16x32_bf16 v[116:119], v[184:187], v[224:227], v[116:119]
    ds_read_b64_tr_b16 v[172:173], v3 offset:40960
    ds_read_b64_tr_b16 v[174:175], v3 offset:43008
    v_mfma_f32_16x16x32_bf16 v[120:123], v[184:187], v[228:231], v[120:123]
    ds_read_b64_tr_b16 v[176:177], v4 offset:40960
    ds_read_b64_tr_b16 v[178:179], v4 offset:43008
    v_mfma_f32_16x16x32_bf16 v[124:127], v[184:187], v[232:235], v[124:127]
    ds_read_b128 v[196:199], v22 offset:8192
    ds_read_b128 v[200:203], v22 offset:12288
    v_mfma_f32_16x16x32_bf16 v[128:131], v[184:187], v[236:239], v[128:131]
    ds_read_b128 v[204:207], v22 offset:16384
    ds_read_b128 v[208:211], v22 offset:4096
    v_mfma_f32_16x16x32_bf16 v[132:135], v[188:191], v[224:227], v[132:135]
    s_add_u32 m0, s54, 20480
    s_add_u32 s47, s92, 184960
    buffer_load_dwordx4 v26, s[72:75], s47 offen lds
    v_mfma_f32_16x16x32_bf16 v[136:139], v[188:191], v[228:231], v[136:139]
    v_mfma_f32_16x16x32_bf16 v[140:143], v[188:191], v[232:235], v[140:143]
    s_add_u32 m0, s54, 21504
    s_add_u32 s47, s92, 184960
    buffer_load_dwordx4 v27, s[72:75], s47 offen lds
    v_mfma_f32_16x16x32_bf16 v[144:147], v[188:191], v[236:239], v[144:147]
    s_waitcnt vmcnt(4) lgkmcnt(0)
    s_barrier
    v_mfma_f32_16x16x32_bf16 v[116:119], v[172:175], v[196:199], v[116:119]
    ds_read_b64_tr_b16 v[184:185], v3 offset:61440
    ds_read_b64_tr_b16 v[186:187], v3 offset:63488
    v_mfma_f32_16x16x32_bf16 v[120:123], v[172:175], v[200:203], v[120:123]
    ds_read_b64_tr_b16 v[188:189], v4 offset:61440
    ds_read_b64_tr_b16 v[190:191], v4 offset:63488
    v_mfma_f32_16x16x32_bf16 v[124:127], v[172:175], v[204:207], v[124:127]
    ds_read_b128 v[224:227], v23 offset:8192
    ds_read_b128 v[228:231], v23 offset:12288
    v_mfma_f32_16x16x32_bf16 v[128:131], v[172:175], v[208:211], v[128:131]
    ds_read_b128 v[232:235], v23 offset:16384
    ds_read_b128 v[236:239], v23 offset:4096
    v_mfma_f32_16x16x32_bf16 v[132:135], v[176:179], v[196:199], v[132:135]
    s_add_u32 m0, s54, 40960
    s_add_u32 s47, s92, 221824
    buffer_load_dwordx4 v26, s[72:75], s47 offen lds
    v_mfma_f32_16x16x32_bf16 v[136:139], v[176:179], v[200:203], v[136:139]
    v_mfma_f32_16x16x32_bf16 v[140:143], v[176:179], v[204:207], v[140:143]
    s_add_u32 m0, s54, 41984
    s_add_u32 s47, s92, 221824
    buffer_load_dwordx4 v27, s[72:75], s47 offen lds
    v_mfma_f32_16x16x32_bf16 v[144:147], v[176:179], v[208:211], v[144:147]
    s_waitcnt vmcnt(4) lgkmcnt(0)
    s_barrier
    v_mfma_f32_16x16x32_bf16 v[116:119], v[184:187], v[224:227], v[116:119]
    ds_read_b64_tr_b16 v[172:173], v3 offset:0
    ds_read_b64_tr_b16 v[174:175], v3 offset:2048
    v_mfma_f32_16x16x32_bf16 v[120:123], v[184:187], v[228:231], v[120:123]
    ds_read_b64_tr_b16 v[176:177], v4 offset:0
    ds_read_b64_tr_b16 v[178:179], v4 offset:2048
    v_mfma_f32_16x16x32_bf16 v[124:127], v[184:187], v[232:235], v[124:127]
    ds_read_b128 v[196:199], v20 offset:36864
    ds_read_b128 v[200:203], v20 offset:40960
    v_mfma_f32_16x16x32_bf16 v[128:131], v[184:187], v[236:239], v[128:131]
    ds_read_b128 v[204:207], v20 offset:45056
    ds_read_b128 v[208:211], v20 offset:0
    v_mfma_f32_16x16x32_bf16 v[132:135], v[188:191], v[224:227], v[132:135]
    s_add_u32 m0, s54, 61440
    s_add_u32 s47, s92, 258688
    buffer_load_dwordx4 v26, s[72:75], s47 offen lds
    v_mfma_f32_16x16x32_bf16 v[136:139], v[188:191], v[228:231], v[136:139]
    v_mfma_f32_16x16x32_bf16 v[140:143], v[188:191], v[232:235], v[140:143]
    s_add_u32 m0, s54, 62464
    s_add_u32 s47, s92, 258688
    buffer_load_dwordx4 v27, s[72:75], s47 offen lds
    v_mfma_f32_16x16x32_bf16 v[144:147], v[188:191], v[236:239], v[144:147]
    s_waitcnt vmcnt(4) lgkmcnt(0)
    s_barrier
    v_mfma_f32_16x16x32_bf16 v[116:119], v[172:175], v[196:199], v[116:119]
    ds_read_b64_tr_b16 v[184:185], v3 offset:20480
    ds_read_b64_tr_b16 v[186:187], v3 offset:22528
    v_mfma_f32_16x16x32_bf16 v[120:123], v[172:175], v[200:203], v[120:123]
    ds_read_b64_tr_b16 v[188:189], v4 offset:20480
    ds_read_b64_tr_b16 v[190:191], v4 offset:22528
    v_mfma_f32_16x16x32_bf16 v[124:127], v[172:175], v[204:207], v[124:127]
    ds_read_b128 v[224:227], v21 offset:36864
    ds_read_b128 v[228:231], v21 offset:40960
    v_mfma_f32_16x16x32_bf16 v[128:131], v[172:175], v[208:211], v[128:131]
    ds_read_b128 v[232:235], v21 offset:45056
    ds_read_b128 v[236:239], v21 offset:0
    v_mfma_f32_16x16x32_bf16 v[132:135], v[176:179], v[196:199], v[132:135]
    v_mfma_f32_16x16x32_bf16 v[136:139], v[176:179], v[200:203], v[136:139]
    v_mfma_f32_16x16x32_bf16 v[140:143], v[176:179], v[204:207], v[140:143]
    v_mfma_f32_16x16x32_bf16 v[144:147], v[176:179], v[208:211], v[144:147]
    s_waitcnt vmcnt(2) lgkmcnt(0)
    s_barrier
    v_mfma_f32_16x16x32_bf16 v[116:119], v[184:187], v[224:227], v[116:119]
    ds_read_b64_tr_b16 v[172:173], v3 offset:40960
    ds_read_b64_tr_b16 v[174:175], v3 offset:43008
    v_mfma_f32_16x16x32_bf16 v[120:123], v[184:187], v[228:231], v[120:123]
    ds_read_b64_tr_b16 v[176:177], v4 offset:40960
    ds_read_b64_tr_b16 v[178:179], v4 offset:43008
    v_mfma_f32_16x16x32_bf16 v[124:127], v[184:187], v[232:235], v[124:127]
    ds_read_b128 v[196:199], v22 offset:36864
    ds_read_b128 v[200:203], v22 offset:40960
    v_mfma_f32_16x16x32_bf16 v[128:131], v[184:187], v[236:239], v[128:131]
    ds_read_b128 v[204:207], v22 offset:45056
    ds_read_b128 v[208:211], v22 offset:0
    v_mfma_f32_16x16x32_bf16 v[132:135], v[188:191], v[224:227], v[132:135]
    v_mfma_f32_16x16x32_bf16 v[136:139], v[188:191], v[228:231], v[136:139]
    v_mfma_f32_16x16x32_bf16 v[140:143], v[188:191], v[232:235], v[140:143]
    v_mfma_f32_16x16x32_bf16 v[144:147], v[188:191], v[236:239], v[144:147]
    s_waitcnt vmcnt(0) lgkmcnt(0)
    s_barrier
    v_mfma_f32_16x16x32_bf16 v[116:119], v[172:175], v[196:199], v[116:119]
    ds_read_b64_tr_b16 v[184:185], v3 offset:61440
    ds_read_b64_tr_b16 v[186:187], v3 offset:63488
    v_mfma_f32_16x16x32_bf16 v[120:123], v[172:175], v[200:203], v[120:123]
    ds_read_b64_tr_b16 v[188:189], v4 offset:61440
    ds_read_b64_tr_b16 v[190:191], v4 offset:63488
    v_mfma_f32_16x16x32_bf16 v[124:127], v[172:175], v[204:207], v[124:127]
    ds_read_b128 v[224:227], v23 offset:36864
    ds_read_b128 v[228:231], v23 offset:40960
    v_mfma_f32_16x16x32_bf16 v[128:131], v[172:175], v[208:211], v[128:131]
    ds_read_b128 v[232:235], v23 offset:45056
    ds_read_b128 v[236:239], v23 offset:0
    v_mfma_f32_16x16x32_bf16 v[132:135], v[176:179], v[196:199], v[132:135]
    v_mfma_f32_16x16x32_bf16 v[136:139], v[176:179], v[200:203], v[136:139]
    v_mfma_f32_16x16x32_bf16 v[140:143], v[176:179], v[204:207], v[140:143]
    v_mfma_f32_16x16x32_bf16 v[144:147], v[176:179], v[208:211], v[144:147]
    s_waitcnt lgkmcnt(0)
    s_barrier
    v_mfma_f32_16x16x32_bf16 v[116:119], v[184:187], v[224:227], v[116:119]
    v_mfma_f32_16x16x32_bf16 v[120:123], v[184:187], v[228:231], v[120:123]
    v_mfma_f32_16x16x32_bf16 v[124:127], v[184:187], v[232:235], v[124:127]
    v_mfma_f32_16x16x32_bf16 v[128:131], v[184:187], v[236:239], v[128:131]
    v_mfma_f32_16x16x32_bf16 v[132:135], v[188:191], v[224:227], v[132:135]
    v_mfma_f32_16x16x32_bf16 v[136:139], v[188:191], v[228:231], v[136:139]
    v_mfma_f32_16x16x32_bf16 v[140:143], v[188:191], v[232:235], v[140:143]
    v_mfma_f32_16x16x32_bf16 v[144:147], v[188:191], v[236:239], v[144:147]
    v_cvt_pk_bf16_f32 v32, v32, v33
    v_cvt_pk_bf16_f32 v33, v34, v35
    v_cvt_pk_bf16_f32 v34, v48, v49
    v_cvt_pk_bf16_f32 v35, v50, v51
    s_cmp_eq_u32 s28, 0
    s_cselect_b32 s47, 0x7ff00000, 0
    v_or_b32 v12, s47, v9
    s_cbranch_scc0 concat_heads__gqa_block_cached__gqa_block_cached__near_ridge_kernel_os8
    v_mov_b32 v80, v32
    v_mov_b32 v81, v33
    v_mov_b32 v82, v34
    v_mov_b32 v83, v35
    concat_heads__gqa_block_cached__gqa_block_cached__near_ridge_kernel_os8:
    s_mov_b32 s46, 0
    buffer_store_dwordx4 v[32:35], v12, s[36:39], s46 offen sc1
    v_cvt_pk_bf16_f32 v36, v36, v37
    v_cvt_pk_bf16_f32 v37, v38, v39
    v_cvt_pk_bf16_f32 v38, v52, v53
    v_cvt_pk_bf16_f32 v39, v54, v55
    s_cmp_eq_u32 s28, 2
    s_cselect_b32 s47, 0x7ff00000, 0
    v_or_b32 v13, s47, v9
    s_cbranch_scc0 concat_heads__gqa_block_cached__gqa_block_cached__near_ridge_kernel_os9
    v_mov_b32 v80, v36
    v_mov_b32 v81, v37
    v_mov_b32 v82, v38
    v_mov_b32 v83, v39
    concat_heads__gqa_block_cached__gqa_block_cached__near_ridge_kernel_os9:
    s_mov_b32 s46, 16384
    buffer_store_dwordx4 v[36:39], v13, s[36:39], s46 offen sc1
    v_cvt_pk_bf16_f32 v40, v40, v41
    v_cvt_pk_bf16_f32 v41, v42, v43
    v_cvt_pk_bf16_f32 v42, v56, v57
    v_cvt_pk_bf16_f32 v43, v58, v59
    s_cmp_eq_u32 s28, 4
    s_cselect_b32 s47, 0x7ff00000, 0
    v_or_b32 v14, s47, v9
    s_cbranch_scc0 concat_heads__gqa_block_cached__gqa_block_cached__near_ridge_kernel_os10
    v_mov_b32 v80, v40
    v_mov_b32 v81, v41
    v_mov_b32 v82, v42
    v_mov_b32 v83, v43
    concat_heads__gqa_block_cached__gqa_block_cached__near_ridge_kernel_os10:
    s_mov_b32 s46, 32768
    buffer_store_dwordx4 v[40:43], v14, s[36:39], s46 offen sc1
    v_cvt_pk_bf16_f32 v44, v44, v45
    v_cvt_pk_bf16_f32 v45, v46, v47
    v_cvt_pk_bf16_f32 v46, v60, v61
    v_cvt_pk_bf16_f32 v47, v62, v63
    s_cmp_eq_u32 s28, 6
    s_cselect_b32 s47, 0x7ff00000, 0
    v_or_b32 v15, s47, v25
    s_cbranch_scc0 concat_heads__gqa_block_cached__gqa_block_cached__near_ridge_kernel_os11
    v_mov_b32 v80, v44
    v_mov_b32 v81, v45
    v_mov_b32 v82, v46
    v_mov_b32 v83, v47
    concat_heads__gqa_block_cached__gqa_block_cached__near_ridge_kernel_os11:
    s_mov_b32 s46, 49152
    buffer_store_dwordx4 v[44:47], v15, s[36:39], s46 offen sc1
    s_nop 7
    v_cvt_pk_bf16_f32 v116, v116, v117
    v_cvt_pk_bf16_f32 v117, v118, v119
    v_cvt_pk_bf16_f32 v118, v132, v133
    v_cvt_pk_bf16_f32 v119, v134, v135
    s_cmp_eq_u32 s28, 1
    s_cselect_b32 s47, 0x7ff00000, 0
    v_or_b32 v12, s47, v9
    s_cbranch_scc0 concat_heads__gqa_block_cached__gqa_block_cached__near_ridge_kernel_os12
    v_mov_b32 v80, v116
    v_mov_b32 v81, v117
    v_mov_b32 v82, v118
    v_mov_b32 v83, v119
    concat_heads__gqa_block_cached__gqa_block_cached__near_ridge_kernel_os12:
    s_mov_b32 s46, 8192
    buffer_store_dwordx4 v[116:119], v12, s[36:39], s46 offen sc1
    v_cvt_pk_bf16_f32 v120, v120, v121
    v_cvt_pk_bf16_f32 v121, v122, v123
    v_cvt_pk_bf16_f32 v122, v136, v137
    v_cvt_pk_bf16_f32 v123, v138, v139
    s_cmp_eq_u32 s28, 3
    s_cselect_b32 s47, 0x7ff00000, 0
    v_or_b32 v13, s47, v9
    s_cbranch_scc0 concat_heads__gqa_block_cached__gqa_block_cached__near_ridge_kernel_os13
    v_mov_b32 v80, v120
    v_mov_b32 v81, v121
    v_mov_b32 v82, v122
    v_mov_b32 v83, v123
    concat_heads__gqa_block_cached__gqa_block_cached__near_ridge_kernel_os13:
    s_mov_b32 s46, 24576
    buffer_store_dwordx4 v[120:123], v13, s[36:39], s46 offen sc1
    v_cvt_pk_bf16_f32 v124, v124, v125
    v_cvt_pk_bf16_f32 v125, v126, v127
    v_cvt_pk_bf16_f32 v126, v140, v141
    v_cvt_pk_bf16_f32 v127, v142, v143
    s_cmp_eq_u32 s28, 5
    s_cselect_b32 s47, 0x7ff00000, 0
    v_or_b32 v14, s47, v9
    s_cbranch_scc0 concat_heads__gqa_block_cached__gqa_block_cached__near_ridge_kernel_os14
    v_mov_b32 v80, v124
    v_mov_b32 v81, v125
    v_mov_b32 v82, v126
    v_mov_b32 v83, v127
    concat_heads__gqa_block_cached__gqa_block_cached__near_ridge_kernel_os14:
    s_mov_b32 s46, 40960
    buffer_store_dwordx4 v[124:127], v14, s[36:39], s46 offen sc1
    v_cvt_pk_bf16_f32 v128, v128, v129
    v_cvt_pk_bf16_f32 v129, v130, v131
    v_cvt_pk_bf16_f32 v130, v144, v145
    v_cvt_pk_bf16_f32 v131, v146, v147
    s_cmp_eq_u32 s28, 7
    s_cselect_b32 s47, 0x7ff00000, 0
    v_or_b32 v15, s47, v25
    s_cbranch_scc0 concat_heads__gqa_block_cached__gqa_block_cached__near_ridge_kernel_os15
    v_mov_b32 v80, v128
    v_mov_b32 v81, v129
    v_mov_b32 v82, v130
    v_mov_b32 v83, v131
    concat_heads__gqa_block_cached__gqa_block_cached__near_ridge_kernel_os15:
    s_mov_b32 s46, 57344
    buffer_store_dwordx4 v[128:131], v15, s[36:39], s46 offen sc1
concat_heads__gqa_block_cached__gqa_block_cached__near_ridge_kernel_tail:
    s_min_u32 s46, s28, 8
    s_lshl_b32 s46, s46, 3
    s_add_u32 s58, s46, s45
    s_cmp_eq_u32 s44, 15
    s_cselect_b32 s63, 0, s20
    s_cmp_eq_u32 s63, 0
    s_cselect_b32 s61, 3, 0
    s_cselect_b32 s62, 0, 133120
    s_lshl_b32 s59, s58, 10
    s_add_u32 s59, s59, s62
    s_lshl_b32 s98, 0x5555, s63
    s_mov_b32 s69, 36864
    s_lshr_b32 s46, s58, 4
    s_and_b32 s47, s58, 7
    s_lshl_b32 s47, s47, 6
    s_bitcmp1_b32 s58, 3
    s_cselect_b32 s62, 640, 0
    s_add_u32 s47, s47, s62
    s_and_b32 s62, s58, 1
    s_and_b32 s68, s62, s63
    s_cmp_eq_u32 s68, 1
    s_cselect_b32 s68, 0x7ff00000, s69
    s_lshl_b32 s62, s62, 1
    s_bfe_u32 s60, s58, 0x20001
    s_lshl_b32 s60, s60, 5
    s_add_u32 s60, s60, 512
    s_cmp_ge_u32 s58, 64
    s_cselect_b32 s46, s62, s46
    s_cselect_b32 s47, s60, s47
    s_cselect_b32 s60, s68, 32
    s_add_u32 s46, s46, s61
    s_mul_i32 s68, s42, 7
    s_add_u32 s46, s46, s68
    s_mul_i32 s46, s46, 36864
    s_mul_i32 s68, s43, 1152
    s_add_u32 s46, s46, s68
    s_add_u32 s46, s46, s47
    v_and_b32 v3, 15, v2
    v_mul_u32_u24 v3, 2304, v3
    v_lshrrev_b32 v4, 4, v2
    v_lshl_add_u32 v3, v4, 3, v3
    v_add_u32 v3, s46, v3
    v_add_u32 v4, s60, v3
    v_lshlrev_b32 v5, 4, v2
    v_add_u32 v5, s59, v5
    s_waitcnt vmcnt(0)
    s_barrier
    s_cmp_lg_u32 s45, 0
    s_cbranch_scc1 concat_heads__gqa_block_cached__gqa_block_cached__near_ridge_kernel_m0x
    s_mov_b64 exec, 1
    v_mov_b32 v6, 0
    s_mov_b32 s47, 0
    v_mov_b32 v7, v29
    buffer_atomic_or v7, v6, s[84:87], 0 offen sc0 sc1
    s_waitcnt vmcnt(0)
    v_or_b32 v7, v29, v7
concat_heads__gqa_block_cached__gqa_block_cached__near_ridge_kernel_m0p:
    s_nop 1
    v_readfirstlane_b32 s46, v7
    s_and_b32 s46, s46, s98
    s_bcnt1_i32_b32 s93, s46
    s_cmp_ge_u32 s93, 1
    s_cbranch_scc1 concat_heads__gqa_block_cached__gqa_block_cached__near_ridge_kernel_m0d
    s_add_u32 s47, s47, 1
    s_cmp_ge_u32 s47, 0x40000
    s_cbranch_scc1 concat_heads__gqa_block_cached__gqa_block_cached__near_ridge_kernel_m0d
    s_sleep 1
    buffer_load_dword v7, v6, s[84:87], 0 offen sc1
    s_waitcnt vmcnt(0)
    s_branch concat_heads__gqa_block_cached__gqa_block_cached__near_ridge_kernel_m0p
concat_heads__gqa_block_cached__gqa_block_cached__near_ridge_kernel_m0d:
    ds_write_b32 v6, v7
    s_waitcnt lgkmcnt(0)
    s_mov_b64 exec, -1
concat_heads__gqa_block_cached__gqa_block_cached__near_ridge_kernel_m0x:
    s_barrier
    v_mov_b32 v6, 0
    ds_read_b32 v7, v6
    v_lshlrev_b32 v8, 16, v80
    v_and_b32 v9, 0xffff0000, v80
    v_lshlrev_b32 v10, 16, v81
    v_and_b32 v11, 0xffff0000, v81
    v_lshlrev_b32 v12, 16, v82
    v_and_b32 v13, 0xffff0000, v82
    v_lshlrev_b32 v14, 16, v83
    v_and_b32 v15, 0xffff0000, v83
    s_lshl_b32 s92, 1, s44
    s_and_b32 s92, s92, 0x5fff
    s_waitcnt lgkmcnt(0)
    v_readfirstlane_b32 s94, v7
    s_and_b32 s94, s94, s98
    s_andn2_b32 s93, s94, s92
    s_lshr_b32 s93, s93, s63
    s_mov_b32 s46, 0
    s_bitcmp1_b32 s93, 0
    s_cselect_b32 s47, 0, 0x7ff00000
    v_add_u32 v96, s47, v5
    buffer_load_dwordx4 v[32:35], v96, s[88:91], s46 offen sc1
    s_mov_b32 s46, 266240
    s_bitcmp1_b32 s93, 2
    s_cselect_b32 s47, 0, 0x7ff00000
    v_add_u32 v97, s47, v5
    buffer_load_dwordx4 v[36:39], v97, s[88:91], s46 offen sc1
    s_mov_b32 s46, 532480
    s_bitcmp1_b32 s93, 4
    s_cselect_b32 s47, 0, 0x7ff00000
    v_add_u32 v98, s47, v5
    buffer_load_dwordx4 v[40:43], v98, s[88:91], s46 offen sc1
    s_mov_b32 s46, 798720
    s_bitcmp1_b32 s93, 6
    s_cselect_b32 s47, 0, 0x7ff00000
    v_add_u32 v99, s47, v5
    buffer_load_dwordx4 v[44:47], v99, s[88:91], s46 offen sc1
    s_mov_b32 s46, 1064960
    s_bitcmp1_b32 s93, 8
    s_cselect_b32 s47, 0, 0x7ff00000
    v_add_u32 v100, s47, v5
    buffer_load_dwordx4 v[48:51], v100, s[88:91], s46 offen sc1
    s_mov_b32 s46, 1331200
    s_bitcmp1_b32 s93, 10
    s_cselect_b32 s47, 0, 0x7ff00000
    v_add_u32 v101, s47, v5
    buffer_load_dwordx4 v[52:55], v101, s[88:91], s46 offen sc1
    s_mov_b32 s46, 1597440
    s_bitcmp1_b32 s93, 12
    s_cselect_b32 s47, 0, 0x7ff00000
    v_add_u32 v102, s47, v5
    buffer_load_dwordx4 v[56:59], v102, s[88:91], s46 offen sc1
    s_mov_b32 s46, 1863680
    s_bitcmp1_b32 s93, 14
    s_cselect_b32 s47, 0, 0x7ff00000
    v_add_u32 v103, s47, v5
    buffer_load_dwordx4 v[60:63], v103, s[88:91], s46 offen sc1
    s_waitcnt vmcnt(7)
    v_lshlrev_b32 v6, 16, v32
    v_and_b32 v7, 0xffff0000, v32
    v_add_f32 v8, v8, v6
    v_add_f32 v9, v9, v7
    v_lshlrev_b32 v6, 16, v33
    v_and_b32 v7, 0xffff0000, v33
    v_add_f32 v10, v10, v6
    v_add_f32 v11, v11, v7
    v_lshlrev_b32 v6, 16, v34
    v_and_b32 v7, 0xffff0000, v34
    v_add_f32 v12, v12, v6
    v_add_f32 v13, v13, v7
    v_lshlrev_b32 v6, 16, v35
    v_and_b32 v7, 0xffff0000, v35
    v_add_f32 v14, v14, v6
    v_add_f32 v15, v15, v7
    s_waitcnt vmcnt(6)
    v_lshlrev_b32 v6, 16, v36
    v_and_b32 v7, 0xffff0000, v36
    v_add_f32 v8, v8, v6
    v_add_f32 v9, v9, v7
    v_lshlrev_b32 v6, 16, v37
    v_and_b32 v7, 0xffff0000, v37
    v_add_f32 v10, v10, v6
    v_add_f32 v11, v11, v7
    v_lshlrev_b32 v6, 16, v38
    v_and_b32 v7, 0xffff0000, v38
    v_add_f32 v12, v12, v6
    v_add_f32 v13, v13, v7
    v_lshlrev_b32 v6, 16, v39
    v_and_b32 v7, 0xffff0000, v39
    v_add_f32 v14, v14, v6
    v_add_f32 v15, v15, v7
    s_waitcnt vmcnt(5)
    v_lshlrev_b32 v6, 16, v40
    v_and_b32 v7, 0xffff0000, v40
    v_add_f32 v8, v8, v6
    v_add_f32 v9, v9, v7
    v_lshlrev_b32 v6, 16, v41
    v_and_b32 v7, 0xffff0000, v41
    v_add_f32 v10, v10, v6
    v_add_f32 v11, v11, v7
    v_lshlrev_b32 v6, 16, v42
    v_and_b32 v7, 0xffff0000, v42
    v_add_f32 v12, v12, v6
    v_add_f32 v13, v13, v7
    v_lshlrev_b32 v6, 16, v43
    v_and_b32 v7, 0xffff0000, v43
    v_add_f32 v14, v14, v6
    v_add_f32 v15, v15, v7
    s_waitcnt vmcnt(4)
    v_lshlrev_b32 v6, 16, v44
    v_and_b32 v7, 0xffff0000, v44
    v_add_f32 v8, v8, v6
    v_add_f32 v9, v9, v7
    v_lshlrev_b32 v6, 16, v45
    v_and_b32 v7, 0xffff0000, v45
    v_add_f32 v10, v10, v6
    v_add_f32 v11, v11, v7
    v_lshlrev_b32 v6, 16, v46
    v_and_b32 v7, 0xffff0000, v46
    v_add_f32 v12, v12, v6
    v_add_f32 v13, v13, v7
    v_lshlrev_b32 v6, 16, v47
    v_and_b32 v7, 0xffff0000, v47
    v_add_f32 v14, v14, v6
    v_add_f32 v15, v15, v7
    s_waitcnt vmcnt(3)
    v_lshlrev_b32 v6, 16, v48
    v_and_b32 v7, 0xffff0000, v48
    v_add_f32 v8, v8, v6
    v_add_f32 v9, v9, v7
    v_lshlrev_b32 v6, 16, v49
    v_and_b32 v7, 0xffff0000, v49
    v_add_f32 v10, v10, v6
    v_add_f32 v11, v11, v7
    v_lshlrev_b32 v6, 16, v50
    v_and_b32 v7, 0xffff0000, v50
    v_add_f32 v12, v12, v6
    v_add_f32 v13, v13, v7
    v_lshlrev_b32 v6, 16, v51
    v_and_b32 v7, 0xffff0000, v51
    v_add_f32 v14, v14, v6
    v_add_f32 v15, v15, v7
    s_waitcnt vmcnt(2)
    v_lshlrev_b32 v6, 16, v52
    v_and_b32 v7, 0xffff0000, v52
    v_add_f32 v8, v8, v6
    v_add_f32 v9, v9, v7
    v_lshlrev_b32 v6, 16, v53
    v_and_b32 v7, 0xffff0000, v53
    v_add_f32 v10, v10, v6
    v_add_f32 v11, v11, v7
    v_lshlrev_b32 v6, 16, v54
    v_and_b32 v7, 0xffff0000, v54
    v_add_f32 v12, v12, v6
    v_add_f32 v13, v13, v7
    v_lshlrev_b32 v6, 16, v55
    v_and_b32 v7, 0xffff0000, v55
    v_add_f32 v14, v14, v6
    v_add_f32 v15, v15, v7
    s_waitcnt vmcnt(1)
    v_lshlrev_b32 v6, 16, v56
    v_and_b32 v7, 0xffff0000, v56
    v_add_f32 v8, v8, v6
    v_add_f32 v9, v9, v7
    v_lshlrev_b32 v6, 16, v57
    v_and_b32 v7, 0xffff0000, v57
    v_add_f32 v10, v10, v6
    v_add_f32 v11, v11, v7
    v_lshlrev_b32 v6, 16, v58
    v_and_b32 v7, 0xffff0000, v58
    v_add_f32 v12, v12, v6
    v_add_f32 v13, v13, v7
    v_lshlrev_b32 v6, 16, v59
    v_and_b32 v7, 0xffff0000, v59
    v_add_f32 v14, v14, v6
    v_add_f32 v15, v15, v7
    s_waitcnt vmcnt(0)
    v_lshlrev_b32 v6, 16, v60
    v_and_b32 v7, 0xffff0000, v60
    v_add_f32 v8, v8, v6
    v_add_f32 v9, v9, v7
    v_lshlrev_b32 v6, 16, v61
    v_and_b32 v7, 0xffff0000, v61
    v_add_f32 v10, v10, v6
    v_add_f32 v11, v11, v7
    v_lshlrev_b32 v6, 16, v62
    v_and_b32 v7, 0xffff0000, v62
    v_add_f32 v12, v12, v6
    v_add_f32 v13, v13, v7
    v_lshlrev_b32 v6, 16, v63
    v_and_b32 v7, 0xffff0000, v63
    v_add_f32 v14, v14, v6
    v_add_f32 v15, v15, v7
    s_cmp_eq_u32 s94, s98
    s_cbranch_scc1 concat_heads__gqa_block_cached__gqa_block_cached__near_ridge_kernel_mfin
    s_cmp_lg_u32 s45, 0
    s_cbranch_scc1 concat_heads__gqa_block_cached__gqa_block_cached__near_ridge_kernel_m1x
    s_mov_b64 exec, 1
    v_mov_b32 v6, 0
    s_mov_b32 s47, 0
    buffer_load_dword v7, v6, s[84:87], 0 offen sc1
    s_waitcnt vmcnt(0)
concat_heads__gqa_block_cached__gqa_block_cached__near_ridge_kernel_m1p:
    s_nop 1
    v_readfirstlane_b32 s46, v7
    s_and_b32 s46, s46, s98
    s_bcnt1_i32_b32 s93, s46
    s_cmp_ge_u32 s93, 8
    s_cbranch_scc1 concat_heads__gqa_block_cached__gqa_block_cached__near_ridge_kernel_m1d
    s_add_u32 s47, s47, 1
    s_cmp_ge_u32 s47, 0x40000
    s_cbranch_scc1 concat_heads__gqa_block_cached__gqa_block_cached__near_ridge_kernel_m1d
    s_sleep 1
    buffer_load_dword v7, v6, s[84:87], 0 offen sc1
    s_waitcnt vmcnt(0)
    s_branch concat_heads__gqa_block_cached__gqa_block_cached__near_ridge_kernel_m1p
concat_heads__gqa_block_cached__gqa_block_cached__near_ridge_kernel_m1d:
    s_mov_b64 exec, -1
concat_heads__gqa_block_cached__gqa_block_cached__near_ridge_kernel_m1x:
    s_barrier
    s_not_b32 s93, s94
    s_lshr_b32 s93, s93, s63
    s_mov_b32 s46, 0
    s_bitcmp1_b32 s93, 0
    s_cselect_b32 s47, 0, 0x7ff00000
    v_add_u32 v96, s47, v5
    buffer_load_dwordx4 v[32:35], v96, s[88:91], s46 offen sc1
    s_mov_b32 s46, 266240
    s_bitcmp1_b32 s93, 2
    s_cselect_b32 s47, 0, 0x7ff00000
    v_add_u32 v97, s47, v5
    buffer_load_dwordx4 v[36:39], v97, s[88:91], s46 offen sc1
    s_mov_b32 s46, 532480
    s_bitcmp1_b32 s93, 4
    s_cselect_b32 s47, 0, 0x7ff00000
    v_add_u32 v98, s47, v5
    buffer_load_dwordx4 v[40:43], v98, s[88:91], s46 offen sc1
    s_mov_b32 s46, 798720
    s_bitcmp1_b32 s93, 6
    s_cselect_b32 s47, 0, 0x7ff00000
    v_add_u32 v99, s47, v5
    buffer_load_dwordx4 v[44:47], v99, s[88:91], s46 offen sc1
    s_mov_b32 s46, 1064960
    s_bitcmp1_b32 s93, 8
    s_cselect_b32 s47, 0, 0x7ff00000
    v_add_u32 v100, s47, v5
    buffer_load_dwordx4 v[48:51], v100, s[88:91], s46 offen sc1
    s_mov_b32 s46, 1331200
    s_bitcmp1_b32 s93, 10
    s_cselect_b32 s47, 0, 0x7ff00000
    v_add_u32 v101, s47, v5
    buffer_load_dwordx4 v[52:55], v101, s[88:91], s46 offen sc1
    s_mov_b32 s46, 1597440
    s_bitcmp1_b32 s93, 12
    s_cselect_b32 s47, 0, 0x7ff00000
    v_add_u32 v102, s47, v5
    buffer_load_dwordx4 v[56:59], v102, s[88:91], s46 offen sc1
    s_mov_b32 s46, 1863680
    s_bitcmp1_b32 s93, 14
    s_cselect_b32 s47, 0, 0x7ff00000
    v_add_u32 v103, s47, v5
    buffer_load_dwordx4 v[60:63], v103, s[88:91], s46 offen sc1
    s_waitcnt vmcnt(7)
    v_lshlrev_b32 v6, 16, v32
    v_and_b32 v7, 0xffff0000, v32
    v_add_f32 v8, v8, v6
    v_add_f32 v9, v9, v7
    v_lshlrev_b32 v6, 16, v33
    v_and_b32 v7, 0xffff0000, v33
    v_add_f32 v10, v10, v6
    v_add_f32 v11, v11, v7
    v_lshlrev_b32 v6, 16, v34
    v_and_b32 v7, 0xffff0000, v34
    v_add_f32 v12, v12, v6
    v_add_f32 v13, v13, v7
    v_lshlrev_b32 v6, 16, v35
    v_and_b32 v7, 0xffff0000, v35
    v_add_f32 v14, v14, v6
    v_add_f32 v15, v15, v7
    s_waitcnt vmcnt(6)
    v_lshlrev_b32 v6, 16, v36
    v_and_b32 v7, 0xffff0000, v36
    v_add_f32 v8, v8, v6
    v_add_f32 v9, v9, v7
    v_lshlrev_b32 v6, 16, v37
    v_and_b32 v7, 0xffff0000, v37
    v_add_f32 v10, v10, v6
    v_add_f32 v11, v11, v7
    v_lshlrev_b32 v6, 16, v38
    v_and_b32 v7, 0xffff0000, v38
    v_add_f32 v12, v12, v6
    v_add_f32 v13, v13, v7
    v_lshlrev_b32 v6, 16, v39
    v_and_b32 v7, 0xffff0000, v39
    v_add_f32 v14, v14, v6
    v_add_f32 v15, v15, v7
    s_waitcnt vmcnt(5)
    v_lshlrev_b32 v6, 16, v40
    v_and_b32 v7, 0xffff0000, v40
    v_add_f32 v8, v8, v6
    v_add_f32 v9, v9, v7
    v_lshlrev_b32 v6, 16, v41
    v_and_b32 v7, 0xffff0000, v41
    v_add_f32 v10, v10, v6
    v_add_f32 v11, v11, v7
    v_lshlrev_b32 v6, 16, v42
    v_and_b32 v7, 0xffff0000, v42
    v_add_f32 v12, v12, v6
    v_add_f32 v13, v13, v7
    v_lshlrev_b32 v6, 16, v43
    v_and_b32 v7, 0xffff0000, v43
    v_add_f32 v14, v14, v6
    v_add_f32 v15, v15, v7
    s_waitcnt vmcnt(4)
    v_lshlrev_b32 v6, 16, v44
    v_and_b32 v7, 0xffff0000, v44
    v_add_f32 v8, v8, v6
    v_add_f32 v9, v9, v7
    v_lshlrev_b32 v6, 16, v45
    v_and_b32 v7, 0xffff0000, v45
    v_add_f32 v10, v10, v6
    v_add_f32 v11, v11, v7
    v_lshlrev_b32 v6, 16, v46
    v_and_b32 v7, 0xffff0000, v46
    v_add_f32 v12, v12, v6
    v_add_f32 v13, v13, v7
    v_lshlrev_b32 v6, 16, v47
    v_and_b32 v7, 0xffff0000, v47
    v_add_f32 v14, v14, v6
    v_add_f32 v15, v15, v7
    s_waitcnt vmcnt(3)
    v_lshlrev_b32 v6, 16, v48
    v_and_b32 v7, 0xffff0000, v48
    v_add_f32 v8, v8, v6
    v_add_f32 v9, v9, v7
    v_lshlrev_b32 v6, 16, v49
    v_and_b32 v7, 0xffff0000, v49
    v_add_f32 v10, v10, v6
    v_add_f32 v11, v11, v7
    v_lshlrev_b32 v6, 16, v50
    v_and_b32 v7, 0xffff0000, v50
    v_add_f32 v12, v12, v6
    v_add_f32 v13, v13, v7
    v_lshlrev_b32 v6, 16, v51
    v_and_b32 v7, 0xffff0000, v51
    v_add_f32 v14, v14, v6
    v_add_f32 v15, v15, v7
    s_waitcnt vmcnt(2)
    v_lshlrev_b32 v6, 16, v52
    v_and_b32 v7, 0xffff0000, v52
    v_add_f32 v8, v8, v6
    v_add_f32 v9, v9, v7
    v_lshlrev_b32 v6, 16, v53
    v_and_b32 v7, 0xffff0000, v53
    v_add_f32 v10, v10, v6
    v_add_f32 v11, v11, v7
    v_lshlrev_b32 v6, 16, v54
    v_and_b32 v7, 0xffff0000, v54
    v_add_f32 v12, v12, v6
    v_add_f32 v13, v13, v7
    v_lshlrev_b32 v6, 16, v55
    v_and_b32 v7, 0xffff0000, v55
    v_add_f32 v14, v14, v6
    v_add_f32 v15, v15, v7
    s_waitcnt vmcnt(1)
    v_lshlrev_b32 v6, 16, v56
    v_and_b32 v7, 0xffff0000, v56
    v_add_f32 v8, v8, v6
    v_add_f32 v9, v9, v7
    v_lshlrev_b32 v6, 16, v57
    v_and_b32 v7, 0xffff0000, v57
    v_add_f32 v10, v10, v6
    v_add_f32 v11, v11, v7
    v_lshlrev_b32 v6, 16, v58
    v_and_b32 v7, 0xffff0000, v58
    v_add_f32 v12, v12, v6
    v_add_f32 v13, v13, v7
    v_lshlrev_b32 v6, 16, v59
    v_and_b32 v7, 0xffff0000, v59
    v_add_f32 v14, v14, v6
    v_add_f32 v15, v15, v7
    s_waitcnt vmcnt(0)
    v_lshlrev_b32 v6, 16, v60
    v_and_b32 v7, 0xffff0000, v60
    v_add_f32 v8, v8, v6
    v_add_f32 v9, v9, v7
    v_lshlrev_b32 v6, 16, v61
    v_and_b32 v7, 0xffff0000, v61
    v_add_f32 v10, v10, v6
    v_add_f32 v11, v11, v7
    v_lshlrev_b32 v6, 16, v62
    v_and_b32 v7, 0xffff0000, v62
    v_add_f32 v12, v12, v6
    v_add_f32 v13, v13, v7
    v_lshlrev_b32 v6, 16, v63
    v_and_b32 v7, 0xffff0000, v63
    v_add_f32 v14, v14, v6
    v_add_f32 v15, v15, v7
concat_heads__gqa_block_cached__gqa_block_cached__near_ridge_kernel_mfin:
    v_cvt_pk_bf16_f32 v16, v8, v9
    v_cvt_pk_bf16_f32 v17, v10, v11
    v_cvt_pk_bf16_f32 v18, v12, v13
    v_cvt_pk_bf16_f32 v19, v14, v15
    buffer_store_dwordx2 v[16:17], v3, s[80:83], 0 offen
    buffer_store_dwordx2 v[18:19], v4, s[80:83], 0 offen
    s_endpgm
concat_heads__gqa_block_cached__gqa_block_cached__near_ridge_kernel_slow1:
    v_mov_b32 v12, v11
    s_nop 1
    v_permlane32_swap_b32 v11, v12
    s_nop 1
    v_max_f32 v11, v11, v12
    v_max_f32 v11, v11, v20
    v_sub_f32 v12, v20, v11
    v_mul_f32 v12, s48, v12
    v_exp_f32 v23, v12
    v_mov_b32 v20, v11
    v_mul_f32 v22, s50, v11
    v_add_f32 v21, s51, v11
    s_mov_b32 s56, 1
    v_mul_f32 v24, v24, v23
    v_mul_f32 v25, v25, v23
    s_branch concat_heads__gqa_block_cached__gqa_block_cached__near_ridge_kernel_ret1
concat_heads__gqa_block_cached__gqa_block_cached__near_ridge_kernel_resc1:
    s_nop 7
    s_nop 7
    v_mul_f32 v128, v128, v23
    v_mul_f32 v129, v129, v23
    v_mul_f32 v130, v130, v23
    v_mul_f32 v131, v131, v23
    v_mul_f32 v132, v132, v23
    v_mul_f32 v133, v133, v23
    v_mul_f32 v134, v134, v23
    v_mul_f32 v135, v135, v23
    v_mul_f32 v136, v136, v23
    v_mul_f32 v137, v137, v23
    v_mul_f32 v138, v138, v23
    v_mul_f32 v139, v139, v23
    v_mul_f32 v140, v140, v23
    v_mul_f32 v141, v141, v23
    v_mul_f32 v142, v142, v23
    v_mul_f32 v143, v143, v23
    v_mul_f32 v144, v144, v23
    v_mul_f32 v145, v145, v23
    v_mul_f32 v146, v146, v23
    v_mul_f32 v147, v147, v23
    v_mul_f32 v148, v148, v23
    v_mul_f32 v149, v149, v23
    v_mul_f32 v150, v150, v23
    v_mul_f32 v151, v151, v23
    v_mul_f32 v152, v152, v23
    v_mul_f32 v153, v153, v23
    v_mul_f32 v154, v154, v23
    v_mul_f32 v155, v155, v23
    v_mul_f32 v156, v156, v23
    v_mul_f32 v157, v157, v23
    v_mul_f32 v158, v158, v23
    v_mul_f32 v159, v159, v23
    v_mul_f32 v160, v160, v23
    v_mul_f32 v161, v161, v23
    v_mul_f32 v162, v162, v23
    v_mul_f32 v163, v163, v23
    v_mul_f32 v164, v164, v23
    v_mul_f32 v165, v165, v23
    v_mul_f32 v166, v166, v23
    v_mul_f32 v167, v167, v23
    v_mul_f32 v168, v168, v23
    v_mul_f32 v169, v169, v23
    v_mul_f32 v170, v170, v23
    v_mul_f32 v171, v171, v23
    v_mul_f32 v172, v172, v23
    v_mul_f32 v173, v173, v23
    v_mul_f32 v174, v174, v23
    v_mul_f32 v175, v175, v23
    v_mul_f32 v176, v176, v23
    v_mul_f32 v177, v177, v23
    v_mul_f32 v178, v178, v23
    v_mul_f32 v179, v179, v23
    v_mul_f32 v180, v180, v23
    v_mul_f32 v181, v181, v23
    v_mul_f32 v182, v182, v23
    v_mul_f32 v183, v183, v23
    v_mul_f32 v184, v184, v23
    v_mul_f32 v185, v185, v23
    v_mul_f32 v186, v186, v23
    v_mul_f32 v187, v187, v23
    v_mul_f32 v188, v188, v23
    v_mul_f32 v189, v189, v23
    v_mul_f32 v190, v190, v23
    v_mul_f32 v191, v191, v23
    s_mov_b32 s56, 0
    s_branch concat_heads__gqa_block_cached__gqa_block_cached__near_ridge_kernel_rr1
concat_heads__gqa_block_cached__gqa_block_cached__near_ridge_kernel_slow2:
    v_mov_b32 v12, v11
    s_nop 1
    v_permlane32_swap_b32 v11, v12
    s_nop 1
    v_max_f32 v11, v11, v12
    v_max_f32 v11, v11, v20
    v_sub_f32 v12, v20, v11
    v_mul_f32 v12, s48, v12
    v_exp_f32 v23, v12
    v_mov_b32 v20, v11
    v_mul_f32 v22, s50, v11
    v_add_f32 v21, s51, v11
    s_mov_b32 s56, 1
    v_mul_f32 v24, v24, v23
    v_mul_f32 v25, v25, v23
    s_branch concat_heads__gqa_block_cached__gqa_block_cached__near_ridge_kernel_ret2
concat_heads__gqa_block_cached__gqa_block_cached__near_ridge_kernel_resc2:
    s_nop 7
    s_nop 7
    v_mul_f32 v128, v128, v23
    v_mul_f32 v129, v129, v23
    v_mul_f32 v130, v130, v23
    v_mul_f32 v131, v131, v23
    v_mul_f32 v132, v132, v23
    v_mul_f32 v133, v133, v23
    v_mul_f32 v134, v134, v23
    v_mul_f32 v135, v135, v23
    v_mul_f32 v136, v136, v23
    v_mul_f32 v137, v137, v23
    v_mul_f32 v138, v138, v23
    v_mul_f32 v139, v139, v23
    v_mul_f32 v140, v140, v23
    v_mul_f32 v141, v141, v23
    v_mul_f32 v142, v142, v23
    v_mul_f32 v143, v143, v23
    v_mul_f32 v144, v144, v23
    v_mul_f32 v145, v145, v23
    v_mul_f32 v146, v146, v23
    v_mul_f32 v147, v147, v23
    v_mul_f32 v148, v148, v23
    v_mul_f32 v149, v149, v23
    v_mul_f32 v150, v150, v23
    v_mul_f32 v151, v151, v23
    v_mul_f32 v152, v152, v23
    v_mul_f32 v153, v153, v23
    v_mul_f32 v154, v154, v23
    v_mul_f32 v155, v155, v23
    v_mul_f32 v156, v156, v23
    v_mul_f32 v157, v157, v23
    v_mul_f32 v158, v158, v23
    v_mul_f32 v159, v159, v23
    v_mul_f32 v160, v160, v23
    v_mul_f32 v161, v161, v23
    v_mul_f32 v162, v162, v23
    v_mul_f32 v163, v163, v23
    v_mul_f32 v164, v164, v23
    v_mul_f32 v165, v165, v23
    v_mul_f32 v166, v166, v23
    v_mul_f32 v167, v167, v23
    v_mul_f32 v168, v168, v23
    v_mul_f32 v169, v169, v23
    v_mul_f32 v170, v170, v23
    v_mul_f32 v171, v171, v23
    v_mul_f32 v172, v172, v23
    v_mul_f32 v173, v173, v23
    v_mul_f32 v174, v174, v23
    v_mul_f32 v175, v175, v23
    v_mul_f32 v176, v176, v23
    v_mul_f32 v177, v177, v23
    v_mul_f32 v178, v178, v23
    v_mul_f32 v179, v179, v23
    v_mul_f32 v180, v180, v23
    v_mul_f32 v181, v181, v23
    v_mul_f32 v182, v182, v23
    v_mul_f32 v183, v183, v23
    v_mul_f32 v184, v184, v23
    v_mul_f32 v185, v185, v23
    v_mul_f32 v186, v186, v23
    v_mul_f32 v187, v187, v23
    v_mul_f32 v188, v188, v23
    v_mul_f32 v189, v189, v23
    v_mul_f32 v190, v190, v23
    v_mul_f32 v191, v191, v23
    s_mov_b32 s56, 0
    s_branch concat_heads__gqa_block_cached__gqa_block_cached__near_ridge_kernel_rr2
concat_heads__gqa_block_cached__gqa_block_cached__near_ridge_kernel_slow3:
    v_mov_b32 v12, v11
    s_nop 1
    v_permlane32_swap_b32 v11, v12
    s_nop 1
    v_max_f32 v11, v11, v12
    v_max_f32 v11, v11, v20
    v_sub_f32 v12, v20, v11
    v_mul_f32 v12, s48, v12
    v_exp_f32 v23, v12
    v_mov_b32 v20, v11
    v_mul_f32 v22, s50, v11
    v_add_f32 v21, s51, v11
    s_mov_b32 s56, 1
    v_mul_f32 v24, v24, v23
    v_mul_f32 v25, v25, v23
    s_branch concat_heads__gqa_block_cached__gqa_block_cached__near_ridge_kernel_ret3
concat_heads__gqa_block_cached__gqa_block_cached__near_ridge_kernel_resc3:
    s_nop 7
    s_nop 7
    v_mul_f32 v128, v128, v23
    v_mul_f32 v129, v129, v23
    v_mul_f32 v130, v130, v23
    v_mul_f32 v131, v131, v23
    v_mul_f32 v132, v132, v23
    v_mul_f32 v133, v133, v23
    v_mul_f32 v134, v134, v23
    v_mul_f32 v135, v135, v23
    v_mul_f32 v136, v136, v23
    v_mul_f32 v137, v137, v23
    v_mul_f32 v138, v138, v23
    v_mul_f32 v139, v139, v23
    v_mul_f32 v140, v140, v23
    v_mul_f32 v141, v141, v23
    v_mul_f32 v142, v142, v23
    v_mul_f32 v143, v143, v23
    v_mul_f32 v144, v144, v23
    v_mul_f32 v145, v145, v23
    v_mul_f32 v146, v146, v23
    v_mul_f32 v147, v147, v23
    v_mul_f32 v148, v148, v23
    v_mul_f32 v149, v149, v23
    v_mul_f32 v150, v150, v23
    v_mul_f32 v151, v151, v23
    v_mul_f32 v152, v152, v23
    v_mul_f32 v153, v153, v23
    v_mul_f32 v154, v154, v23
    v_mul_f32 v155, v155, v23
    v_mul_f32 v156, v156, v23
    v_mul_f32 v157, v157, v23
    v_mul_f32 v158, v158, v23
    v_mul_f32 v159, v159, v23
    v_mul_f32 v160, v160, v23
    v_mul_f32 v161, v161, v23
    v_mul_f32 v162, v162, v23
    v_mul_f32 v163, v163, v23
    v_mul_f32 v164, v164, v23
    v_mul_f32 v165, v165, v23
    v_mul_f32 v166, v166, v23
    v_mul_f32 v167, v167, v23
    v_mul_f32 v168, v168, v23
    v_mul_f32 v169, v169, v23
    v_mul_f32 v170, v170, v23
    v_mul_f32 v171, v171, v23
    v_mul_f32 v172, v172, v23
    v_mul_f32 v173, v173, v23
    v_mul_f32 v174, v174, v23
    v_mul_f32 v175, v175, v23
    v_mul_f32 v176, v176, v23
    v_mul_f32 v177, v177, v23
    v_mul_f32 v178, v178, v23
    v_mul_f32 v179, v179, v23
    v_mul_f32 v180, v180, v23
    v_mul_f32 v181, v181, v23
    v_mul_f32 v182, v182, v23
    v_mul_f32 v183, v183, v23
    v_mul_f32 v184, v184, v23
    v_mul_f32 v185, v185, v23
    v_mul_f32 v186, v186, v23
    v_mul_f32 v187, v187, v23
    v_mul_f32 v188, v188, v23
    v_mul_f32 v189, v189, v23
    v_mul_f32 v190, v190, v23
    v_mul_f32 v191, v191, v23
    s_mov_b32 s56, 0
    s_branch concat_heads__gqa_block_cached__gqa_block_cached__near_ridge_kernel_rr3
concat_heads__gqa_block_cached__gqa_block_cached__near_ridge_kernel_slow4:
    v_mov_b32 v12, v11
    s_nop 1
    v_permlane32_swap_b32 v11, v12
    s_nop 1
    v_max_f32 v11, v11, v12
    v_max_f32 v11, v11, v20
    v_sub_f32 v12, v20, v11
    v_mul_f32 v12, s48, v12
    v_exp_f32 v23, v12
    v_mov_b32 v20, v11
    v_mul_f32 v22, s50, v11
    v_add_f32 v21, s51, v11
    s_mov_b32 s56, 1
    v_mul_f32 v24, v24, v23
    v_mul_f32 v25, v25, v23
    s_branch concat_heads__gqa_block_cached__gqa_block_cached__near_ridge_kernel_ret4
concat_heads__gqa_block_cached__gqa_block_cached__near_ridge_kernel_resc4:
    s_nop 7
    s_nop 7
    v_mul_f32 v128, v128, v23
    v_mul_f32 v129, v129, v23
    v_mul_f32 v130, v130, v23
    v_mul_f32 v131, v131, v23
    v_mul_f32 v132, v132, v23
    v_mul_f32 v133, v133, v23
    v_mul_f32 v134, v134, v23
    v_mul_f32 v135, v135, v23
    v_mul_f32 v136, v136, v23
    v_mul_f32 v137, v137, v23
    v_mul_f32 v138, v138, v23
    v_mul_f32 v139, v139, v23
    v_mul_f32 v140, v140, v23
    v_mul_f32 v141, v141, v23
    v_mul_f32 v142, v142, v23
    v_mul_f32 v143, v143, v23
    v_mul_f32 v144, v144, v23
    v_mul_f32 v145, v145, v23
    v_mul_f32 v146, v146, v23
    v_mul_f32 v147, v147, v23
    v_mul_f32 v148, v148, v23
    v_mul_f32 v149, v149, v23
    v_mul_f32 v150, v150, v23
    v_mul_f32 v151, v151, v23
    v_mul_f32 v152, v152, v23
    v_mul_f32 v153, v153, v23
    v_mul_f32 v154, v154, v23
    v_mul_f32 v155, v155, v23
    v_mul_f32 v156, v156, v23
    v_mul_f32 v157, v157, v23
    v_mul_f32 v158, v158, v23
    v_mul_f32 v159, v159, v23
    v_mul_f32 v160, v160, v23
    v_mul_f32 v161, v161, v23
    v_mul_f32 v162, v162, v23
    v_mul_f32 v163, v163, v23
    v_mul_f32 v164, v164, v23
    v_mul_f32 v165, v165, v23
    v_mul_f32 v166, v166, v23
    v_mul_f32 v167, v167, v23
    v_mul_f32 v168, v168, v23
    v_mul_f32 v169, v169, v23
    v_mul_f32 v170, v170, v23
    v_mul_f32 v171, v171, v23
    v_mul_f32 v172, v172, v23
    v_mul_f32 v173, v173, v23
    v_mul_f32 v174, v174, v23
    v_mul_f32 v175, v175, v23
    v_mul_f32 v176, v176, v23
    v_mul_f32 v177, v177, v23
    v_mul_f32 v178, v178, v23
    v_mul_f32 v179, v179, v23
    v_mul_f32 v180, v180, v23
    v_mul_f32 v181, v181, v23
    v_mul_f32 v182, v182, v23
    v_mul_f32 v183, v183, v23
    v_mul_f32 v184, v184, v23
    v_mul_f32 v185, v185, v23
    v_mul_f32 v186, v186, v23
    v_mul_f32 v187, v187, v23
    v_mul_f32 v188, v188, v23
    v_mul_f32 v189, v189, v23
    v_mul_f32 v190, v190, v23
    v_mul_f32 v191, v191, v23
    s_mov_b32 s56, 0
    s_branch concat_heads__gqa_block_cached__gqa_block_cached__near_ridge_kernel_rr4
concat_heads__gqa_block_cached__gqa_block_cached__near_ridge_kernel_slow5:
    v_mov_b32 v12, v11
    s_nop 1
    v_permlane32_swap_b32 v11, v12
    s_nop 1
    v_max_f32 v11, v11, v12
    v_max_f32 v11, v11, v20
    v_sub_f32 v12, v20, v11
    v_mul_f32 v12, s48, v12
    v_exp_f32 v23, v12
    v_mov_b32 v20, v11
    v_mul_f32 v22, s50, v11
    v_add_f32 v21, s51, v11
    s_mov_b32 s56, 1
    v_mul_f32 v24, v24, v23
    v_mul_f32 v25, v25, v23
    s_branch concat_heads__gqa_block_cached__gqa_block_cached__near_ridge_kernel_ret5
concat_heads__gqa_block_cached__gqa_block_cached__near_ridge_kernel_resc5:
    s_nop 7
    s_nop 7
    v_mul_f32 v128, v128, v23
    v_mul_f32 v129, v129, v23
    v_mul_f32 v130, v130, v23
    v_mul_f32 v131, v131, v23
    v_mul_f32 v132, v132, v23
    v_mul_f32 v133, v133, v23
    v_mul_f32 v134, v134, v23
    v_mul_f32 v135, v135, v23
    v_mul_f32 v136, v136, v23
    v_mul_f32 v137, v137, v23
    v_mul_f32 v138, v138, v23
    v_mul_f32 v139, v139, v23
    v_mul_f32 v140, v140, v23
    v_mul_f32 v141, v141, v23
    v_mul_f32 v142, v142, v23
    v_mul_f32 v143, v143, v23
    v_mul_f32 v144, v144, v23
    v_mul_f32 v145, v145, v23
    v_mul_f32 v146, v146, v23
    v_mul_f32 v147, v147, v23
    v_mul_f32 v148, v148, v23
    v_mul_f32 v149, v149, v23
    v_mul_f32 v150, v150, v23
    v_mul_f32 v151, v151, v23
    v_mul_f32 v152, v152, v23
    v_mul_f32 v153, v153, v23
    v_mul_f32 v154, v154, v23
    v_mul_f32 v155, v155, v23
    v_mul_f32 v156, v156, v23
    v_mul_f32 v157, v157, v23
    v_mul_f32 v158, v158, v23
    v_mul_f32 v159, v159, v23
    v_mul_f32 v160, v160, v23
    v_mul_f32 v161, v161, v23
    v_mul_f32 v162, v162, v23
    v_mul_f32 v163, v163, v23
    v_mul_f32 v164, v164, v23
    v_mul_f32 v165, v165, v23
    v_mul_f32 v166, v166, v23
    v_mul_f32 v167, v167, v23
    v_mul_f32 v168, v168, v23
    v_mul_f32 v169, v169, v23
    v_mul_f32 v170, v170, v23
    v_mul_f32 v171, v171, v23
    v_mul_f32 v172, v172, v23
    v_mul_f32 v173, v173, v23
    v_mul_f32 v174, v174, v23
    v_mul_f32 v175, v175, v23
    v_mul_f32 v176, v176, v23
    v_mul_f32 v177, v177, v23
    v_mul_f32 v178, v178, v23
    v_mul_f32 v179, v179, v23
    v_mul_f32 v180, v180, v23
    v_mul_f32 v181, v181, v23
    v_mul_f32 v182, v182, v23
    v_mul_f32 v183, v183, v23
    v_mul_f32 v184, v184, v23
    v_mul_f32 v185, v185, v23
    v_mul_f32 v186, v186, v23
    v_mul_f32 v187, v187, v23
    v_mul_f32 v188, v188, v23
    v_mul_f32 v189, v189, v23
    v_mul_f32 v190, v190, v23
    v_mul_f32 v191, v191, v23
    s_mov_b32 s56, 0
    s_branch concat_heads__gqa_block_cached__gqa_block_cached__near_ridge_kernel_rr5
concat_heads__gqa_block_cached__gqa_block_cached__near_ridge_kernel_slow6:
    v_mov_b32 v12, v11
    s_nop 1
    v_permlane32_swap_b32 v11, v12
    s_nop 1
    v_max_f32 v11, v11, v12
    v_max_f32 v11, v11, v20
    v_sub_f32 v12, v20, v11
    v_mul_f32 v12, s48, v12
    v_exp_f32 v23, v12
    v_mov_b32 v20, v11
    v_mul_f32 v22, s50, v11
    v_add_f32 v21, s51, v11
    s_mov_b32 s56, 1
    v_mul_f32 v24, v24, v23
    v_mul_f32 v25, v25, v23
    s_branch concat_heads__gqa_block_cached__gqa_block_cached__near_ridge_kernel_ret6
concat_heads__gqa_block_cached__gqa_block_cached__near_ridge_kernel_resc6:
    s_nop 7
    s_nop 7
    v_mul_f32 v128, v128, v23
    v_mul_f32 v129, v129, v23
    v_mul_f32 v130, v130, v23
    v_mul_f32 v131, v131, v23
    v_mul_f32 v132, v132, v23
    v_mul_f32 v133, v133, v23
    v_mul_f32 v134, v134, v23
    v_mul_f32 v135, v135, v23
    v_mul_f32 v136, v136, v23
    v_mul_f32 v137, v137, v23
    v_mul_f32 v138, v138, v23
    v_mul_f32 v139, v139, v23
    v_mul_f32 v140, v140, v23
    v_mul_f32 v141, v141, v23
    v_mul_f32 v142, v142, v23
    v_mul_f32 v143, v143, v23
    v_mul_f32 v144, v144, v23
    v_mul_f32 v145, v145, v23
    v_mul_f32 v146, v146, v23
    v_mul_f32 v147, v147, v23
    v_mul_f32 v148, v148, v23
    v_mul_f32 v149, v149, v23
    v_mul_f32 v150, v150, v23
    v_mul_f32 v151, v151, v23
    v_mul_f32 v152, v152, v23
    v_mul_f32 v153, v153, v23
    v_mul_f32 v154, v154, v23
    v_mul_f32 v155, v155, v23
    v_mul_f32 v156, v156, v23
    v_mul_f32 v157, v157, v23
    v_mul_f32 v158, v158, v23
    v_mul_f32 v159, v159, v23
    v_mul_f32 v160, v160, v23
    v_mul_f32 v161, v161, v23
    v_mul_f32 v162, v162, v23
    v_mul_f32 v163, v163, v23
    v_mul_f32 v164, v164, v23
    v_mul_f32 v165, v165, v23
    v_mul_f32 v166, v166, v23
    v_mul_f32 v167, v167, v23
    v_mul_f32 v168, v168, v23
    v_mul_f32 v169, v169, v23
    v_mul_f32 v170, v170, v23
    v_mul_f32 v171, v171, v23
    v_mul_f32 v172, v172, v23
    v_mul_f32 v173, v173, v23
    v_mul_f32 v174, v174, v23
    v_mul_f32 v175, v175, v23
    v_mul_f32 v176, v176, v23
    v_mul_f32 v177, v177, v23
    v_mul_f32 v178, v178, v23
    v_mul_f32 v179, v179, v23
    v_mul_f32 v180, v180, v23
    v_mul_f32 v181, v181, v23
    v_mul_f32 v182, v182, v23
    v_mul_f32 v183, v183, v23
    v_mul_f32 v184, v184, v23
    v_mul_f32 v185, v185, v23
    v_mul_f32 v186, v186, v23
    v_mul_f32 v187, v187, v23
    v_mul_f32 v188, v188, v23
    v_mul_f32 v189, v189, v23
    v_mul_f32 v190, v190, v23
    v_mul_f32 v191, v191, v23
    s_mov_b32 s56, 0
    s_branch concat_heads__gqa_block_cached__gqa_block_cached__near_ridge_kernel_rr6
concat_heads__gqa_block_cached__gqa_block_cached__near_ridge_kernel_slow7:
    v_mov_b32 v12, v11
    s_nop 1
    v_permlane32_swap_b32 v11, v12
    s_nop 1
    v_max_f32 v11, v11, v12
    v_max_f32 v11, v11, v20
    v_sub_f32 v12, v20, v11
    v_mul_f32 v12, s48, v12
    v_exp_f32 v23, v12
    v_mov_b32 v20, v11
    v_mul_f32 v22, s50, v11
    v_add_f32 v21, s51, v11
    s_mov_b32 s56, 1
    v_mul_f32 v24, v24, v23
    v_mul_f32 v25, v25, v23
    s_branch concat_heads__gqa_block_cached__gqa_block_cached__near_ridge_kernel_ret7
concat_heads__gqa_block_cached__gqa_block_cached__near_ridge_kernel_resc7:
    s_nop 7
    s_nop 7
    v_mul_f32 v128, v128, v23
    v_mul_f32 v129, v129, v23
    v_mul_f32 v130, v130, v23
    v_mul_f32 v131, v131, v23
    v_mul_f32 v132, v132, v23
    v_mul_f32 v133, v133, v23
    v_mul_f32 v134, v134, v23
    v_mul_f32 v135, v135, v23
    v_mul_f32 v136, v136, v23
    v_mul_f32 v137, v137, v23
    v_mul_f32 v138, v138, v23
    v_mul_f32 v139, v139, v23
    v_mul_f32 v140, v140, v23
    v_mul_f32 v141, v141, v23
    v_mul_f32 v142, v142, v23
    v_mul_f32 v143, v143, v23
    v_mul_f32 v144, v144, v23
    v_mul_f32 v145, v145, v23
    v_mul_f32 v146, v146, v23
    v_mul_f32 v147, v147, v23
    v_mul_f32 v148, v148, v23
    v_mul_f32 v149, v149, v23
    v_mul_f32 v150, v150, v23
    v_mul_f32 v151, v151, v23
    v_mul_f32 v152, v152, v23
    v_mul_f32 v153, v153, v23
    v_mul_f32 v154, v154, v23
    v_mul_f32 v155, v155, v23
    v_mul_f32 v156, v156, v23
    v_mul_f32 v157, v157, v23
    v_mul_f32 v158, v158, v23
    v_mul_f32 v159, v159, v23
    v_mul_f32 v160, v160, v23
    v_mul_f32 v161, v161, v23
    v_mul_f32 v162, v162, v23
    v_mul_f32 v163, v163, v23
    v_mul_f32 v164, v164, v23
    v_mul_f32 v165, v165, v23
    v_mul_f32 v166, v166, v23
    v_mul_f32 v167, v167, v23
    v_mul_f32 v168, v168, v23
    v_mul_f32 v169, v169, v23
    v_mul_f32 v170, v170, v23
    v_mul_f32 v171, v171, v23
    v_mul_f32 v172, v172, v23
    v_mul_f32 v173, v173, v23
    v_mul_f32 v174, v174, v23
    v_mul_f32 v175, v175, v23
    v_mul_f32 v176, v176, v23
    v_mul_f32 v177, v177, v23
    v_mul_f32 v178, v178, v23
    v_mul_f32 v179, v179, v23
    v_mul_f32 v180, v180, v23
    v_mul_f32 v181, v181, v23
    v_mul_f32 v182, v182, v23
    v_mul_f32 v183, v183, v23
    v_mul_f32 v184, v184, v23
    v_mul_f32 v185, v185, v23
    v_mul_f32 v186, v186, v23
    v_mul_f32 v187, v187, v23
    v_mul_f32 v188, v188, v23
    v_mul_f32 v189, v189, v23
    v_mul_f32 v190, v190, v23
    v_mul_f32 v191, v191, v23
    s_mov_b32 s56, 0
    s_branch concat_heads__gqa_block_cached__gqa_block_cached__near_ridge_kernel_rr7
concat_heads__gqa_block_cached__gqa_block_cached__near_ridge_kernel_slow8:
    v_mov_b32 v12, v11
    s_nop 1
    v_permlane32_swap_b32 v11, v12
    s_nop 1
    v_max_f32 v11, v11, v12
    v_max_f32 v11, v11, v20
    v_sub_f32 v12, v20, v11
    v_mul_f32 v12, s48, v12
    v_exp_f32 v23, v12
    v_mov_b32 v20, v11
    v_mul_f32 v22, s50, v11
    v_add_f32 v21, s51, v11
    s_mov_b32 s56, 1
    v_mul_f32 v24, v24, v23
    v_mul_f32 v25, v25, v23
    s_branch concat_heads__gqa_block_cached__gqa_block_cached__near_ridge_kernel_ret8
concat_heads__gqa_block_cached__gqa_block_cached__near_ridge_kernel_resc8:
    s_nop 7
    s_nop 7
    v_mul_f32 v128, v128, v23
    v_mul_f32 v129, v129, v23
    v_mul_f32 v130, v130, v23
    v_mul_f32 v131, v131, v23
    v_mul_f32 v132, v132, v23
    v_mul_f32 v133, v133, v23
    v_mul_f32 v134, v134, v23
    v_mul_f32 v135, v135, v23
    v_mul_f32 v136, v136, v23
    v_mul_f32 v137, v137, v23
    v_mul_f32 v138, v138, v23
    v_mul_f32 v139, v139, v23
    v_mul_f32 v140, v140, v23
    v_mul_f32 v141, v141, v23
    v_mul_f32 v142, v142, v23
    v_mul_f32 v143, v143, v23
    v_mul_f32 v144, v144, v23
    v_mul_f32 v145, v145, v23
    v_mul_f32 v146, v146, v23
    v_mul_f32 v147, v147, v23
    v_mul_f32 v148, v148, v23
    v_mul_f32 v149, v149, v23
    v_mul_f32 v150, v150, v23
    v_mul_f32 v151, v151, v23
    v_mul_f32 v152, v152, v23
    v_mul_f32 v153, v153, v23
    v_mul_f32 v154, v154, v23
    v_mul_f32 v155, v155, v23
    v_mul_f32 v156, v156, v23
    v_mul_f32 v157, v157, v23
    v_mul_f32 v158, v158, v23
    v_mul_f32 v159, v159, v23
    v_mul_f32 v160, v160, v23
    v_mul_f32 v161, v161, v23
    v_mul_f32 v162, v162, v23
    v_mul_f32 v163, v163, v23
    v_mul_f32 v164, v164, v23
    v_mul_f32 v165, v165, v23
    v_mul_f32 v166, v166, v23
    v_mul_f32 v167, v167, v23
    v_mul_f32 v168, v168, v23
    v_mul_f32 v169, v169, v23
    v_mul_f32 v170, v170, v23
    v_mul_f32 v171, v171, v23
    v_mul_f32 v172, v172, v23
    v_mul_f32 v173, v173, v23
    v_mul_f32 v174, v174, v23
    v_mul_f32 v175, v175, v23
    v_mul_f32 v176, v176, v23
    v_mul_f32 v177, v177, v23
    v_mul_f32 v178, v178, v23
    v_mul_f32 v179, v179, v23
    v_mul_f32 v180, v180, v23
    v_mul_f32 v181, v181, v23
    v_mul_f32 v182, v182, v23
    v_mul_f32 v183, v183, v23
    v_mul_f32 v184, v184, v23
    v_mul_f32 v185, v185, v23
    v_mul_f32 v186, v186, v23
    v_mul_f32 v187, v187, v23
    v_mul_f32 v188, v188, v23
    v_mul_f32 v189, v189, v23
    v_mul_f32 v190, v190, v23
    v_mul_f32 v191, v191, v23
    s_mov_b32 s56, 0
    s_branch concat_heads__gqa_block_cached__gqa_block_cached__near_ridge_kernel_rr8
concat_heads__gqa_block_cached__gqa_block_cached__near_ridge_kernel_slow9:
    v_mov_b32 v12, v11
    s_nop 1
    v_permlane32_swap_b32 v11, v12
    s_nop 1
    v_max_f32 v11, v11, v12
    v_max_f32 v11, v11, v20
    v_sub_f32 v12, v20, v11
    v_mul_f32 v12, s48, v12
    v_exp_f32 v23, v12
    v_mov_b32 v20, v11
    v_mul_f32 v22, s50, v11
    v_add_f32 v21, s51, v11
    s_mov_b32 s56, 1
    v_mul_f32 v24, v24, v23
    v_mul_f32 v25, v25, v23
    s_branch concat_heads__gqa_block_cached__gqa_block_cached__near_ridge_kernel_ret9
concat_heads__gqa_block_cached__gqa_block_cached__near_ridge_kernel_resc9:
    s_nop 7
    s_nop 7
    v_mul_f32 v128, v128, v23
    v_mul_f32 v129, v129, v23
    v_mul_f32 v130, v130, v23
    v_mul_f32 v131, v131, v23
    v_mul_f32 v132, v132, v23
    v_mul_f32 v133, v133, v23
    v_mul_f32 v134, v134, v23
    v_mul_f32 v135, v135, v23
    v_mul_f32 v136, v136, v23
    v_mul_f32 v137, v137, v23
    v_mul_f32 v138, v138, v23
    v_mul_f32 v139, v139, v23
    v_mul_f32 v140, v140, v23
    v_mul_f32 v141, v141, v23
    v_mul_f32 v142, v142, v23
    v_mul_f32 v143, v143, v23
    v_mul_f32 v144, v144, v23
    v_mul_f32 v145, v145, v23
    v_mul_f32 v146, v146, v23
    v_mul_f32 v147, v147, v23
    v_mul_f32 v148, v148, v23
    v_mul_f32 v149, v149, v23
    v_mul_f32 v150, v150, v23
    v_mul_f32 v151, v151, v23
    v_mul_f32 v152, v152, v23
    v_mul_f32 v153, v153, v23
    v_mul_f32 v154, v154, v23
    v_mul_f32 v155, v155, v23
    v_mul_f32 v156, v156, v23
    v_mul_f32 v157, v157, v23
    v_mul_f32 v158, v158, v23
    v_mul_f32 v159, v159, v23
    v_mul_f32 v160, v160, v23
    v_mul_f32 v161, v161, v23
    v_mul_f32 v162, v162, v23
    v_mul_f32 v163, v163, v23
    v_mul_f32 v164, v164, v23
    v_mul_f32 v165, v165, v23
    v_mul_f32 v166, v166, v23
    v_mul_f32 v167, v167, v23
    v_mul_f32 v168, v168, v23
    v_mul_f32 v169, v169, v23
    v_mul_f32 v170, v170, v23
    v_mul_f32 v171, v171, v23
    v_mul_f32 v172, v172, v23
    v_mul_f32 v173, v173, v23
    v_mul_f32 v174, v174, v23
    v_mul_f32 v175, v175, v23
    v_mul_f32 v176, v176, v23
    v_mul_f32 v177, v177, v23
    v_mul_f32 v178, v178, v23
    v_mul_f32 v179, v179, v23
    v_mul_f32 v180, v180, v23
    v_mul_f32 v181, v181, v23
    v_mul_f32 v182, v182, v23
    v_mul_f32 v183, v183, v23
    v_mul_f32 v184, v184, v23
    v_mul_f32 v185, v185, v23
    v_mul_f32 v186, v186, v23
    v_mul_f32 v187, v187, v23
    v_mul_f32 v188, v188, v23
    v_mul_f32 v189, v189, v23
    v_mul_f32 v190, v190, v23
    v_mul_f32 v191, v191, v23
    s_mov_b32 s56, 0
    s_branch concat_heads__gqa_block_cached__gqa_block_cached__near_ridge_kernel_rr9
concat_heads__gqa_block_cached__gqa_block_cached__near_ridge_kernel_slow10:
    v_mov_b32 v12, v11
    s_nop 1
    v_permlane32_swap_b32 v11, v12
    s_nop 1
    v_max_f32 v11, v11, v12
    v_max_f32 v11, v11, v20
    v_sub_f32 v12, v20, v11
    v_mul_f32 v12, s48, v12
    v_exp_f32 v23, v12
    v_mov_b32 v20, v11
    v_mul_f32 v22, s50, v11
    v_add_f32 v21, s51, v11
    s_mov_b32 s56, 1
    v_mul_f32 v24, v24, v23
    v_mul_f32 v25, v25, v23
    s_branch concat_heads__gqa_block_cached__gqa_block_cached__near_ridge_kernel_ret10
concat_heads__gqa_block_cached__gqa_block_cached__near_ridge_kernel_resc10:
    s_nop 7
    s_nop 7
    v_mul_f32 v128, v128, v23
    v_mul_f32 v129, v129, v23
    v_mul_f32 v130, v130, v23
    v_mul_f32 v131, v131, v23
    v_mul_f32 v132, v132, v23
    v_mul_f32 v133, v133, v23
    v_mul_f32 v134, v134, v23
    v_mul_f32 v135, v135, v23
    v_mul_f32 v136, v136, v23
    v_mul_f32 v137, v137, v23
    v_mul_f32 v138, v138, v23
    v_mul_f32 v139, v139, v23
    v_mul_f32 v140, v140, v23
    v_mul_f32 v141, v141, v23
    v_mul_f32 v142, v142, v23
    v_mul_f32 v143, v143, v23
    v_mul_f32 v144, v144, v23
    v_mul_f32 v145, v145, v23
    v_mul_f32 v146, v146, v23
    v_mul_f32 v147, v147, v23
    v_mul_f32 v148, v148, v23
    v_mul_f32 v149, v149, v23
    v_mul_f32 v150, v150, v23
    v_mul_f32 v151, v151, v23
    v_mul_f32 v152, v152, v23
    v_mul_f32 v153, v153, v23
    v_mul_f32 v154, v154, v23
    v_mul_f32 v155, v155, v23
    v_mul_f32 v156, v156, v23
    v_mul_f32 v157, v157, v23
    v_mul_f32 v158, v158, v23
    v_mul_f32 v159, v159, v23
    v_mul_f32 v160, v160, v23
    v_mul_f32 v161, v161, v23
    v_mul_f32 v162, v162, v23
    v_mul_f32 v163, v163, v23
    v_mul_f32 v164, v164, v23
    v_mul_f32 v165, v165, v23
    v_mul_f32 v166, v166, v23
    v_mul_f32 v167, v167, v23
    v_mul_f32 v168, v168, v23
    v_mul_f32 v169, v169, v23
    v_mul_f32 v170, v170, v23
    v_mul_f32 v171, v171, v23
    v_mul_f32 v172, v172, v23
    v_mul_f32 v173, v173, v23
    v_mul_f32 v174, v174, v23
    v_mul_f32 v175, v175, v23
    v_mul_f32 v176, v176, v23
    v_mul_f32 v177, v177, v23
    v_mul_f32 v178, v178, v23
    v_mul_f32 v179, v179, v23
    v_mul_f32 v180, v180, v23
    v_mul_f32 v181, v181, v23
    v_mul_f32 v182, v182, v23
    v_mul_f32 v183, v183, v23
    v_mul_f32 v184, v184, v23
    v_mul_f32 v185, v185, v23
    v_mul_f32 v186, v186, v23
    v_mul_f32 v187, v187, v23
    v_mul_f32 v188, v188, v23
    v_mul_f32 v189, v189, v23
    v_mul_f32 v190, v190, v23
    v_mul_f32 v191, v191, v23
    s_mov_b32 s56, 0
    s_branch concat_heads__gqa_block_cached__gqa_block_cached__near_ridge_kernel_rr10
concat_heads__gqa_block_cached__gqa_block_cached__near_ridge_kernel_slow11:
    v_mov_b32 v12, v11
    s_nop 1
    v_permlane32_swap_b32 v11, v12
    s_nop 1
    v_max_f32 v11, v11, v12
    v_max_f32 v11, v11, v20
    v_sub_f32 v12, v20, v11
    v_mul_f32 v12, s48, v12
    v_exp_f32 v23, v12
    v_mov_b32 v20, v11
    v_mul_f32 v22, s50, v11
    v_add_f32 v21, s51, v11
    s_mov_b32 s56, 1
    v_mul_f32 v24, v24, v23
    v_mul_f32 v25, v25, v23
    s_branch concat_heads__gqa_block_cached__gqa_block_cached__near_ridge_kernel_ret11
concat_heads__gqa_block_cached__gqa_block_cached__near_ridge_kernel_resc11:
    s_nop 7
    s_nop 7
    v_mul_f32 v128, v128, v23
    v_mul_f32 v129, v129, v23
    v_mul_f32 v130, v130, v23
    v_mul_f32 v131, v131, v23
    v_mul_f32 v132, v132, v23
    v_mul_f32 v133, v133, v23
    v_mul_f32 v134, v134, v23
    v_mul_f32 v135, v135, v23
    v_mul_f32 v136, v136, v23
    v_mul_f32 v137, v137, v23
    v_mul_f32 v138, v138, v23
    v_mul_f32 v139, v139, v23
    v_mul_f32 v140, v140, v23
    v_mul_f32 v141, v141, v23
    v_mul_f32 v142, v142, v23
    v_mul_f32 v143, v143, v23
    v_mul_f32 v144, v144, v23
    v_mul_f32 v145, v145, v23
    v_mul_f32 v146, v146, v23
    v_mul_f32 v147, v147, v23
    v_mul_f32 v148, v148, v23
    v_mul_f32 v149, v149, v23
    v_mul_f32 v150, v150, v23
    v_mul_f32 v151, v151, v23
    v_mul_f32 v152, v152, v23
    v_mul_f32 v153, v153, v23
    v_mul_f32 v154, v154, v23
    v_mul_f32 v155, v155, v23
    v_mul_f32 v156, v156, v23
    v_mul_f32 v157, v157, v23
    v_mul_f32 v158, v158, v23
    v_mul_f32 v159, v159, v23
    v_mul_f32 v160, v160, v23
    v_mul_f32 v161, v161, v23
    v_mul_f32 v162, v162, v23
    v_mul_f32 v163, v163, v23
    v_mul_f32 v164, v164, v23
    v_mul_f32 v165, v165, v23
    v_mul_f32 v166, v166, v23
    v_mul_f32 v167, v167, v23
    v_mul_f32 v168, v168, v23
    v_mul_f32 v169, v169, v23
    v_mul_f32 v170, v170, v23
    v_mul_f32 v171, v171, v23
    v_mul_f32 v172, v172, v23
    v_mul_f32 v173, v173, v23
    v_mul_f32 v174, v174, v23
    v_mul_f32 v175, v175, v23
    v_mul_f32 v176, v176, v23
    v_mul_f32 v177, v177, v23
    v_mul_f32 v178, v178, v23
    v_mul_f32 v179, v179, v23
    v_mul_f32 v180, v180, v23
    v_mul_f32 v181, v181, v23
    v_mul_f32 v182, v182, v23
    v_mul_f32 v183, v183, v23
    v_mul_f32 v184, v184, v23
    v_mul_f32 v185, v185, v23
    v_mul_f32 v186, v186, v23
    v_mul_f32 v187, v187, v23
    v_mul_f32 v188, v188, v23
    v_mul_f32 v189, v189, v23
    v_mul_f32 v190, v190, v23
    v_mul_f32 v191, v191, v23
    s_mov_b32 s56, 0
    s_branch concat_heads__gqa_block_cached__gqa_block_cached__near_ridge_kernel_rr11
concat_heads__gqa_block_cached__gqa_block_cached__near_ridge_kernel_slow12:
    v_mov_b32 v12, v11
    s_nop 1
    v_permlane32_swap_b32 v11, v12
    s_nop 1
    v_max_f32 v11, v11, v12
    v_max_f32 v11, v11, v20
    v_sub_f32 v12, v20, v11
    v_mul_f32 v12, s48, v12
    v_exp_f32 v23, v12
    v_mov_b32 v20, v11
    v_mul_f32 v22, s50, v11
    v_add_f32 v21, s51, v11
    s_mov_b32 s56, 1
    v_mul_f32 v24, v24, v23
    v_mul_f32 v25, v25, v23
    s_branch concat_heads__gqa_block_cached__gqa_block_cached__near_ridge_kernel_ret12
concat_heads__gqa_block_cached__gqa_block_cached__near_ridge_kernel_resc12:
    s_nop 7
    s_nop 7
    v_mul_f32 v128, v128, v23
    v_mul_f32 v129, v129, v23
    v_mul_f32 v130, v130, v23
    v_mul_f32 v131, v131, v23
    v_mul_f32 v132, v132, v23
    v_mul_f32 v133, v133, v23
    v_mul_f32 v134, v134, v23
    v_mul_f32 v135, v135, v23
    v_mul_f32 v136, v136, v23
    v_mul_f32 v137, v137, v23
    v_mul_f32 v138, v138, v23
    v_mul_f32 v139, v139, v23
    v_mul_f32 v140, v140, v23
    v_mul_f32 v141, v141, v23
    v_mul_f32 v142, v142, v23
    v_mul_f32 v143, v143, v23
    v_mul_f32 v144, v144, v23
    v_mul_f32 v145, v145, v23
    v_mul_f32 v146, v146, v23
    v_mul_f32 v147, v147, v23
    v_mul_f32 v148, v148, v23
    v_mul_f32 v149, v149, v23
    v_mul_f32 v150, v150, v23
    v_mul_f32 v151, v151, v23
    v_mul_f32 v152, v152, v23
    v_mul_f32 v153, v153, v23
    v_mul_f32 v154, v154, v23
    v_mul_f32 v155, v155, v23
    v_mul_f32 v156, v156, v23
    v_mul_f32 v157, v157, v23
    v_mul_f32 v158, v158, v23
    v_mul_f32 v159, v159, v23
    v_mul_f32 v160, v160, v23
    v_mul_f32 v161, v161, v23
    v_mul_f32 v162, v162, v23
    v_mul_f32 v163, v163, v23
    v_mul_f32 v164, v164, v23
    v_mul_f32 v165, v165, v23
    v_mul_f32 v166, v166, v23
    v_mul_f32 v167, v167, v23
    v_mul_f32 v168, v168, v23
    v_mul_f32 v169, v169, v23
    v_mul_f32 v170, v170, v23
    v_mul_f32 v171, v171, v23
    v_mul_f32 v172, v172, v23
    v_mul_f32 v173, v173, v23
    v_mul_f32 v174, v174, v23
    v_mul_f32 v175, v175, v23
    v_mul_f32 v176, v176, v23
    v_mul_f32 v177, v177, v23
    v_mul_f32 v178, v178, v23
    v_mul_f32 v179, v179, v23
    v_mul_f32 v180, v180, v23
    v_mul_f32 v181, v181, v23
    v_mul_f32 v182, v182, v23
    v_mul_f32 v183, v183, v23
    v_mul_f32 v184, v184, v23
    v_mul_f32 v185, v185, v23
    v_mul_f32 v186, v186, v23
    v_mul_f32 v187, v187, v23
    v_mul_f32 v188, v188, v23
    v_mul_f32 v189, v189, v23
    v_mul_f32 v190, v190, v23
    v_mul_f32 v191, v191, v23
    s_mov_b32 s56, 0
    s_branch concat_heads__gqa_block_cached__gqa_block_cached__near_ridge_kernel_rr12
concat_heads__gqa_block_cached__gqa_block_cached__near_ridge_kernel_slow13:
    v_mov_b32 v12, v11
    s_nop 1
    v_permlane32_swap_b32 v11, v12
    s_nop 1
    v_max_f32 v11, v11, v12
    v_max_f32 v11, v11, v20
    v_sub_f32 v12, v20, v11
    v_mul_f32 v12, s48, v12
    v_exp_f32 v23, v12
    v_mov_b32 v20, v11
    v_mul_f32 v22, s50, v11
    v_add_f32 v21, s51, v11
    s_mov_b32 s56, 1
    v_mul_f32 v24, v24, v23
    v_mul_f32 v25, v25, v23
    s_branch concat_heads__gqa_block_cached__gqa_block_cached__near_ridge_kernel_ret13
concat_heads__gqa_block_cached__gqa_block_cached__near_ridge_kernel_resc13:
    s_nop 7
    s_nop 7
    v_mul_f32 v128, v128, v23
    v_mul_f32 v129, v129, v23
    v_mul_f32 v130, v130, v23
    v_mul_f32 v131, v131, v23
    v_mul_f32 v132, v132, v23
    v_mul_f32 v133, v133, v23
    v_mul_f32 v134, v134, v23
    v_mul_f32 v135, v135, v23
    v_mul_f32 v136, v136, v23
    v_mul_f32 v137, v137, v23
    v_mul_f32 v138, v138, v23
    v_mul_f32 v139, v139, v23
    v_mul_f32 v140, v140, v23
    v_mul_f32 v141, v141, v23
    v_mul_f32 v142, v142, v23
    v_mul_f32 v143, v143, v23
    v_mul_f32 v144, v144, v23
    v_mul_f32 v145, v145, v23
    v_mul_f32 v146, v146, v23
    v_mul_f32 v147, v147, v23
    v_mul_f32 v148, v148, v23
    v_mul_f32 v149, v149, v23
    v_mul_f32 v150, v150, v23
    v_mul_f32 v151, v151, v23
    v_mul_f32 v152, v152, v23
    v_mul_f32 v153, v153, v23
    v_mul_f32 v154, v154, v23
    v_mul_f32 v155, v155, v23
    v_mul_f32 v156, v156, v23
    v_mul_f32 v157, v157, v23
    v_mul_f32 v158, v158, v23
    v_mul_f32 v159, v159, v23
    v_mul_f32 v160, v160, v23
    v_mul_f32 v161, v161, v23
    v_mul_f32 v162, v162, v23
    v_mul_f32 v163, v163, v23
    v_mul_f32 v164, v164, v23
    v_mul_f32 v165, v165, v23
    v_mul_f32 v166, v166, v23
    v_mul_f32 v167, v167, v23
    v_mul_f32 v168, v168, v23
    v_mul_f32 v169, v169, v23
    v_mul_f32 v170, v170, v23
    v_mul_f32 v171, v171, v23
    v_mul_f32 v172, v172, v23
    v_mul_f32 v173, v173, v23
    v_mul_f32 v174, v174, v23
    v_mul_f32 v175, v175, v23
    v_mul_f32 v176, v176, v23
    v_mul_f32 v177, v177, v23
    v_mul_f32 v178, v178, v23
    v_mul_f32 v179, v179, v23
    v_mul_f32 v180, v180, v23
    v_mul_f32 v181, v181, v23
    v_mul_f32 v182, v182, v23
    v_mul_f32 v183, v183, v23
    v_mul_f32 v184, v184, v23
    v_mul_f32 v185, v185, v23
    v_mul_f32 v186, v186, v23
    v_mul_f32 v187, v187, v23
    v_mul_f32 v188, v188, v23
    v_mul_f32 v189, v189, v23
    v_mul_f32 v190, v190, v23
    v_mul_f32 v191, v191, v23
    s_mov_b32 s56, 0
    s_branch concat_heads__gqa_block_cached__gqa_block_cached__near_ridge_kernel_rr13
concat_heads__gqa_block_cached__gqa_block_cached__near_ridge_kernel_slow14:
    v_mov_b32 v12, v11
    s_nop 1
    v_permlane32_swap_b32 v11, v12
    s_nop 1
    v_max_f32 v11, v11, v12
    v_max_f32 v11, v11, v20
    v_sub_f32 v12, v20, v11
    v_mul_f32 v12, s48, v12
    v_exp_f32 v23, v12
    v_mov_b32 v20, v11
    v_mul_f32 v22, s50, v11
    v_add_f32 v21, s51, v11
    s_mov_b32 s56, 1
    v_mul_f32 v24, v24, v23
    v_mul_f32 v25, v25, v23
    s_branch concat_heads__gqa_block_cached__gqa_block_cached__near_ridge_kernel_ret14
concat_heads__gqa_block_cached__gqa_block_cached__near_ridge_kernel_resc14:
    s_nop 7
    s_nop 7
    v_mul_f32 v128, v128, v23
    v_mul_f32 v129, v129, v23
    v_mul_f32 v130, v130, v23
    v_mul_f32 v131, v131, v23
    v_mul_f32 v132, v132, v23
    v_mul_f32 v133, v133, v23
    v_mul_f32 v134, v134, v23
    v_mul_f32 v135, v135, v23
    v_mul_f32 v136, v136, v23
    v_mul_f32 v137, v137, v23
    v_mul_f32 v138, v138, v23
    v_mul_f32 v139, v139, v23
    v_mul_f32 v140, v140, v23
    v_mul_f32 v141, v141, v23
    v_mul_f32 v142, v142, v23
    v_mul_f32 v143, v143, v23
    v_mul_f32 v144, v144, v23
    v_mul_f32 v145, v145, v23
    v_mul_f32 v146, v146, v23
    v_mul_f32 v147, v147, v23
    v_mul_f32 v148, v148, v23
    v_mul_f32 v149, v149, v23
    v_mul_f32 v150, v150, v23
    v_mul_f32 v151, v151, v23
    v_mul_f32 v152, v152, v23
    v_mul_f32 v153, v153, v23
    v_mul_f32 v154, v154, v23
    v_mul_f32 v155, v155, v23
    v_mul_f32 v156, v156, v23
    v_mul_f32 v157, v157, v23
    v_mul_f32 v158, v158, v23
    v_mul_f32 v159, v159, v23
    v_mul_f32 v160, v160, v23
    v_mul_f32 v161, v161, v23
    v_mul_f32 v162, v162, v23
    v_mul_f32 v163, v163, v23
    v_mul_f32 v164, v164, v23
    v_mul_f32 v165, v165, v23
    v_mul_f32 v166, v166, v23
    v_mul_f32 v167, v167, v23
    v_mul_f32 v168, v168, v23
    v_mul_f32 v169, v169, v23
    v_mul_f32 v170, v170, v23
    v_mul_f32 v171, v171, v23
    v_mul_f32 v172, v172, v23
    v_mul_f32 v173, v173, v23
    v_mul_f32 v174, v174, v23
    v_mul_f32 v175, v175, v23
    v_mul_f32 v176, v176, v23
    v_mul_f32 v177, v177, v23
    v_mul_f32 v178, v178, v23
    v_mul_f32 v179, v179, v23
    v_mul_f32 v180, v180, v23
    v_mul_f32 v181, v181, v23
    v_mul_f32 v182, v182, v23
    v_mul_f32 v183, v183, v23
    v_mul_f32 v184, v184, v23
    v_mul_f32 v185, v185, v23
    v_mul_f32 v186, v186, v23
    v_mul_f32 v187, v187, v23
    v_mul_f32 v188, v188, v23
    v_mul_f32 v189, v189, v23
    v_mul_f32 v190, v190, v23
    v_mul_f32 v191, v191, v23
    s_mov_b32 s56, 0
    s_branch concat_heads__gqa_block_cached__gqa_block_cached__near_ridge_kernel_rr14
concat_heads__gqa_block_cached__gqa_block_cached__near_ridge_kernel_slow15:
    v_mov_b32 v12, v11
    s_nop 1
    v_permlane32_swap_b32 v11, v12
    s_nop 1
    v_max_f32 v11, v11, v12
    v_max_f32 v11, v11, v20
    v_sub_f32 v12, v20, v11
    v_mul_f32 v12, s48, v12
    v_exp_f32 v23, v12
    v_mov_b32 v20, v11
    v_mul_f32 v22, s50, v11
    v_add_f32 v21, s51, v11
    s_mov_b32 s56, 1
    v_mul_f32 v24, v24, v23
    v_mul_f32 v25, v25, v23
    s_branch concat_heads__gqa_block_cached__gqa_block_cached__near_ridge_kernel_ret15
concat_heads__gqa_block_cached__gqa_block_cached__near_ridge_kernel_resc15:
    s_nop 7
    s_nop 7
    v_mul_f32 v128, v128, v23
    v_mul_f32 v129, v129, v23
    v_mul_f32 v130, v130, v23
    v_mul_f32 v131, v131, v23
    v_mul_f32 v132, v132, v23
    v_mul_f32 v133, v133, v23
    v_mul_f32 v134, v134, v23
    v_mul_f32 v135, v135, v23
    v_mul_f32 v136, v136, v23
    v_mul_f32 v137, v137, v23
    v_mul_f32 v138, v138, v23
    v_mul_f32 v139, v139, v23
    v_mul_f32 v140, v140, v23
    v_mul_f32 v141, v141, v23
    v_mul_f32 v142, v142, v23
    v_mul_f32 v143, v143, v23
    v_mul_f32 v144, v144, v23
    v_mul_f32 v145, v145, v23
    v_mul_f32 v146, v146, v23
    v_mul_f32 v147, v147, v23
    v_mul_f32 v148, v148, v23
    v_mul_f32 v149, v149, v23
    v_mul_f32 v150, v150, v23
    v_mul_f32 v151, v151, v23
    v_mul_f32 v152, v152, v23
    v_mul_f32 v153, v153, v23
    v_mul_f32 v154, v154, v23
    v_mul_f32 v155, v155, v23
    v_mul_f32 v156, v156, v23
    v_mul_f32 v157, v157, v23
    v_mul_f32 v158, v158, v23
    v_mul_f32 v159, v159, v23
    v_mul_f32 v160, v160, v23
    v_mul_f32 v161, v161, v23
    v_mul_f32 v162, v162, v23
    v_mul_f32 v163, v163, v23
    v_mul_f32 v164, v164, v23
    v_mul_f32 v165, v165, v23
    v_mul_f32 v166, v166, v23
    v_mul_f32 v167, v167, v23
    v_mul_f32 v168, v168, v23
    v_mul_f32 v169, v169, v23
    v_mul_f32 v170, v170, v23
    v_mul_f32 v171, v171, v23
    v_mul_f32 v172, v172, v23
    v_mul_f32 v173, v173, v23
    v_mul_f32 v174, v174, v23
    v_mul_f32 v175, v175, v23
    v_mul_f32 v176, v176, v23
    v_mul_f32 v177, v177, v23
    v_mul_f32 v178, v178, v23
    v_mul_f32 v179, v179, v23
    v_mul_f32 v180, v180, v23
    v_mul_f32 v181, v181, v23
    v_mul_f32 v182, v182, v23
    v_mul_f32 v183, v183, v23
    v_mul_f32 v184, v184, v23
    v_mul_f32 v185, v185, v23
    v_mul_f32 v186, v186, v23
    v_mul_f32 v187, v187, v23
    v_mul_f32 v188, v188, v23
    v_mul_f32 v189, v189, v23
    v_mul_f32 v190, v190, v23
    v_mul_f32 v191, v191, v23
    s_mov_b32 s56, 0
    s_branch concat_heads__gqa_block_cached__gqa_block_cached__near_ridge_kernel_rr15
concat_heads__gqa_block_cached__gqa_block_cached__near_ridge_kernel_w7:
    v_lshrrev_b32 v11, 5, v2
    v_bfe_u32 v12, v2, 1, 4
    v_and_b32 v13, 1, v2
    v_lshlrev_b32 v13, 4, v13
    s_bfe_u32 s46, s45, 0x10001
    s_lshl_b32 s46, s46, 2
    v_add_u32 v14, 0, v11
    v_or_b32 v15, s46, v14
    v_xor_b32 v15, v15, v12
    v_lshlrev_b32 v15, 5, v15
    v_lshlrev_b32 v14, 13, v14
    v_add3_u32 v104, v14, v15, v13
    v_add_u32 v14, 2, v11
    v_or_b32 v15, s46, v14
    v_xor_b32 v15, v15, v12
    v_lshlrev_b32 v15, 5, v15
    v_lshlrev_b32 v14, 13, v14
    v_add3_u32 v105, v14, v15, v13
    s_waitcnt lgkmcnt(0)
    s_cmp_eq_u32 s43, 0
    s_cselect_b32 s4, s4, s12
    s_cselect_b32 s5, s5, s13
    s_cselect_b32 s6, s6, s14
    s_cselect_b32 s7, s7, s15
    s_cselect_b32 s8, s8, s16
    s_cselect_b32 s9, s9, s17
    s_cselect_b32 s10, s10, s18
    s_cselect_b32 s11, s11, s19
    s_mul_i32 s46, s42, 129024
    s_add_u32 s20, s4, s46
    s_addc_u32 s21, s5, 0
    s_mov_b32 s22, 129024
    s_mov_b32 s23, 0x00020000
    s_lshl_b32 s46, s44, 9
    s_add_u32 s24, s10, s46
    s_addc_u32 s25, s11, 0
    s_sub_u32 s26, 4718592, s46
    s_mov_b32 s27, 0x00020000
    s_add_u32 m0, s54, 116736
    s_add_u32 s47, s53, s96
    buffer_load_dwordx4 v104, s[24:27], s47 offen lds
    s_add_u32 m0, s54, 117760
    s_add_u32 s47, s53, s96
    buffer_load_dwordx4 v105, s[24:27], s47 offen lds
    s_add_u32 s96, s96, 262144
    s_cmp_ge_u32 s96, 4718592
    s_cselect_b32 s96, 0, s96
    s_add_u32 m0, s54, 133120
    s_add_u32 s47, s53, s96
    buffer_load_dwordx4 v104, s[24:27], s47 offen lds
    s_add_u32 m0, s54, 134144
    s_add_u32 s47, s53, s96
    buffer_load_dwordx4 v105, s[24:27], s47 offen lds
    s_add_u32 s96, s96, 262144
    s_cmp_ge_u32 s96, 4718592
    s_cselect_b32 s96, 0, s96
    s_add_u32 m0, s54, 43008
    s_add_u32 s47, s53, s96
    buffer_load_dwordx4 v104, s[24:27], s47 offen lds
    s_add_u32 m0, s54, 44032
    s_add_u32 s47, s53, s96
    buffer_load_dwordx4 v105, s[24:27], s47 offen lds
    s_add_u32 s96, s96, 262144
    s_cmp_ge_u32 s96, 4718592
    s_cselect_b32 s96, 0, s96
    s_lshl_b32 s46, s42, 4
    s_add_u32 s46, s46, s44
    s_lshl_b32 s46, s46, 17
    s_add_u32 s28, s6, s46
    s_addc_u32 s29, s7, 0
    s_mov_b32 s30, 131072
    s_mov_b32 s31, 0x00020000
    s_add_u32 s32, s8, s46
    s_addc_u32 s33, s9, 0
    s_mov_b32 s34, 131072
    s_mov_b32 s35, 0x00020000
    s_lshl_b32 s47, s43, 3
    s_add_u32 s47, s47, s42
    s_mul_i32 s46, s47, 2129920
    s_add_u32 s88, s40, s46
    s_addc_u32 s89, s41, 0
    s_mov_b32 s90, 2127872
    s_mov_b32 s91, 0x00020000
    s_mul_i32 s46, s44, 133120
    s_add_u32 s36, s88, s46
    s_addc_u32 s37, s89, 0
    s_mov_b32 s38, 131072
    s_mov_b32 s39, 0x00020000
    s_mov_b32 s80, s76
    s_mov_b32 s81, s77
    s_mov_b32 s82, 2064384
    s_mov_b32 s83, 0x00020000
    s_lshl_b32 s46, s47, 4
    s_add_u32 s84, s78, s46
    s_addc_u32 s85, s79, 0
    s_mov_b32 s86, 16
    s_mov_b32 s87, 0x00020000
    s_cmp_eq_u32 s43, 0
    s_cselect_b32 s72, s68, s70
    s_cselect_b32 s73, s69, s71
    s_mul_i32 s46, s44, 294912
    s_add_u32 s72, s72, s46
    s_addc_u32 s73, s73, 0
    s_mov_b32 s74, 294912
    s_mov_b32 s75, 0x00020000
    v_lshlrev_b32 v19, 7, v2
    v_lshrrev_b32 v25, 2, v2
    v_lshlrev_b32 v25, 13, v25
    v_and_b32 v11, 3, v2
    v_lshl_add_u32 v25, v11, 7, v25
    v_lshrrev_b32 v11, 4, v2
    v_and_b32 v12, 15, v2
    v_lshlrev_b32 v14, 8, v11
    v_add_u32 v13, 0, v11
    v_xor_b32 v13, v13, v12
    v_lshl_add_u32 v13, v13, 4, v14
    v_add_u32 v3, 0, v13
    v_add_u32 v13, 4, v11
    v_xor_b32 v13, v13, v12
    v_lshl_add_u32 v13, v13, 4, v14
    v_add_u32 v4, 1024, v13
    v_add_u32 v13, 8, v11
    v_xor_b32 v13, v13, v12
    v_lshl_add_u32 v13, v13, 4, v14
    v_add_u32 v5, 2048, v13
    v_add_u32 v13, 12, v11
    v_xor_b32 v13, v13, v12
    v_lshl_add_u32 v13, v13, 4, v14
    v_add_u32 v9, 3072, v13
    v_lshlrev_b32 v13, 2, v11
    v_xor_b32 v13, v13, v12
    v_lshl_add_u32 v18, v13, 4, v14
    v_lshrrev_b32 v11, 4, v2
    v_bfe_u32 v12, v2, 2, 2
    v_and_b32 v13, 3, v2
    v_lshlrev_b32 v14, 3, v11
    v_add_u32 v14, v14, v12
    v_lshlrev_b32 v14, 9, v14
    v_lshlrev_b32 v13, 3, v13
    v_add_u32 v14, v14, v13
    v_and_b32 v15, 1, v11
    v_lshlrev_b32 v15, 2, v15
    v_or_b32 v15, v15, v12
    s_lshl_b32 s46, s45, 1
    s_add_u32 s47, s46, 0
    v_xor_b32 v16, s47, v15
    v_lshlrev_b32 v16, 5, v16
    v_add_u32 v6, v14, v16
    s_add_u32 s47, s46, 1
    v_xor_b32 v16, s47, v15
    v_lshlrev_b32 v16, 5, v16
    v_add_u32 v7, v14, v16
    v_add_u32 v10, 83968, v6
    v_add_u32 v29, 83968, v7
    v_add_u32 v6, 43008, v6
    v_add_u32 v7, 43008, v7
    v_bfe_u32 v12, v2, 1, 3
    v_xor_b32 v12, v12, v11
    v_lshlrev_b32 v12, 4, v12
    v_and_b32 v14, 15, v2
    v_lshl_add_u32 v8, v14, 7, v12
    v_xor_b32 v31, 64, v8
    s_bfe_u32 s61, s45, 0x10001
    s_and_b32 s59, s45, 1
    v_lshrrev_b32 v11, 5, v2
    v_bfe_u32 v12, v2, 1, 4
    v_and_b32 v13, 1, v2
    v_lshlrev_b32 v13, 4, v13
    s_lshl_b32 s46, s61, 2
    v_add_u32 v14, 0, v11
    v_or_b32 v15, s46, v14
    v_xor_b32 v15, v15, v12
    v_lshlrev_b32 v15, 5, v15
    v_mul_u32_u24 v14, 1152, v14
    v_add3_u32 v26, v14, v15, v13
    v_add_u32 v14, 2, v11
    v_or_b32 v15, s46, v14
    v_xor_b32 v15, v15, v12
    v_lshlrev_b32 v15, 5, v15
    v_mul_u32_u24 v14, 1152, v14
    v_add3_u32 v27, v14, v15, v13
    s_lshl_b32 s46, s59, 1
    v_lshrrev_b32 v11, 3, v2
    v_mul_u32_u24 v11, 1152, v11
    v_bfe_u32 v12, v2, 1, 2
    v_bfe_u32 v14, v2, 4, 1
    v_or_b32 v14, s46, v14
    v_xor_b32 v14, v14, v12
    v_lshlrev_b32 v14, 5, v14
    v_add3_u32 v28, v11, v14, v13
    s_cmp_lt_u32 s45, 4
    s_cselect_b32 s46, 0, 0x7ff00000
    v_add_u32 v28, s46, v28
    s_mul_i32 s92, s45, 4608
    s_lshl_b32 s93, s92, 1
    s_add_u32 s94, s52, 16384
    v_mov_b32 v128, 0
    v_mov_b32 v129, 0
    v_mov_b32 v130, 0
    v_mov_b32 v131, 0
    v_mov_b32 v132, 0
    v_mov_b32 v133, 0
    v_mov_b32 v134, 0
    v_mov_b32 v135, 0
    v_mov_b32 v136, 0
    v_mov_b32 v137, 0
    v_mov_b32 v138, 0
    v_mov_b32 v139, 0
    v_mov_b32 v140, 0
    v_mov_b32 v141, 0
    v_mov_b32 v142, 0
    v_mov_b32 v143, 0
    v_mov_b32 v144, 0
    v_mov_b32 v145, 0
    v_mov_b32 v146, 0
    v_mov_b32 v147, 0
    v_mov_b32 v148, 0
    v_mov_b32 v149, 0
    v_mov_b32 v150, 0
    v_mov_b32 v151, 0
    v_mov_b32 v152, 0
    v_mov_b32 v153, 0
    v_mov_b32 v154, 0
    v_mov_b32 v155, 0
    v_mov_b32 v156, 0
    v_mov_b32 v157, 0
    v_mov_b32 v158, 0
    v_mov_b32 v159, 0
    v_mov_b32 v160, 0
    v_mov_b32 v161, 0
    v_mov_b32 v162, 0
    v_mov_b32 v163, 0
    v_mov_b32 v164, 0
    v_mov_b32 v165, 0
    v_mov_b32 v166, 0
    v_mov_b32 v167, 0
    v_mov_b32 v168, 0
    v_mov_b32 v169, 0
    v_mov_b32 v170, 0
    v_mov_b32 v171, 0
    v_mov_b32 v172, 0
    v_mov_b32 v173, 0
    v_mov_b32 v174, 0
    v_mov_b32 v175, 0
    v_mov_b32 v176, 0
    v_mov_b32 v177, 0
    v_mov_b32 v178, 0
    v_mov_b32 v179, 0
    v_mov_b32 v180, 0
    v_mov_b32 v181, 0
    v_mov_b32 v182, 0
    v_mov_b32 v183, 0
    s_waitcnt vmcnt(4)
    s_barrier
    s_add_u32 m0, s54, 83968
    s_add_u32 s47, s53, s96
    buffer_load_dwordx4 v104, s[24:27], s47 offen lds
    s_add_u32 m0, s54, 84992
    s_add_u32 s47, s53, s96
    buffer_load_dwordx4 v105, s[24:27], s47 offen lds
    s_add_u32 s96, s96, 262144
    s_cmp_ge_u32 s96, 4718592
    s_cselect_b32 s96, 0, s96
    s_add_u32 m0, s54, 100352
    s_add_u32 s47, s53, s96
    buffer_load_dwordx4 v104, s[24:27], s47 offen lds
    s_add_u32 m0, s54, 101376
    s_add_u32 s47, s53, s96
    buffer_load_dwordx4 v105, s[24:27], s47 offen lds
    s_add_u32 s96, s96, 262144
    s_cmp_ge_u32 s96, 4718592
    s_cselect_b32 s96, 0, s96
    ds_read_b64_tr_b16 v[32:33], v10 offset:32768
    ds_read_b64_tr_b16 v[34:35], v10 offset:34816
    ds_read_b64_tr_b16 v[36:37], v29 offset:32768
    ds_read_b64_tr_b16 v[38:39], v29 offset:34816
    ds_read_b128 v[48:51], v8 offset:0
    ds_read_b128 v[52:55], v8 offset:2048
    ds_read_b128 v[56:59], v8 offset:4096
    ds_read_b128 v[60:63], v8 offset:6144
    ds_read_b128 v[64:67], v8 offset:8192
    ds_read_b128 v[68:71], v8 offset:10240
    ds_read_b128 v[72:75], v8 offset:12288
    s_waitcnt vmcnt(6) lgkmcnt(0)
    s_barrier
    v_mfma_f32_16x16x32_bf16 v[128:131], v[32:35], v[48:51], v[128:131]
    s_add_u32 m0, s54, 116736
    s_add_u32 s47, s53, s96
    buffer_load_dwordx4 v104, s[24:27], s47 offen lds
    s_add_u32 m0, s54, 117760
    s_add_u32 s47, s53, s96
    buffer_load_dwordx4 v105, s[24:27], s47 offen lds
    s_add_u32 s96, s96, 262144
    s_cmp_ge_u32 s96, 4718592
    s_cselect_b32 s96, 0, s96
    v_mfma_f32_16x16x32_bf16 v[132:135], v[32:35], v[52:55], v[132:135]
    ds_read_b64_tr_b16 v[40:41], v10 offset:49152
    ds_read_b64_tr_b16 v[42:43], v10 offset:51200
    v_mfma_f32_16x16x32_bf16 v[136:139], v[32:35], v[56:59], v[136:139]
    ds_read_b64_tr_b16 v[44:45], v29 offset:49152
    ds_read_b64_tr_b16 v[46:47], v29 offset:51200
    v_mfma_f32_16x16x32_bf16 v[140:143], v[32:35], v[60:63], v[140:143]
    ds_read_b128 v[76:79], v31 offset:0
    ds_read_b128 v[80:83], v31 offset:2048
    v_mfma_f32_16x16x32_bf16 v[144:147], v[32:35], v[64:67], v[144:147]
    ds_read_b128 v[84:87], v31 offset:4096
    v_mfma_f32_16x16x32_bf16 v[148:151], v[32:35], v[68:71], v[148:151]
    ds_read_b128 v[88:91], v31 offset:6144
    v_mfma_f32_16x16x32_bf16 v[152:155], v[32:35], v[72:75], v[152:155]
    ds_read_b128 v[92:95], v31 offset:8192
    v_mfma_f32_16x16x32_bf16 v[156:159], v[36:39], v[48:51], v[156:159]
    ds_read_b128 v[96:99], v31 offset:10240
    v_mfma_f32_16x16x32_bf16 v[160:163], v[36:39], v[52:55], v[160:163]
    ds_read_b128 v[100:103], v31 offset:12288
    v_mfma_f32_16x16x32_bf16 v[164:167], v[36:39], v[56:59], v[164:167]
    v_mfma_f32_16x16x32_bf16 v[168:171], v[36:39], v[60:63], v[168:171]
    v_mfma_f32_16x16x32_bf16 v[172:175], v[36:39], v[64:67], v[172:175]
    v_mfma_f32_16x16x32_bf16 v[176:179], v[36:39], v[68:71], v[176:179]
    v_mfma_f32_16x16x32_bf16 v[180:183], v[36:39], v[72:75], v[180:183]
    s_waitcnt vmcnt(6) lgkmcnt(0)
    s_barrier
    v_mfma_f32_16x16x32_bf16 v[128:131], v[40:43], v[76:79], v[128:131]
    s_add_u32 m0, s54, 133120
    s_add_u32 s47, s53, s96
    buffer_load_dwordx4 v104, s[24:27], s47 offen lds
    s_add_u32 m0, s54, 134144
    s_add_u32 s47, s53, s96
    buffer_load_dwordx4 v105, s[24:27], s47 offen lds
    s_add_u32 s96, s96, 262144
    s_cmp_ge_u32 s96, 4718592
    s_cselect_b32 s96, 0, s96
    v_mfma_f32_16x16x32_bf16 v[132:135], v[40:43], v[80:83], v[132:135]
    ds_read_b64_tr_b16 v[32:33], v6 offset:0
    ds_read_b64_tr_b16 v[34:35], v6 offset:2048
    v_mfma_f32_16x16x32_bf16 v[136:139], v[40:43], v[84:87], v[136:139]
    ds_read_b64_tr_b16 v[36:37], v7 offset:0
    ds_read_b64_tr_b16 v[38:39], v7 offset:2048
    v_mfma_f32_16x16x32_bf16 v[140:143], v[40:43], v[88:91], v[140:143]
    ds_read_b128 v[48:51], v8 offset:14336
    ds_read_b128 v[52:55], v8 offset:16384
    v_mfma_f32_16x16x32_bf16 v[144:147], v[40:43], v[92:95], v[144:147]
    ds_read_b128 v[56:59], v8 offset:18432
    v_mfma_f32_16x16x32_bf16 v[148:151], v[40:43], v[96:99], v[148:151]
    ds_read_b128 v[60:63], v8 offset:20480
    v_mfma_f32_16x16x32_bf16 v[152:155], v[40:43], v[100:103], v[152:155]
    ds_read_b128 v[64:67], v8 offset:22528
    v_mfma_f32_16x16x32_bf16 v[156:159], v[44:47], v[76:79], v[156:159]
    ds_read_b128 v[68:71], v8 offset:24576
    v_mfma_f32_16x16x32_bf16 v[160:163], v[44:47], v[80:83], v[160:163]
    ds_read_b128 v[72:75], v8 offset:26624
    v_mfma_f32_16x16x32_bf16 v[164:167], v[44:47], v[84:87], v[164:167]
    v_mfma_f32_16x16x32_bf16 v[168:171], v[44:47], v[88:91], v[168:171]
    v_mfma_f32_16x16x32_bf16 v[172:175], v[44:47], v[92:95], v[172:175]
    v_mfma_f32_16x16x32_bf16 v[176:179], v[44:47], v[96:99], v[176:179]
    v_mfma_f32_16x16x32_bf16 v[180:183], v[44:47], v[100:103], v[180:183]
    s_waitcnt vmcnt(6) lgkmcnt(0)
    s_barrier
    v_mfma_f32_16x16x32_bf16 v[128:131], v[32:35], v[48:51], v[128:131]
    s_add_u32 m0, s54, 43008
    s_add_u32 s47, s53, s96
    buffer_load_dwordx4 v104, s[24:27], s47 offen lds
    s_add_u32 m0, s54, 44032
    s_add_u32 s47, s53, s96
    buffer_load_dwordx4 v105, s[24:27], s47 offen lds
    s_add_u32 s96, s96, 262144
    s_cmp_ge_u32 s96, 4718592
    s_cselect_b32 s96, 0, s96
    v_mfma_f32_16x16x32_bf16 v[132:135], v[32:35], v[52:55], v[132:135]
    ds_read_b64_tr_b16 v[40:41], v10 offset:0
    ds_read_b64_tr_b16 v[42:43], v10 offset:2048
    v_mfma_f32_16x16x32_bf16 v[136:139], v[32:35], v[56:59], v[136:139]
    ds_read_b64_tr_b16 v[44:45], v29 offset:0
    ds_read_b64_tr_b16 v[46:47], v29 offset:2048
    v_mfma_f32_16x16x32_bf16 v[140:143], v[32:35], v[60:63], v[140:143]
    ds_read_b128 v[76:79], v31 offset:14336
    ds_read_b128 v[80:83], v31 offset:16384
    v_mfma_f32_16x16x32_bf16 v[144:147], v[32:35], v[64:67], v[144:147]
    ds_read_b128 v[84:87], v31 offset:18432
    v_mfma_f32_16x16x32_bf16 v[148:151], v[32:35], v[68:71], v[148:151]
    ds_read_b128 v[88:91], v31 offset:20480
    v_mfma_f32_16x16x32_bf16 v[152:155], v[32:35], v[72:75], v[152:155]
    ds_read_b128 v[92:95], v31 offset:22528
    v_mfma_f32_16x16x32_bf16 v[156:159], v[36:39], v[48:51], v[156:159]
    ds_read_b128 v[96:99], v31 offset:24576
    v_mfma_f32_16x16x32_bf16 v[160:163], v[36:39], v[52:55], v[160:163]
    ds_read_b128 v[100:103], v31 offset:26624
    v_mfma_f32_16x16x32_bf16 v[164:167], v[36:39], v[56:59], v[164:167]
    v_mfma_f32_16x16x32_bf16 v[168:171], v[36:39], v[60:63], v[168:171]
    v_mfma_f32_16x16x32_bf16 v[172:175], v[36:39], v[64:67], v[172:175]
    v_mfma_f32_16x16x32_bf16 v[176:179], v[36:39], v[68:71], v[176:179]
    v_mfma_f32_16x16x32_bf16 v[180:183], v[36:39], v[72:75], v[180:183]
    s_waitcnt vmcnt(6) lgkmcnt(0)
    s_barrier
    v_mfma_f32_16x16x32_bf16 v[128:131], v[40:43], v[76:79], v[128:131]
    s_add_u32 m0, s54, 83968
    s_add_u32 s47, s53, s96
    buffer_load_dwordx4 v104, s[24:27], s47 offen lds
    s_add_u32 m0, s54, 84992
    s_add_u32 s47, s53, s96
    buffer_load_dwordx4 v105, s[24:27], s47 offen lds
    s_add_u32 s96, s96, 262144
    s_cmp_ge_u32 s96, 4718592
    s_cselect_b32 s96, 0, s96
    v_mfma_f32_16x16x32_bf16 v[132:135], v[40:43], v[80:83], v[132:135]
    ds_read_b64_tr_b16 v[32:33], v10 offset:16384
    ds_read_b64_tr_b16 v[34:35], v10 offset:18432
    v_mfma_f32_16x16x32_bf16 v[136:139], v[40:43], v[84:87], v[136:139]
    ds_read_b64_tr_b16 v[36:37], v29 offset:16384
    ds_read_b64_tr_b16 v[38:39], v29 offset:18432
    v_mfma_f32_16x16x32_bf16 v[140:143], v[40:43], v[88:91], v[140:143]
    ds_read_b128 v[48:51], v8 offset:28672
    ds_read_b128 v[52:55], v8 offset:30720
    v_mfma_f32_16x16x32_bf16 v[144:147], v[40:43], v[92:95], v[144:147]
    ds_read_b128 v[56:59], v8 offset:32768
    v_mfma_f32_16x16x32_bf16 v[148:151], v[40:43], v[96:99], v[148:151]
    ds_read_b128 v[60:63], v8 offset:34816
    v_mfma_f32_16x16x32_bf16 v[152:155], v[40:43], v[100:103], v[152:155]
    ds_read_b128 v[64:67], v8 offset:36864
    v_mfma_f32_16x16x32_bf16 v[156:159], v[44:47], v[76:79], v[156:159]
    ds_read_b128 v[68:71], v8 offset:38912
    v_mfma_f32_16x16x32_bf16 v[160:163], v[44:47], v[80:83], v[160:163]
    ds_read_b128 v[72:75], v8 offset:40960
    v_mfma_f32_16x16x32_bf16 v[164:167], v[44:47], v[84:87], v[164:167]
    v_mfma_f32_16x16x32_bf16 v[168:171], v[44:47], v[88:91], v[168:171]
    v_mfma_f32_16x16x32_bf16 v[172:175], v[44:47], v[92:95], v[172:175]
    v_mfma_f32_16x16x32_bf16 v[176:179], v[44:47], v[96:99], v[176:179]
    v_mfma_f32_16x16x32_bf16 v[180:183], v[44:47], v[100:103], v[180:183]
    s_waitcnt vmcnt(6) lgkmcnt(0)
    s_barrier
    v_mfma_f32_16x16x32_bf16 v[128:131], v[32:35], v[48:51], v[128:131]
    s_add_u32 m0, s54, 100352
    s_add_u32 s47, s53, s96
    buffer_load_dwordx4 v104, s[24:27], s47 offen lds
    s_add_u32 m0, s54, 101376
    s_add_u32 s47, s53, s96
    buffer_load_dwordx4 v105, s[24:27], s47 offen lds
    s_add_u32 s96, s96, 262144
    s_cmp_ge_u32 s96, 4718592
    s_cselect_b32 s96, 0, s96
    v_mfma_f32_16x16x32_bf16 v[132:135], v[32:35], v[52:55], v[132:135]
    ds_read_b64_tr_b16 v[40:41], v10 offset:32768
    ds_read_b64_tr_b16 v[42:43], v10 offset:34816
    v_mfma_f32_16x16x32_bf16 v[136:139], v[32:35], v[56:59], v[136:139]
    ds_read_b64_tr_b16 v[44:45], v29 offset:32768
    ds_read_b64_tr_b16 v[46:47], v29 offset:34816
    v_mfma_f32_16x16x32_bf16 v[140:143], v[32:35], v[60:63], v[140:143]
    ds_read_b128 v[76:79], v31 offset:28672
    ds_read_b128 v[80:83], v31 offset:30720
    v_mfma_f32_16x16x32_bf16 v[144:147], v[32:35], v[64:67], v[144:147]
    ds_read_b128 v[84:87], v31 offset:32768
    v_mfma_f32_16x16x32_bf16 v[148:151], v[32:35], v[68:71], v[148:151]
    ds_read_b128 v[88:91], v31 offset:34816
    v_mfma_f32_16x16x32_bf16 v[152:155], v[32:35], v[72:75], v[152:155]
    ds_read_b128 v[92:95], v31 offset:36864
    v_mfma_f32_16x16x32_bf16 v[156:159], v[36:39], v[48:51], v[156:159]
    ds_read_b128 v[96:99], v31 offset:38912
    v_mfma_f32_16x16x32_bf16 v[160:163], v[36:39], v[52:55], v[160:163]
    ds_read_b128 v[100:103], v31 offset:40960
    v_mfma_f32_16x16x32_bf16 v[164:167], v[36:39], v[56:59], v[164:167]
    v_mfma_f32_16x16x32_bf16 v[168:171], v[36:39], v[60:63], v[168:171]
    v_mfma_f32_16x16x32_bf16 v[172:175], v[36:39], v[64:67], v[172:175]
    v_mfma_f32_16x16x32_bf16 v[176:179], v[36:39], v[68:71], v[176:179]
    v_mfma_f32_16x16x32_bf16 v[180:183], v[36:39], v[72:75], v[180:183]
    s_waitcnt vmcnt(6) lgkmcnt(0)
    s_barrier
    v_mfma_f32_16x16x32_bf16 v[128:131], v[40:43], v[76:79], v[128:131]
    s_add_u32 m0, s54, 116736
    s_add_u32 s47, s53, s96
    buffer_load_dwordx4 v104, s[24:27], s47 offen lds
    s_add_u32 m0, s54, 117760
    s_add_u32 s47, s53, s96
    buffer_load_dwordx4 v105, s[24:27], s47 offen lds
    s_add_u32 s96, s96, 262144
    s_cmp_ge_u32 s96, 4718592
    s_cselect_b32 s96, 0, s96
    v_mfma_f32_16x16x32_bf16 v[132:135], v[40:43], v[80:83], v[132:135]
    ds_read_b64_tr_b16 v[32:33], v10 offset:49152
    ds_read_b64_tr_b16 v[34:35], v10 offset:51200
    v_mfma_f32_16x16x32_bf16 v[136:139], v[40:43], v[84:87], v[136:139]
    ds_read_b64_tr_b16 v[36:37], v29 offset:49152
    ds_read_b64_tr_b16 v[38:39], v29 offset:51200
    v_mfma_f32_16x16x32_bf16 v[140:143], v[40:43], v[88:91], v[140:143]
    ds_read_b128 v[48:51], v8 offset:0
    ds_read_b128 v[52:55], v8 offset:2048
    v_mfma_f32_16x16x32_bf16 v[144:147], v[40:43], v[92:95], v[144:147]
    ds_read_b128 v[56:59], v8 offset:4096
    v_mfma_f32_16x16x32_bf16 v[148:151], v[40:43], v[96:99], v[148:151]
    ds_read_b128 v[60:63], v8 offset:6144
    v_mfma_f32_16x16x32_bf16 v[152:155], v[40:43], v[100:103], v[152:155]
    ds_read_b128 v[64:67], v8 offset:8192
    v_mfma_f32_16x16x32_bf16 v[156:159], v[44:47], v[76:79], v[156:159]
    ds_read_b128 v[68:71], v8 offset:10240
    v_mfma_f32_16x16x32_bf16 v[160:163], v[44:47], v[80:83], v[160:163]
    ds_read_b128 v[72:75], v8 offset:12288
    v_mfma_f32_16x16x32_bf16 v[164:167], v[44:47], v[84:87], v[164:167]
    v_mfma_f32_16x16x32_bf16 v[168:171], v[44:47], v[88:91], v[168:171]
    v_mfma_f32_16x16x32_bf16 v[172:175], v[44:47], v[92:95], v[172:175]
    v_mfma_f32_16x16x32_bf16 v[176:179], v[44:47], v[96:99], v[176:179]
    v_mfma_f32_16x16x32_bf16 v[180:183], v[44:47], v[100:103], v[180:183]
    s_waitcnt vmcnt(6) lgkmcnt(0)
    s_barrier
    v_mfma_f32_16x16x32_bf16 v[128:131], v[32:35], v[48:51], v[128:131]
    s_add_u32 m0, s54, 133120
    s_add_u32 s47, s53, s96
    buffer_load_dwordx4 v104, s[24:27], s47 offen lds
    s_add_u32 m0, s54, 134144
    s_add_u32 s47, s53, s96
    buffer_load_dwordx4 v105, s[24:27], s47 offen lds
    s_add_u32 s96, s96, 262144
    s_cmp_ge_u32 s96, 4718592
    s_cselect_b32 s96, 0, s96
    v_mfma_f32_16x16x32_bf16 v[132:135], v[32:35], v[52:55], v[132:135]
    ds_read_b64_tr_b16 v[40:41], v6 offset:0
    ds_read_b64_tr_b16 v[42:43], v6 offset:2048
    v_mfma_f32_16x16x32_bf16 v[136:139], v[32:35], v[56:59], v[136:139]
    ds_read_b64_tr_b16 v[44:45], v7 offset:0
    ds_read_b64_tr_b16 v[46:47], v7 offset:2048
    v_mfma_f32_16x16x32_bf16 v[140:143], v[32:35], v[60:63], v[140:143]
    ds_read_b128 v[76:79], v31 offset:0
    ds_read_b128 v[80:83], v31 offset:2048
    v_mfma_f32_16x16x32_bf16 v[144:147], v[32:35], v[64:67], v[144:147]
    ds_read_b128 v[84:87], v31 offset:4096
    v_mfma_f32_16x16x32_bf16 v[148:151], v[32:35], v[68:71], v[148:151]
    ds_read_b128 v[88:91], v31 offset:6144
    v_mfma_f32_16x16x32_bf16 v[152:155], v[32:35], v[72:75], v[152:155]
    ds_read_b128 v[92:95], v31 offset:8192
    v_mfma_f32_16x16x32_bf16 v[156:159], v[36:39], v[48:51], v[156:159]
    ds_read_b128 v[96:99], v31 offset:10240
    v_mfma_f32_16x16x32_bf16 v[160:163], v[36:39], v[52:55], v[160:163]
    ds_read_b128 v[100:103], v31 offset:12288
    v_mfma_f32_16x16x32_bf16 v[164:167], v[36:39], v[56:59], v[164:167]
    v_mfma_f32_16x16x32_bf16 v[168:171], v[36:39], v[60:63], v[168:171]
    v_mfma_f32_16x16x32_bf16 v[172:175], v[36:39], v[64:67], v[172:175]
    v_mfma_f32_16x16x32_bf16 v[176:179], v[36:39], v[68:71], v[176:179]
    v_mfma_f32_16x16x32_bf16 v[180:183], v[36:39], v[72:75], v[180:183]
    s_waitcnt vmcnt(6) lgkmcnt(0)
    s_barrier
    v_mfma_f32_16x16x32_bf16 v[128:131], v[40:43], v[76:79], v[128:131]
    s_add_u32 m0, s54, 43008
    s_add_u32 s47, s53, s96
    buffer_load_dwordx4 v104, s[24:27], s47 offen lds
    s_add_u32 m0, s54, 44032
    s_add_u32 s47, s53, s96
    buffer_load_dwordx4 v105, s[24:27], s47 offen lds
    s_add_u32 s96, s96, 262144
    s_cmp_ge_u32 s96, 4718592
    s_cselect_b32 s96, 0, s96
    v_mfma_f32_16x16x32_bf16 v[132:135], v[40:43], v[80:83], v[132:135]
    ds_read_b64_tr_b16 v[32:33], v10 offset:0
    ds_read_b64_tr_b16 v[34:35], v10 offset:2048
    v_mfma_f32_16x16x32_bf16 v[136:139], v[40:43], v[84:87], v[136:139]
    ds_read_b64_tr_b16 v[36:37], v29 offset:0
    ds_read_b64_tr_b16 v[38:39], v29 offset:2048
    v_mfma_f32_16x16x32_bf16 v[140:143], v[40:43], v[88:91], v[140:143]
    ds_read_b128 v[48:51], v8 offset:14336
    ds_read_b128 v[52:55], v8 offset:16384
    v_mfma_f32_16x16x32_bf16 v[144:147], v[40:43], v[92:95], v[144:147]
    ds_read_b128 v[56:59], v8 offset:18432
    v_mfma_f32_16x16x32_bf16 v[148:151], v[40:43], v[96:99], v[148:151]
    ds_read_b128 v[60:63], v8 offset:20480
    v_mfma_f32_16x16x32_bf16 v[152:155], v[40:43], v[100:103], v[152:155]
    ds_read_b128 v[64:67], v8 offset:22528
    v_mfma_f32_16x16x32_bf16 v[156:159], v[44:47], v[76:79], v[156:159]
    ds_read_b128 v[68:71], v8 offset:24576
    v_mfma_f32_16x16x32_bf16 v[160:163], v[44:47], v[80:83], v[160:163]
    ds_read_b128 v[72:75], v8 offset:26624
    v_mfma_f32_16x16x32_bf16 v[164:167], v[44:47], v[84:87], v[164:167]
    v_mfma_f32_16x16x32_bf16 v[168:171], v[44:47], v[88:91], v[168:171]
    v_mfma_f32_16x16x32_bf16 v[172:175], v[44:47], v[92:95], v[172:175]
    v_mfma_f32_16x16x32_bf16 v[176:179], v[44:47], v[96:99], v[176:179]
    v_mfma_f32_16x16x32_bf16 v[180:183], v[44:47], v[100:103], v[180:183]
    s_waitcnt vmcnt(6) lgkmcnt(0)
    s_barrier
    v_mfma_f32_16x16x32_bf16 v[128:131], v[32:35], v[48:51], v[128:131]
    s_add_u32 m0, s54, 83968
    s_add_u32 s47, s53, s96
    buffer_load_dwordx4 v104, s[24:27], s47 offen lds
    s_add_u32 m0, s54, 84992
    s_add_u32 s47, s53, s96
    buffer_load_dwordx4 v105, s[24:27], s47 offen lds
    s_add_u32 s96, s96, 262144
    s_cmp_ge_u32 s96, 4718592
    s_cselect_b32 s96, 0, s96
    v_mfma_f32_16x16x32_bf16 v[132:135], v[32:35], v[52:55], v[132:135]
    ds_read_b64_tr_b16 v[40:41], v10 offset:16384
    ds_read_b64_tr_b16 v[42:43], v10 offset:18432
    v_mfma_f32_16x16x32_bf16 v[136:139], v[32:35], v[56:59], v[136:139]
    ds_read_b64_tr_b16 v[44:45], v29 offset:16384
    ds_read_b64_tr_b16 v[46:47], v29 offset:18432
    v_mfma_f32_16x16x32_bf16 v[140:143], v[32:35], v[60:63], v[140:143]
    ds_read_b128 v[76:79], v31 offset:14336
    ds_read_b128 v[80:83], v31 offset:16384
    v_mfma_f32_16x16x32_bf16 v[144:147], v[32:35], v[64:67], v[144:147]
    ds_read_b128 v[84:87], v31 offset:18432
    v_mfma_f32_16x16x32_bf16 v[148:151], v[32:35], v[68:71], v[148:151]
    ds_read_b128 v[88:91], v31 offset:20480
    v_mfma_f32_16x16x32_bf16 v[152:155], v[32:35], v[72:75], v[152:155]
    ds_read_b128 v[92:95], v31 offset:22528
    v_mfma_f32_16x16x32_bf16 v[156:159], v[36:39], v[48:51], v[156:159]
    ds_read_b128 v[96:99], v31 offset:24576
    v_mfma_f32_16x16x32_bf16 v[160:163], v[36:39], v[52:55], v[160:163]
    ds_read_b128 v[100:103], v31 offset:26624
    v_mfma_f32_16x16x32_bf16 v[164:167], v[36:39], v[56:59], v[164:167]
    v_mfma_f32_16x16x32_bf16 v[168:171], v[36:39], v[60:63], v[168:171]
    v_mfma_f32_16x16x32_bf16 v[172:175], v[36:39], v[64:67], v[172:175]
    v_mfma_f32_16x16x32_bf16 v[176:179], v[36:39], v[68:71], v[176:179]
    v_mfma_f32_16x16x32_bf16 v[180:183], v[36:39], v[72:75], v[180:183]
    s_waitcnt vmcnt(6) lgkmcnt(0)
    s_barrier
    v_mfma_f32_16x16x32_bf16 v[128:131], v[40:43], v[76:79], v[128:131]
    s_add_u32 m0, s54, 100352
    s_add_u32 s47, s53, s96
    buffer_load_dwordx4 v104, s[24:27], s47 offen lds
    s_add_u32 m0, s54, 101376
    s_add_u32 s47, s53, s96
    buffer_load_dwordx4 v105, s[24:27], s47 offen lds
    s_add_u32 s96, s96, 262144
    s_cmp_ge_u32 s96, 4718592
    s_cselect_b32 s96, 0, s96
    s_add_u32 s61, s62, 0
    s_and_b32 s61, s61, 0x1ffff
    s_mov_b32 m0, 59392
    s_add_u32 s47, s61, 0
    buffer_load_dwordx4 v3, s[28:31], s47 offen lds
    s_mov_b32 m0, 60416
    s_add_u32 s47, s61, 0
    buffer_load_dwordx4 v4, s[28:31], s47 offen lds
    s_mov_b32 m0, 61440
    s_add_u32 s47, s61, 0
    buffer_load_dwordx4 v5, s[28:31], s47 offen lds
    s_mov_b32 m0, 62464
    s_add_u32 s47, s61, 0
    buffer_load_dwordx4 v9, s[28:31], s47 offen lds
    s_mov_b32 m0, 63488
    s_add_u32 s47, s61, 4096
    buffer_load_dwordx4 v3, s[28:31], s47 offen lds
    s_mov_b32 m0, 64512
    s_add_u32 s47, s61, 4096
    buffer_load_dwordx4 v4, s[28:31], s47 offen lds
    s_mov_b32 m0, 65536
    s_add_u32 s47, s61, 4096
    buffer_load_dwordx4 v5, s[28:31], s47 offen lds
    s_mov_b32 m0, 66560
    s_add_u32 s47, s61, 4096
    buffer_load_dwordx4 v9, s[28:31], s47 offen lds
    v_mfma_f32_16x16x32_bf16 v[132:135], v[40:43], v[80:83], v[132:135]
    ds_read_b64_tr_b16 v[32:33], v10 offset:32768
    ds_read_b64_tr_b16 v[34:35], v10 offset:34816
    v_mfma_f32_16x16x32_bf16 v[136:139], v[40:43], v[84:87], v[136:139]
    ds_read_b64_tr_b16 v[36:37], v29 offset:32768
    ds_read_b64_tr_b16 v[38:39], v29 offset:34816
    v_mfma_f32_16x16x32_bf16 v[140:143], v[40:43], v[88:91], v[140:143]
    ds_read_b128 v[48:51], v8 offset:28672
    ds_read_b128 v[52:55], v8 offset:30720
    v_mfma_f32_16x16x32_bf16 v[144:147], v[40:43], v[92:95], v[144:147]
    ds_read_b128 v[56:59], v8 offset:32768
    v_mfma_f32_16x16x32_bf16 v[148:151], v[40:43], v[96:99], v[148:151]
    ds_read_b128 v[60:63], v8 offset:34816
    v_mfma_f32_16x16x32_bf16 v[152:155], v[40:43], v[100:103], v[152:155]
    ds_read_b128 v[64:67], v8 offset:36864
    v_mfma_f32_16x16x32_bf16 v[156:159], v[44:47], v[76:79], v[156:159]
    ds_read_b128 v[68:71], v8 offset:38912
    v_mfma_f32_16x16x32_bf16 v[160:163], v[44:47], v[80:83], v[160:163]
    ds_read_b128 v[72:75], v8 offset:40960
    v_mfma_f32_16x16x32_bf16 v[164:167], v[44:47], v[84:87], v[164:167]
    v_mfma_f32_16x16x32_bf16 v[168:171], v[44:47], v[88:91], v[168:171]
    v_mfma_f32_16x16x32_bf16 v[172:175], v[44:47], v[92:95], v[172:175]
    v_mfma_f32_16x16x32_bf16 v[176:179], v[44:47], v[96:99], v[176:179]
    v_mfma_f32_16x16x32_bf16 v[180:183], v[44:47], v[100:103], v[180:183]
    s_waitcnt vmcnt(14) lgkmcnt(0)
    s_barrier
    v_mfma_f32_16x16x32_bf16 v[128:131], v[32:35], v[48:51], v[128:131]
    s_add_u32 m0, s54, 116736
    s_add_u32 s47, s53, s96
    buffer_load_dwordx4 v104, s[24:27], s47 offen lds
    s_add_u32 m0, s54, 117760
    s_add_u32 s47, s53, s96
    buffer_load_dwordx4 v105, s[24:27], s47 offen lds
    s_add_u32 s96, s96, 262144
    s_cmp_ge_u32 s96, 4718592
    s_cselect_b32 s96, 0, s96
    s_add_u32 s61, s62, 8192
    s_and_b32 s61, s61, 0x1ffff
    s_mov_b32 m0, 67584
    s_add_u32 s47, s61, 0
    buffer_load_dwordx4 v3, s[28:31], s47 offen lds
    s_mov_b32 m0, 68608
    s_add_u32 s47, s61, 0
    buffer_load_dwordx4 v4, s[28:31], s47 offen lds
    s_mov_b32 m0, 69632
    s_add_u32 s47, s61, 0
    buffer_load_dwordx4 v5, s[28:31], s47 offen lds
    s_mov_b32 m0, 70656
    s_add_u32 s47, s61, 0
    buffer_load_dwordx4 v9, s[28:31], s47 offen lds
    s_mov_b32 m0, 71680
    s_add_u32 s47, s61, 4096
    buffer_load_dwordx4 v3, s[28:31], s47 offen lds
    s_mov_b32 m0, 72704
    s_add_u32 s47, s61, 4096
    buffer_load_dwordx4 v4, s[28:31], s47 offen lds
    s_mov_b32 m0, 73728
    s_add_u32 s47, s61, 4096
    buffer_load_dwordx4 v5, s[28:31], s47 offen lds
    s_mov_b32 m0, 74752
    s_add_u32 s47, s61, 4096
    buffer_load_dwordx4 v9, s[28:31], s47 offen lds
    v_mfma_f32_16x16x32_bf16 v[132:135], v[32:35], v[52:55], v[132:135]
    ds_read_b64_tr_b16 v[40:41], v10 offset:49152
    ds_read_b64_tr_b16 v[42:43], v10 offset:51200
    v_mfma_f32_16x16x32_bf16 v[136:139], v[32:35], v[56:59], v[136:139]
    ds_read_b64_tr_b16 v[44:45], v29 offset:49152
    ds_read_b64_tr_b16 v[46:47], v29 offset:51200
    v_mfma_f32_16x16x32_bf16 v[140:143], v[32:35], v[60:63], v[140:143]
    ds_read_b128 v[76:79], v31 offset:28672
    ds_read_b128 v[80:83], v31 offset:30720
    v_mfma_f32_16x16x32_bf16 v[144:147], v[32:35], v[64:67], v[144:147]
    ds_read_b128 v[84:87], v31 offset:32768
    v_mfma_f32_16x16x32_bf16 v[148:151], v[32:35], v[68:71], v[148:151]
    ds_read_b128 v[88:91], v31 offset:34816
    v_mfma_f32_16x16x32_bf16 v[152:155], v[32:35], v[72:75], v[152:155]
    ds_read_b128 v[92:95], v31 offset:36864
    v_mfma_f32_16x16x32_bf16 v[156:159], v[36:39], v[48:51], v[156:159]
    ds_read_b128 v[96:99], v31 offset:38912
    v_mfma_f32_16x16x32_bf16 v[160:163], v[36:39], v[52:55], v[160:163]
    ds_read_b128 v[100:103], v31 offset:40960
    v_mfma_f32_16x16x32_bf16 v[164:167], v[36:39], v[56:59], v[164:167]
    v_mfma_f32_16x16x32_bf16 v[168:171], v[36:39], v[60:63], v[168:171]
    v_mfma_f32_16x16x32_bf16 v[172:175], v[36:39], v[64:67], v[172:175]
    v_mfma_f32_16x16x32_bf16 v[176:179], v[36:39], v[68:71], v[176:179]
    v_mfma_f32_16x16x32_bf16 v[180:183], v[36:39], v[72:75], v[180:183]
    s_waitcnt vmcnt(22) lgkmcnt(0)
    s_barrier
    v_mfma_f32_16x16x32_bf16 v[128:131], v[40:43], v[76:79], v[128:131]
    s_add_u32 m0, s54, 133120
    s_add_u32 s47, s53, s96
    buffer_load_dwordx4 v104, s[24:27], s47 offen lds
    s_add_u32 m0, s54, 134144
    s_add_u32 s47, s53, s96
    buffer_load_dwordx4 v105, s[24:27], s47 offen lds
    s_add_u32 s96, s96, 262144
    s_cmp_ge_u32 s96, 4718592
    s_cselect_b32 s96, 0, s96
    s_add_u32 s61, s62, 0
    s_and_b32 s61, s61, 0x1ffff
    s_mov_b32 m0, 149504
    s_add_u32 s47, s61, 0
    buffer_load_dwordx4 v18, s[32:35], s47 offen lds
    s_mov_b32 m0, 150528
    s_add_u32 s47, s61, 1024
    buffer_load_dwordx4 v18, s[32:35], s47 offen lds
    s_mov_b32 m0, 151552
    s_add_u32 s47, s61, 2048
    buffer_load_dwordx4 v18, s[32:35], s47 offen lds
    s_mov_b32 m0, 152576
    s_add_u32 s47, s61, 3072
    buffer_load_dwordx4 v18, s[32:35], s47 offen lds
    s_mov_b32 m0, 153600
    s_add_u32 s47, s61, 4096
    buffer_load_dwordx4 v18, s[32:35], s47 offen lds
    s_mov_b32 m0, 154624
    s_add_u32 s47, s61, 5120
    buffer_load_dwordx4 v18, s[32:35], s47 offen lds
    s_mov_b32 m0, 155648
    s_add_u32 s47, s61, 6144
    buffer_load_dwordx4 v18, s[32:35], s47 offen lds
    s_mov_b32 m0, 156672
    s_add_u32 s47, s61, 7168
    buffer_load_dwordx4 v18, s[32:35], s47 offen lds
    v_mfma_f32_16x16x32_bf16 v[132:135], v[40:43], v[80:83], v[132:135]
    ds_read_b64_tr_b16 v[32:33], v6 offset:0
    ds_read_b64_tr_b16 v[34:35], v6 offset:2048
    v_mfma_f32_16x16x32_bf16 v[136:139], v[40:43], v[84:87], v[136:139]
    ds_read_b64_tr_b16 v[36:37], v7 offset:0
    ds_read_b64_tr_b16 v[38:39], v7 offset:2048
    v_mfma_f32_16x16x32_bf16 v[140:143], v[40:43], v[88:91], v[140:143]
    ds_read_b128 v[48:51], v8 offset:0
    ds_read_b128 v[52:55], v8 offset:2048
    v_mfma_f32_16x16x32_bf16 v[144:147], v[40:43], v[92:95], v[144:147]
    ds_read_b128 v[56:59], v8 offset:4096
    v_mfma_f32_16x16x32_bf16 v[148:151], v[40:43], v[96:99], v[148:151]
    ds_read_b128 v[60:63], v8 offset:6144
    v_mfma_f32_16x16x32_bf16 v[152:155], v[40:43], v[100:103], v[152:155]
    ds_read_b128 v[64:67], v8 offset:8192
    v_mfma_f32_16x16x32_bf16 v[156:159], v[44:47], v[76:79], v[156:159]
    ds_read_b128 v[68:71], v8 offset:10240
    v_mfma_f32_16x16x32_bf16 v[160:163], v[44:47], v[80:83], v[160:163]
    ds_read_b128 v[72:75], v8 offset:12288
    v_mfma_f32_16x16x32_bf16 v[164:167], v[44:47], v[84:87], v[164:167]
    v_mfma_f32_16x16x32_bf16 v[168:171], v[44:47], v[88:91], v[168:171]
    v_mfma_f32_16x16x32_bf16 v[172:175], v[44:47], v[92:95], v[172:175]
    v_mfma_f32_16x16x32_bf16 v[176:179], v[44:47], v[96:99], v[176:179]
    v_mfma_f32_16x16x32_bf16 v[180:183], v[44:47], v[100:103], v[180:183]
    s_waitcnt vmcnt(30) lgkmcnt(0)
    s_barrier
    v_mfma_f32_16x16x32_bf16 v[128:131], v[32:35], v[48:51], v[128:131]
    s_add_u32 m0, s54, 43008
    s_add_u32 s47, s53, s96
    buffer_load_dwordx4 v104, s[24:27], s47 offen lds
    s_add_u32 m0, s54, 44032
    s_add_u32 s47, s53, s96
    buffer_load_dwordx4 v105, s[24:27], s47 offen lds
    s_add_u32 s96, s96, 262144
    s_cmp_ge_u32 s96, 4718592
    s_cselect_b32 s96, 0, s96
    s_add_u32 s61, s62, 16384
    s_and_b32 s61, s61, 0x1ffff
    s_mov_b32 m0, 75776
    s_add_u32 s47, s61, 0
    buffer_load_dwordx4 v3, s[28:31], s47 offen lds
    s_mov_b32 m0, 76800
    s_add_u32 s47, s61, 0
    buffer_load_dwordx4 v4, s[28:31], s47 offen lds
    s_mov_b32 m0, 77824
    s_add_u32 s47, s61, 0
    buffer_load_dwordx4 v5, s[28:31], s47 offen lds
    s_mov_b32 m0, 78848
    s_add_u32 s47, s61, 0
    buffer_load_dwordx4 v9, s[28:31], s47 offen lds
    s_mov_b32 m0, 79872
    s_add_u32 s47, s61, 4096
    buffer_load_dwordx4 v3, s[28:31], s47 offen lds
    s_mov_b32 m0, 80896
    s_add_u32 s47, s61, 4096
    buffer_load_dwordx4 v4, s[28:31], s47 offen lds
    s_mov_b32 m0, 81920
    s_add_u32 s47, s61, 4096
    buffer_load_dwordx4 v5, s[28:31], s47 offen lds
    s_mov_b32 m0, 82944
    s_add_u32 s47, s61, 4096
    buffer_load_dwordx4 v9, s[28:31], s47 offen lds
    v_mfma_f32_16x16x32_bf16 v[132:135], v[32:35], v[52:55], v[132:135]
    ds_read_b64_tr_b16 v[40:41], v10 offset:0
    ds_read_b64_tr_b16 v[42:43], v10 offset:2048
    v_mfma_f32_16x16x32_bf16 v[136:139], v[32:35], v[56:59], v[136:139]
    ds_read_b64_tr_b16 v[44:45], v29 offset:0
    ds_read_b64_tr_b16 v[46:47], v29 offset:2048
    v_mfma_f32_16x16x32_bf16 v[140:143], v[32:35], v[60:63], v[140:143]
    ds_read_b128 v[76:79], v31 offset:0
    ds_read_b128 v[80:83], v31 offset:2048
    v_mfma_f32_16x16x32_bf16 v[144:147], v[32:35], v[64:67], v[144:147]
    ds_read_b128 v[84:87], v31 offset:4096
    v_mfma_f32_16x16x32_bf16 v[148:151], v[32:35], v[68:71], v[148:151]
    ds_read_b128 v[88:91], v31 offset:6144
    v_mfma_f32_16x16x32_bf16 v[152:155], v[32:35], v[72:75], v[152:155]
    ds_read_b128 v[92:95], v31 offset:8192
    v_mfma_f32_16x16x32_bf16 v[156:159], v[36:39], v[48:51], v[156:159]
    ds_read_b128 v[96:99], v31 offset:10240
    v_mfma_f32_16x16x32_bf16 v[160:163], v[36:39], v[52:55], v[160:163]
    ds_read_b128 v[100:103], v31 offset:12288
    v_mfma_f32_16x16x32_bf16 v[164:167], v[36:39], v[56:59], v[164:167]
    v_mfma_f32_16x16x32_bf16 v[168:171], v[36:39], v[60:63], v[168:171]
    v_mfma_f32_16x16x32_bf16 v[172:175], v[36:39], v[64:67], v[172:175]
    v_mfma_f32_16x16x32_bf16 v[176:179], v[36:39], v[68:71], v[176:179]
    v_mfma_f32_16x16x32_bf16 v[180:183], v[36:39], v[72:75], v[180:183]
    s_waitcnt vmcnt(38) lgkmcnt(0)
    s_barrier
    v_mfma_f32_16x16x32_bf16 v[128:131], v[40:43], v[76:79], v[128:131]
    s_add_u32 s61, s62, 24576
    s_and_b32 s61, s61, 0x1ffff
    s_mov_b32 m0, 83968
    s_add_u32 s47, s61, 0
    buffer_load_dwordx4 v3, s[28:31], s47 offen lds
    s_mov_b32 m0, 84992
    s_add_u32 s47, s61, 0
    buffer_load_dwordx4 v4, s[28:31], s47 offen lds
    s_mov_b32 m0, 86016
    s_add_u32 s47, s61, 0
    buffer_load_dwordx4 v5, s[28:31], s47 offen lds
    s_mov_b32 m0, 87040
    s_add_u32 s47, s61, 0
    buffer_load_dwordx4 v9, s[28:31], s47 offen lds
    s_mov_b32 m0, 88064
    s_add_u32 s47, s61, 4096
    buffer_load_dwordx4 v3, s[28:31], s47 offen lds
    s_mov_b32 m0, 89088
    s_add_u32 s47, s61, 4096
    buffer_load_dwordx4 v4, s[28:31], s47 offen lds
    s_mov_b32 m0, 90112
    s_add_u32 s47, s61, 4096
    buffer_load_dwordx4 v5, s[28:31], s47 offen lds
    s_mov_b32 m0, 91136
    s_add_u32 s47, s61, 4096
    buffer_load_dwordx4 v9, s[28:31], s47 offen lds
    s_add_u32 s61, s62, 8192
    s_and_b32 s61, s61, 0x1ffff
    s_mov_b32 m0, 92160
    s_add_u32 s47, s61, 0
    buffer_load_dwordx4 v18, s[32:35], s47 offen lds
    s_mov_b32 m0, 93184
    s_add_u32 s47, s61, 1024
    buffer_load_dwordx4 v18, s[32:35], s47 offen lds
    s_mov_b32 m0, 94208
    s_add_u32 s47, s61, 2048
    buffer_load_dwordx4 v18, s[32:35], s47 offen lds
    s_mov_b32 m0, 95232
    s_add_u32 s47, s61, 3072
    buffer_load_dwordx4 v18, s[32:35], s47 offen lds
    s_mov_b32 m0, 96256
    s_add_u32 s47, s61, 4096
    buffer_load_dwordx4 v18, s[32:35], s47 offen lds
    s_mov_b32 m0, 97280
    s_add_u32 s47, s61, 5120
    buffer_load_dwordx4 v18, s[32:35], s47 offen lds
    s_mov_b32 m0, 98304
    s_add_u32 s47, s61, 6144
    buffer_load_dwordx4 v18, s[32:35], s47 offen lds
    s_mov_b32 m0, 99328
    s_add_u32 s47, s61, 7168
    buffer_load_dwordx4 v18, s[32:35], s47 offen lds
    v_mfma_f32_16x16x32_bf16 v[132:135], v[40:43], v[80:83], v[132:135]
    ds_read_b64_tr_b16 v[32:33], v10 offset:16384
    ds_read_b64_tr_b16 v[34:35], v10 offset:18432
    v_mfma_f32_16x16x32_bf16 v[136:139], v[40:43], v[84:87], v[136:139]
    ds_read_b64_tr_b16 v[36:37], v29 offset:16384
    ds_read_b64_tr_b16 v[38:39], v29 offset:18432
    v_mfma_f32_16x16x32_bf16 v[140:143], v[40:43], v[88:91], v[140:143]
    ds_read_b128 v[48:51], v8 offset:14336
    ds_read_b128 v[52:55], v8 offset:16384
    v_mfma_f32_16x16x32_bf16 v[144:147], v[40:43], v[92:95], v[144:147]
    ds_read_b128 v[56:59], v8 offset:18432
    v_mfma_f32_16x16x32_bf16 v[148:151], v[40:43], v[96:99], v[148:151]
    ds_read_b128 v[60:63], v8 offset:20480
    v_mfma_f32_16x16x32_bf16 v[152:155], v[40:43], v[100:103], v[152:155]
    ds_read_b128 v[64:67], v8 offset:22528
    v_mfma_f32_16x16x32_bf16 v[156:159], v[44:47], v[76:79], v[156:159]
    ds_read_b128 v[68:71], v8 offset:24576
    v_mfma_f32_16x16x32_bf16 v[160:163], v[44:47], v[80:83], v[160:163]
    ds_read_b128 v[72:75], v8 offset:26624
    v_mfma_f32_16x16x32_bf16 v[164:167], v[44:47], v[84:87], v[164:167]
    v_mfma_f32_16x16x32_bf16 v[168:171], v[44:47], v[88:91], v[168:171]
    v_mfma_f32_16x16x32_bf16 v[172:175], v[44:47], v[92:95], v[172:175]
    v_mfma_f32_16x16x32_bf16 v[176:179], v[44:47], v[96:99], v[176:179]
    v_mfma_f32_16x16x32_bf16 v[180:183], v[44:47], v[100:103], v[180:183]
    s_waitcnt vmcnt(44) lgkmcnt(0)
    s_barrier
    v_mfma_f32_16x16x32_bf16 v[128:131], v[32:35], v[48:51], v[128:131]
    s_add_u32 s61, s62, 32768
    s_and_b32 s61, s61, 0x1ffff
    s_mov_b32 m0, 100352
    s_add_u32 s47, s61, 0
    buffer_load_dwordx4 v3, s[28:31], s47 offen lds
    s_mov_b32 m0, 101376
    s_add_u32 s47, s61, 0
    buffer_load_dwordx4 v4, s[28:31], s47 offen lds
    s_mov_b32 m0, 102400
    s_add_u32 s47, s61, 0
    buffer_load_dwordx4 v5, s[28:31], s47 offen lds
    s_mov_b32 m0, 103424
    s_add_u32 s47, s61, 0
    buffer_load_dwordx4 v9, s[28:31], s47 offen lds
    s_mov_b32 m0, 104448
    s_add_u32 s47, s61, 4096
    buffer_load_dwordx4 v3, s[28:31], s47 offen lds
    s_mov_b32 m0, 105472
    s_add_u32 s47, s61, 4096
    buffer_load_dwordx4 v4, s[28:31], s47 offen lds
    s_mov_b32 m0, 106496
    s_add_u32 s47, s61, 4096
    buffer_load_dwordx4 v5, s[28:31], s47 offen lds
    s_mov_b32 m0, 107520
    s_add_u32 s47, s61, 4096
    buffer_load_dwordx4 v9, s[28:31], s47 offen lds
    s_add_u32 s61, s62, 16384
    s_and_b32 s61, s61, 0x1ffff
    s_mov_b32 m0, 108544
    s_add_u32 s47, s61, 0
    buffer_load_dwordx4 v18, s[32:35], s47 offen lds
    s_mov_b32 m0, 109568
    s_add_u32 s47, s61, 1024
    buffer_load_dwordx4 v18, s[32:35], s47 offen lds
    s_mov_b32 m0, 110592
    s_add_u32 s47, s61, 2048
    buffer_load_dwordx4 v18, s[32:35], s47 offen lds
    s_mov_b32 m0, 111616
    s_add_u32 s47, s61, 3072
    buffer_load_dwordx4 v18, s[32:35], s47 offen lds
    s_mov_b32 m0, 112640
    s_add_u32 s47, s61, 4096
    buffer_load_dwordx4 v18, s[32:35], s47 offen lds
    s_mov_b32 m0, 113664
    s_add_u32 s47, s61, 5120
    buffer_load_dwordx4 v18, s[32:35], s47 offen lds
    s_mov_b32 m0, 114688
    s_add_u32 s47, s61, 6144
    buffer_load_dwordx4 v18, s[32:35], s47 offen lds
    s_mov_b32 m0, 115712
    s_add_u32 s47, s61, 7168
    buffer_load_dwordx4 v18, s[32:35], s47 offen lds
    v_mfma_f32_16x16x32_bf16 v[132:135], v[32:35], v[52:55], v[132:135]
    ds_read_b64_tr_b16 v[40:41], v10 offset:32768
    ds_read_b64_tr_b16 v[42:43], v10 offset:34816
    v_mfma_f32_16x16x32_bf16 v[136:139], v[32:35], v[56:59], v[136:139]
    ds_read_b64_tr_b16 v[44:45], v29 offset:32768
    ds_read_b64_tr_b16 v[46:47], v29 offset:34816
    v_mfma_f32_16x16x32_bf16 v[140:143], v[32:35], v[60:63], v[140:143]
    ds_read_b128 v[76:79], v31 offset:14336
    ds_read_b128 v[80:83], v31 offset:16384
    v_mfma_f32_16x16x32_bf16 v[144:147], v[32:35], v[64:67], v[144:147]
    ds_read_b128 v[84:87], v31 offset:18432
    v_mfma_f32_16x16x32_bf16 v[148:151], v[32:35], v[68:71], v[148:151]
    ds_read_b128 v[88:91], v31 offset:20480
    v_mfma_f32_16x16x32_bf16 v[152:155], v[32:35], v[72:75], v[152:155]
    ds_read_b128 v[92:95], v31 offset:22528
    v_mfma_f32_16x16x32_bf16 v[156:159], v[36:39], v[48:51], v[156:159]
    ds_read_b128 v[96:99], v31 offset:24576
    v_mfma_f32_16x16x32_bf16 v[160:163], v[36:39], v[52:55], v[160:163]
    ds_read_b128 v[100:103], v31 offset:26624
    v_mfma_f32_16x16x32_bf16 v[164:167], v[36:39], v[56:59], v[164:167]
    v_mfma_f32_16x16x32_bf16 v[168:171], v[36:39], v[60:63], v[168:171]
    v_mfma_f32_16x16x32_bf16 v[172:175], v[36:39], v[64:67], v[172:175]
    v_mfma_f32_16x16x32_bf16 v[176:179], v[36:39], v[68:71], v[176:179]
    v_mfma_f32_16x16x32_bf16 v[180:183], v[36:39], v[72:75], v[180:183]
    s_waitcnt vmcnt(50) lgkmcnt(0)
    s_barrier
    v_mfma_f32_16x16x32_bf16 v[128:131], v[40:43], v[76:79], v[128:131]
    s_add_u32 s61, s62, 40960
    s_and_b32 s61, s61, 0x1ffff
    s_mov_b32 m0, 116736
    s_add_u32 s47, s61, 0
    buffer_load_dwordx4 v3, s[28:31], s47 offen lds
    s_mov_b32 m0, 117760
    s_add_u32 s47, s61, 0
    buffer_load_dwordx4 v4, s[28:31], s47 offen lds
    s_mov_b32 m0, 118784
    s_add_u32 s47, s61, 0
    buffer_load_dwordx4 v5, s[28:31], s47 offen lds
    s_mov_b32 m0, 119808
    s_add_u32 s47, s61, 0
    buffer_load_dwordx4 v9, s[28:31], s47 offen lds
    s_mov_b32 m0, 120832
    s_add_u32 s47, s61, 4096
    buffer_load_dwordx4 v3, s[28:31], s47 offen lds
    s_mov_b32 m0, 121856
    s_add_u32 s47, s61, 4096
    buffer_load_dwordx4 v4, s[28:31], s47 offen lds
    s_mov_b32 m0, 122880
    s_add_u32 s47, s61, 4096
    buffer_load_dwordx4 v5, s[28:31], s47 offen lds
    s_mov_b32 m0, 123904
    s_add_u32 s47, s61, 4096
    buffer_load_dwordx4 v9, s[28:31], s47 offen lds
    s_add_u32 s61, s62, 24576
    s_and_b32 s61, s61, 0x1ffff
    s_mov_b32 m0, 124928
    s_add_u32 s47, s61, 0
    buffer_load_dwordx4 v18, s[32:35], s47 offen lds
    s_mov_b32 m0, 125952
    s_add_u32 s47, s61, 1024
    buffer_load_dwordx4 v18, s[32:35], s47 offen lds
    s_mov_b32 m0, 126976
    s_add_u32 s47, s61, 2048
    buffer_load_dwordx4 v18, s[32:35], s47 offen lds
    s_mov_b32 m0, 128000
    s_add_u32 s47, s61, 3072
    buffer_load_dwordx4 v18, s[32:35], s47 offen lds
    s_mov_b32 m0, 129024
    s_add_u32 s47, s61, 4096
    buffer_load_dwordx4 v18, s[32:35], s47 offen lds
    s_mov_b32 m0, 130048
    s_add_u32 s47, s61, 5120
    buffer_load_dwordx4 v18, s[32:35], s47 offen lds
    s_mov_b32 m0, 131072
    s_add_u32 s47, s61, 6144
    buffer_load_dwordx4 v18, s[32:35], s47 offen lds
    s_mov_b32 m0, 132096
    s_add_u32 s47, s61, 7168
    buffer_load_dwordx4 v18, s[32:35], s47 offen lds
    v_mfma_f32_16x16x32_bf16 v[132:135], v[40:43], v[80:83], v[132:135]
    ds_read_b64_tr_b16 v[32:33], v10 offset:49152
    ds_read_b64_tr_b16 v[34:35], v10 offset:51200
    v_mfma_f32_16x16x32_bf16 v[136:139], v[40:43], v[84:87], v[136:139]
    ds_read_b64_tr_b16 v[36:37], v29 offset:49152
    ds_read_b64_tr_b16 v[38:39], v29 offset:51200
    v_mfma_f32_16x16x32_bf16 v[140:143], v[40:43], v[88:91], v[140:143]
    ds_read_b128 v[48:51], v8 offset:28672
    ds_read_b128 v[52:55], v8 offset:30720
    v_mfma_f32_16x16x32_bf16 v[144:147], v[40:43], v[92:95], v[144:147]
    ds_read_b128 v[56:59], v8 offset:32768
    v_mfma_f32_16x16x32_bf16 v[148:151], v[40:43], v[96:99], v[148:151]
    ds_read_b128 v[60:63], v8 offset:34816
    v_mfma_f32_16x16x32_bf16 v[152:155], v[40:43], v[100:103], v[152:155]
    ds_read_b128 v[64:67], v8 offset:36864
    v_mfma_f32_16x16x32_bf16 v[156:159], v[44:47], v[76:79], v[156:159]
    ds_read_b128 v[68:71], v8 offset:38912
    v_mfma_f32_16x16x32_bf16 v[160:163], v[44:47], v[80:83], v[160:163]
    ds_read_b128 v[72:75], v8 offset:40960
    v_mfma_f32_16x16x32_bf16 v[164:167], v[44:47], v[84:87], v[164:167]
    v_mfma_f32_16x16x32_bf16 v[168:171], v[44:47], v[88:91], v[168:171]
    v_mfma_f32_16x16x32_bf16 v[172:175], v[44:47], v[92:95], v[172:175]
    v_mfma_f32_16x16x32_bf16 v[176:179], v[44:47], v[96:99], v[176:179]
    v_mfma_f32_16x16x32_bf16 v[180:183], v[44:47], v[100:103], v[180:183]
    s_waitcnt vmcnt(56) lgkmcnt(0)
    s_barrier
    v_mfma_f32_16x16x32_bf16 v[128:131], v[32:35], v[48:51], v[128:131]
    s_add_u32 s61, s62, 32768
    s_and_b32 s61, s61, 0x1ffff
    s_mov_b32 m0, 133120
    s_add_u32 s47, s61, 0
    buffer_load_dwordx4 v18, s[32:35], s47 offen lds
    s_mov_b32 m0, 134144
    s_add_u32 s47, s61, 1024
    buffer_load_dwordx4 v18, s[32:35], s47 offen lds
    s_mov_b32 m0, 135168
    s_add_u32 s47, s61, 2048
    buffer_load_dwordx4 v18, s[32:35], s47 offen lds
    s_mov_b32 m0, 136192
    s_add_u32 s47, s61, 3072
    buffer_load_dwordx4 v18, s[32:35], s47 offen lds
    s_mov_b32 m0, 137216
    s_add_u32 s47, s61, 4096
    buffer_load_dwordx4 v18, s[32:35], s47 offen lds
    s_mov_b32 m0, 138240
    s_add_u32 s47, s61, 5120
    buffer_load_dwordx4 v18, s[32:35], s47 offen lds
    s_mov_b32 m0, 139264
    s_add_u32 s47, s61, 6144
    buffer_load_dwordx4 v18, s[32:35], s47 offen lds
    s_mov_b32 m0, 140288
    s_add_u32 s47, s61, 7168
    buffer_load_dwordx4 v18, s[32:35], s47 offen lds
    v_mfma_f32_16x16x32_bf16 v[132:135], v[32:35], v[52:55], v[132:135]
    ds_read_b64_tr_b16 v[40:41], v6 offset:0
    ds_read_b64_tr_b16 v[42:43], v6 offset:2048
    v_mfma_f32_16x16x32_bf16 v[136:139], v[32:35], v[56:59], v[136:139]
    ds_read_b64_tr_b16 v[44:45], v7 offset:0
    ds_read_b64_tr_b16 v[46:47], v7 offset:2048
    v_mfma_f32_16x16x32_bf16 v[140:143], v[32:35], v[60:63], v[140:143]
    ds_read_b128 v[76:79], v31 offset:28672
    ds_read_b128 v[80:83], v31 offset:30720
    v_mfma_f32_16x16x32_bf16 v[144:147], v[32:35], v[64:67], v[144:147]
    ds_read_b128 v[84:87], v31 offset:32768
    v_mfma_f32_16x16x32_bf16 v[148:151], v[32:35], v[68:71], v[148:151]
    ds_read_b128 v[88:91], v31 offset:34816
    v_mfma_f32_16x16x32_bf16 v[152:155], v[32:35], v[72:75], v[152:155]
    ds_read_b128 v[92:95], v31 offset:36864
    v_mfma_f32_16x16x32_bf16 v[156:159], v[36:39], v[48:51], v[156:159]
    ds_read_b128 v[96:99], v31 offset:38912
    v_mfma_f32_16x16x32_bf16 v[160:163], v[36:39], v[52:55], v[160:163]
    ds_read_b128 v[100:103], v31 offset:40960
    v_mfma_f32_16x16x32_bf16 v[164:167], v[36:39], v[56:59], v[164:167]
    v_mfma_f32_16x16x32_bf16 v[168:171], v[36:39], v[60:63], v[168:171]
    v_mfma_f32_16x16x32_bf16 v[172:175], v[36:39], v[64:67], v[172:175]
    v_mfma_f32_16x16x32_bf16 v[176:179], v[36:39], v[68:71], v[176:179]
    v_mfma_f32_16x16x32_bf16 v[180:183], v[36:39], v[72:75], v[180:183]
    s_waitcnt vmcnt(63) lgkmcnt(0)
    s_barrier
    v_mfma_f32_16x16x32_bf16 v[128:131], v[40:43], v[76:79], v[128:131]
    v_lshrrev_b32 v11, 4, v2
    v_and_b32 v12, 15, v2
    s_lshr_b32 s46, s45, 2
    v_mfma_f32_16x16x32_bf16 v[132:135], v[40:43], v[80:83], v[132:135]
    s_mul_i32 s46, s46, 28672
    v_lshlrev_b32 v13, 8, v12
    v_add_u32 v13, s46, v13
    v_mfma_f32_16x16x32_bf16 v[136:139], v[40:43], v[84:87], v[136:139]
    v_and_b32 v14, 1, v11
    v_lshlrev_b32 v14, 3, v14
    v_add_u32 v13, v13, v14
    v_mfma_f32_16x16x32_bf16 v[140:143], v[40:43], v[88:91], v[140:143]
    v_lshrrev_b32 v14, 1, v11
    s_and_b32 s46, s45, 3
    s_lshl_b32 s46, s46, 2
    v_mfma_f32_16x16x32_bf16 v[144:147], v[40:43], v[92:95], v[144:147]
    v_add_u32 v14, s46, v14
    v_add_u32 v15, 0, v14
    v_xor_b32 v15, v15, v12
    v_mfma_f32_16x16x32_bf16 v[148:151], v[40:43], v[96:99], v[148:151]
    v_lshlrev_b32 v15, 4, v15
    v_add_u32 v16, v13, v15
    v_add_u32 v15, 2, v14
    v_mfma_f32_16x16x32_bf16 v[152:155], v[40:43], v[100:103], v[152:155]
    v_xor_b32 v15, v15, v12
    v_lshlrev_b32 v15, 4, v15
    v_add_u32 v17, v13, v15
    v_mfma_f32_16x16x32_bf16 v[156:159], v[44:47], v[76:79], v[156:159]
    v_mfma_f32_16x16x32_bf16 v[160:163], v[44:47], v[80:83], v[160:163]
    v_cvt_pk_bf16_f32 v128, v128, v129
    v_cvt_pk_bf16_f32 v129, v130, v131
    ds_write_b64 v16, v[128:129] offset:0
    v_mfma_f32_16x16x32_bf16 v[164:167], v[44:47], v[84:87], v[164:167]
    v_cvt_pk_bf16_f32 v132, v132, v133
    v_cvt_pk_bf16_f32 v133, v134, v135
    ds_write_b64 v16, v[132:133] offset:4096
    v_mfma_f32_16x16x32_bf16 v[168:171], v[44:47], v[88:91], v[168:171]
    v_cvt_pk_bf16_f32 v136, v136, v137
    v_cvt_pk_bf16_f32 v137, v138, v139
    ds_write_b64 v16, v[136:137] offset:8192
    v_mfma_f32_16x16x32_bf16 v[172:175], v[44:47], v[92:95], v[172:175]
    v_cvt_pk_bf16_f32 v140, v140, v141
    v_cvt_pk_bf16_f32 v141, v142, v143
    ds_write_b64 v16, v[140:141] offset:12288
    v_mfma_f32_16x16x32_bf16 v[176:179], v[44:47], v[96:99], v[176:179]
    v_cvt_pk_bf16_f32 v144, v144, v145
    v_cvt_pk_bf16_f32 v145, v146, v147
    ds_write_b64 v16, v[144:145] offset:16384
    v_mfma_f32_16x16x32_bf16 v[180:183], v[44:47], v[100:103], v[180:183]
    v_cvt_pk_bf16_f32 v148, v148, v149
    v_cvt_pk_bf16_f32 v149, v150, v151
    ds_write_b64 v16, v[148:149] offset:20480
    v_cvt_pk_bf16_f32 v152, v152, v153
    v_cvt_pk_bf16_f32 v153, v154, v155
    ds_write_b64 v16, v[152:153] offset:24576
    v_cvt_pk_bf16_f32 v156, v156, v157
    v_cvt_pk_bf16_f32 v157, v158, v159
    ds_write_b64 v17, v[156:157] offset:0
    v_cvt_pk_bf16_f32 v160, v160, v161
    v_cvt_pk_bf16_f32 v161, v162, v163
    ds_write_b64 v17, v[160:161] offset:4096
    v_cvt_pk_bf16_f32 v164, v164, v165
    v_cvt_pk_bf16_f32 v165, v166, v167
    ds_write_b64 v17, v[164:165] offset:8192
    v_cvt_pk_bf16_f32 v168, v168, v169
    v_cvt_pk_bf16_f32 v169, v170, v171
    ds_write_b64 v17, v[168:169] offset:12288
    v_cvt_pk_bf16_f32 v172, v172, v173
    v_cvt_pk_bf16_f32 v173, v174, v175
    ds_write_b64 v17, v[172:173] offset:16384
    v_cvt_pk_bf16_f32 v176, v176, v177
    v_cvt_pk_bf16_f32 v177, v178, v179
    ds_write_b64 v17, v[176:177] offset:20480
    v_cvt_pk_bf16_f32 v180, v180, v181
    v_cvt_pk_bf16_f32 v181, v182, v183
    ds_write_b64 v17, v[180:181] offset:24576
    s_waitcnt lgkmcnt(0)
    s_barrier
    s_waitcnt vmcnt(56)
    s_barrier
    s_add_u32 s61, s62, 49152
    s_and_b32 s61, s61, 0x1ffff
    s_mov_b32 m0, 59392
    s_add_u32 s47, s61, 0
    buffer_load_dwordx4 v3, s[28:31], s47 offen lds
    s_mov_b32 m0, 60416
    s_add_u32 s47, s61, 0
    buffer_load_dwordx4 v4, s[28:31], s47 offen lds
    s_mov_b32 m0, 61440
    s_add_u32 s47, s61, 0
    buffer_load_dwordx4 v5, s[28:31], s47 offen lds
    s_mov_b32 m0, 62464
    s_add_u32 s47, s61, 0
    buffer_load_dwordx4 v9, s[28:31], s47 offen lds
    s_mov_b32 m0, 63488
    s_add_u32 s47, s61, 4096
    buffer_load_dwordx4 v3, s[28:31], s47 offen lds
    s_mov_b32 m0, 64512
    s_add_u32 s47, s61, 4096
    buffer_load_dwordx4 v4, s[28:31], s47 offen lds
    s_mov_b32 m0, 65536
    s_add_u32 s47, s61, 4096
    buffer_load_dwordx4 v5, s[28:31], s47 offen lds
    s_mov_b32 m0, 66560
    s_add_u32 s47, s61, 4096
    buffer_load_dwordx4 v9, s[28:31], s47 offen lds
    s_add_u32 s61, s62, 57344
    s_and_b32 s61, s61, 0x1ffff
    s_mov_b32 m0, 67584
    s_add_u32 s47, s61, 0
    buffer_load_dwordx4 v3, s[28:31], s47 offen lds
    s_mov_b32 m0, 68608
    s_add_u32 s47, s61, 0
    buffer_load_dwordx4 v4, s[28:31], s47 offen lds
    s_mov_b32 m0, 69632
    s_add_u32 s47, s61, 0
    buffer_load_dwordx4 v5, s[28:31], s47 offen lds
    s_mov_b32 m0, 70656
    s_add_u32 s47, s61, 0
    buffer_load_dwordx4 v9, s[28:31], s47 offen lds
    s_mov_b32 m0, 71680
    s_add_u32 s47, s61, 4096
    buffer_load_dwordx4 v3, s[28:31], s47 offen lds
    s_mov_b32 m0, 72704
    s_add_u32 s47, s61, 4096
    buffer_load_dwordx4 v4, s[28:31], s47 offen lds
    s_mov_b32 m0, 73728
    s_add_u32 s47, s61, 4096
    buffer_load_dwordx4 v5, s[28:31], s47 offen lds
    s_mov_b32 m0, 74752
    s_add_u32 s47, s61, 4096
    buffer_load_dwordx4 v9, s[28:31], s47 offen lds
    s_waitcnt vmcnt(56)
    s_barrier
    s_add_u32 s61, s62, 65536
    s_and_b32 s61, s61, 0x1ffff
    s_mov_b32 m0, 75776
    s_add_u32 s47, s61, 0
    buffer_load_dwordx4 v3, s[28:31], s47 offen lds
    s_mov_b32 m0, 76800
    s_add_u32 s47, s61, 0
    buffer_load_dwordx4 v4, s[28:31], s47 offen lds
    s_mov_b32 m0, 77824
    s_add_u32 s47, s61, 0
    buffer_load_dwordx4 v5, s[28:31], s47 offen lds
    s_mov_b32 m0, 78848
    s_add_u32 s47, s61, 0
    buffer_load_dwordx4 v9, s[28:31], s47 offen lds
    s_mov_b32 m0, 79872
    s_add_u32 s47, s61, 4096
    buffer_load_dwordx4 v3, s[28:31], s47 offen lds
    s_mov_b32 m0, 80896
    s_add_u32 s47, s61, 4096
    buffer_load_dwordx4 v4, s[28:31], s47 offen lds
    s_mov_b32 m0, 81920
    s_add_u32 s47, s61, 4096
    buffer_load_dwordx4 v5, s[28:31], s47 offen lds
    s_mov_b32 m0, 82944
    s_add_u32 s47, s61, 4096
    buffer_load_dwordx4 v9, s[28:31], s47 offen lds
    s_add_u32 s61, s62, 40960
    s_and_b32 s61, s61, 0x1ffff
    s_mov_b32 m0, 149504
    s_add_u32 s47, s61, 0
    buffer_load_dwordx4 v18, s[32:35], s47 offen lds
    s_mov_b32 m0, 150528
    s_add_u32 s47, s61, 1024
    buffer_load_dwordx4 v18, s[32:35], s47 offen lds
    s_mov_b32 m0, 151552
    s_add_u32 s47, s61, 2048
    buffer_load_dwordx4 v18, s[32:35], s47 offen lds
    s_mov_b32 m0, 152576
    s_add_u32 s47, s61, 3072
    buffer_load_dwordx4 v18, s[32:35], s47 offen lds
    s_mov_b32 m0, 153600
    s_add_u32 s47, s61, 4096
    buffer_load_dwordx4 v18, s[32:35], s47 offen lds
    s_mov_b32 m0, 154624
    s_add_u32 s47, s61, 5120
    buffer_load_dwordx4 v18, s[32:35], s47 offen lds
    s_mov_b32 m0, 155648
    s_add_u32 s47, s61, 6144
    buffer_load_dwordx4 v18, s[32:35], s47 offen lds
    s_mov_b32 m0, 156672
    s_add_u32 s47, s61, 7168
    buffer_load_dwordx4 v18, s[32:35], s47 offen lds
    s_waitcnt vmcnt(56)
    s_barrier
    s_add_u32 s61, s62, 73728
    s_and_b32 s61, s61, 0x1ffff
    s_mov_b32 m0, 83968
    s_add_u32 s47, s61, 0
    buffer_load_dwordx4 v3, s[28:31], s47 offen lds
    s_mov_b32 m0, 84992
    s_add_u32 s47, s61, 0
    buffer_load_dwordx4 v4, s[28:31], s47 offen lds
    s_mov_b32 m0, 86016
    s_add_u32 s47, s61, 0
    buffer_load_dwordx4 v5, s[28:31], s47 offen lds
    s_mov_b32 m0, 87040
    s_add_u32 s47, s61, 0
    buffer_load_dwordx4 v9, s[28:31], s47 offen lds
    s_mov_b32 m0, 88064
    s_add_u32 s47, s61, 4096
    buffer_load_dwordx4 v3, s[28:31], s47 offen lds
    s_mov_b32 m0, 89088
    s_add_u32 s47, s61, 4096
    buffer_load_dwordx4 v4, s[28:31], s47 offen lds
    s_mov_b32 m0, 90112
    s_add_u32 s47, s61, 4096
    buffer_load_dwordx4 v5, s[28:31], s47 offen lds
    s_mov_b32 m0, 91136
    s_add_u32 s47, s61, 4096
    buffer_load_dwordx4 v9, s[28:31], s47 offen lds
    s_add_u32 s61, s62, 49152
    s_and_b32 s61, s61, 0x1ffff
    s_mov_b32 m0, 92160
    s_add_u32 s47, s61, 0
    buffer_load_dwordx4 v18, s[32:35], s47 offen lds
    s_mov_b32 m0, 93184
    s_add_u32 s47, s61, 1024
    buffer_load_dwordx4 v18, s[32:35], s47 offen lds
    s_mov_b32 m0, 94208
    s_add_u32 s47, s61, 2048
    buffer_load_dwordx4 v18, s[32:35], s47 offen lds
    s_mov_b32 m0, 95232
    s_add_u32 s47, s61, 3072
    buffer_load_dwordx4 v18, s[32:35], s47 offen lds
    s_mov_b32 m0, 96256
    s_add_u32 s47, s61, 4096
    buffer_load_dwordx4 v18, s[32:35], s47 offen lds
    s_mov_b32 m0, 97280
    s_add_u32 s47, s61, 5120
    buffer_load_dwordx4 v18, s[32:35], s47 offen lds
    s_mov_b32 m0, 98304
    s_add_u32 s47, s61, 6144
    buffer_load_dwordx4 v18, s[32:35], s47 offen lds
    s_mov_b32 m0, 99328
    s_add_u32 s47, s61, 7168
    buffer_load_dwordx4 v18, s[32:35], s47 offen lds
    s_waitcnt vmcnt(56)
    s_barrier
    s_add_u32 s61, s62, 81920
    s_and_b32 s61, s61, 0x1ffff
    s_mov_b32 m0, 100352
    s_add_u32 s47, s61, 0
    buffer_load_dwordx4 v3, s[28:31], s47 offen lds
    s_mov_b32 m0, 101376
    s_add_u32 s47, s61, 0
    buffer_load_dwordx4 v4, s[28:31], s47 offen lds
    s_mov_b32 m0, 102400
    s_add_u32 s47, s61, 0
    buffer_load_dwordx4 v5, s[28:31], s47 offen lds
    s_mov_b32 m0, 103424
    s_add_u32 s47, s61, 0
    buffer_load_dwordx4 v9, s[28:31], s47 offen lds
    s_mov_b32 m0, 104448
    s_add_u32 s47, s61, 4096
    buffer_load_dwordx4 v3, s[28:31], s47 offen lds
    s_mov_b32 m0, 105472
    s_add_u32 s47, s61, 4096
    buffer_load_dwordx4 v4, s[28:31], s47 offen lds
    s_mov_b32 m0, 106496
    s_add_u32 s47, s61, 4096
    buffer_load_dwordx4 v5, s[28:31], s47 offen lds
    s_mov_b32 m0, 107520
    s_add_u32 s47, s61, 4096
    buffer_load_dwordx4 v9, s[28:31], s47 offen lds
    s_add_u32 s61, s62, 57344
    s_and_b32 s61, s61, 0x1ffff
    s_mov_b32 m0, 108544
    s_add_u32 s47, s61, 0
    buffer_load_dwordx4 v18, s[32:35], s47 offen lds
    s_mov_b32 m0, 109568
    s_add_u32 s47, s61, 1024
    buffer_load_dwordx4 v18, s[32:35], s47 offen lds
    s_mov_b32 m0, 110592
    s_add_u32 s47, s61, 2048
    buffer_load_dwordx4 v18, s[32:35], s47 offen lds
    s_mov_b32 m0, 111616
    s_add_u32 s47, s61, 3072
    buffer_load_dwordx4 v18, s[32:35], s47 offen lds
    s_mov_b32 m0, 112640
    s_add_u32 s47, s61, 4096
    buffer_load_dwordx4 v18, s[32:35], s47 offen lds
    s_mov_b32 m0, 113664
    s_add_u32 s47, s61, 5120
    buffer_load_dwordx4 v18, s[32:35], s47 offen lds
    s_mov_b32 m0, 114688
    s_add_u32 s47, s61, 6144
    buffer_load_dwordx4 v18, s[32:35], s47 offen lds
    s_mov_b32 m0, 115712
    s_add_u32 s47, s61, 7168
    buffer_load_dwordx4 v18, s[32:35], s47 offen lds
    s_waitcnt vmcnt(56)
    s_barrier
    s_add_u32 s61, s62, 90112
    s_and_b32 s61, s61, 0x1ffff
    s_mov_b32 m0, 116736
    s_add_u32 s47, s61, 0
    buffer_load_dwordx4 v3, s[28:31], s47 offen lds
    s_mov_b32 m0, 117760
    s_add_u32 s47, s61, 0
    buffer_load_dwordx4 v4, s[28:31], s47 offen lds
    s_mov_b32 m0, 118784
    s_add_u32 s47, s61, 0
    buffer_load_dwordx4 v5, s[28:31], s47 offen lds
    s_mov_b32 m0, 119808
    s_add_u32 s47, s61, 0
    buffer_load_dwordx4 v9, s[28:31], s47 offen lds
    s_mov_b32 m0, 120832
    s_add_u32 s47, s61, 4096
    buffer_load_dwordx4 v3, s[28:31], s47 offen lds
    s_mov_b32 m0, 121856
    s_add_u32 s47, s61, 4096
    buffer_load_dwordx4 v4, s[28:31], s47 offen lds
    s_mov_b32 m0, 122880
    s_add_u32 s47, s61, 4096
    buffer_load_dwordx4 v5, s[28:31], s47 offen lds
    s_mov_b32 m0, 123904
    s_add_u32 s47, s61, 4096
    buffer_load_dwordx4 v9, s[28:31], s47 offen lds
    s_add_u32 s61, s62, 65536
    s_and_b32 s61, s61, 0x1ffff
    s_mov_b32 m0, 124928
    s_add_u32 s47, s61, 0
    buffer_load_dwordx4 v18, s[32:35], s47 offen lds
    s_mov_b32 m0, 125952
    s_add_u32 s47, s61, 1024
    buffer_load_dwordx4 v18, s[32:35], s47 offen lds
    s_mov_b32 m0, 126976
    s_add_u32 s47, s61, 2048
    buffer_load_dwordx4 v18, s[32:35], s47 offen lds
    s_mov_b32 m0, 128000
    s_add_u32 s47, s61, 3072
    buffer_load_dwordx4 v18, s[32:35], s47 offen lds
    s_mov_b32 m0, 129024
    s_add_u32 s47, s61, 4096
    buffer_load_dwordx4 v18, s[32:35], s47 offen lds
    s_mov_b32 m0, 130048
    s_add_u32 s47, s61, 5120
    buffer_load_dwordx4 v18, s[32:35], s47 offen lds
    s_mov_b32 m0, 131072
    s_add_u32 s47, s61, 6144
    buffer_load_dwordx4 v18, s[32:35], s47 offen lds
    s_mov_b32 m0, 132096
    s_add_u32 s47, s61, 7168
    buffer_load_dwordx4 v18, s[32:35], s47 offen lds
    s_waitcnt vmcnt(48)
    s_barrier
    s_add_u32 s61, s62, 98304
    s_and_b32 s61, s61, 0x1ffff
    s_mov_b32 m0, 59392
    s_add_u32 s47, s61, 0
    buffer_load_dwordx4 v3, s[28:31], s47 offen lds
    s_mov_b32 m0, 60416
    s_add_u32 s47, s61, 0
    buffer_load_dwordx4 v4, s[28:31], s47 offen lds
    s_mov_b32 m0, 61440
    s_add_u32 s47, s61, 0
    buffer_load_dwordx4 v5, s[28:31], s47 offen lds
    s_mov_b32 m0, 62464
    s_add_u32 s47, s61, 0
    buffer_load_dwordx4 v9, s[28:31], s47 offen lds
    s_mov_b32 m0, 63488
    s_add_u32 s47, s61, 4096
    buffer_load_dwordx4 v3, s[28:31], s47 offen lds
    s_mov_b32 m0, 64512
    s_add_u32 s47, s61, 4096
    buffer_load_dwordx4 v4, s[28:31], s47 offen lds
    s_mov_b32 m0, 65536
    s_add_u32 s47, s61, 4096
    buffer_load_dwordx4 v5, s[28:31], s47 offen lds
    s_mov_b32 m0, 66560
    s_add_u32 s47, s61, 4096
    buffer_load_dwordx4 v9, s[28:31], s47 offen lds
    s_add_u32 s61, s62, 73728
    s_and_b32 s61, s61, 0x1ffff
    s_mov_b32 m0, 133120
    s_add_u32 s47, s61, 0
    buffer_load_dwordx4 v18, s[32:35], s47 offen lds
    s_mov_b32 m0, 134144
    s_add_u32 s47, s61, 1024
    buffer_load_dwordx4 v18, s[32:35], s47 offen lds
    s_mov_b32 m0, 135168
    s_add_u32 s47, s61, 2048
    buffer_load_dwordx4 v18, s[32:35], s47 offen lds
    s_mov_b32 m0, 136192
    s_add_u32 s47, s61, 3072
    buffer_load_dwordx4 v18, s[32:35], s47 offen lds
    s_mov_b32 m0, 137216
    s_add_u32 s47, s61, 4096
    buffer_load_dwordx4 v18, s[32:35], s47 offen lds
    s_mov_b32 m0, 138240
    s_add_u32 s47, s61, 5120
    buffer_load_dwordx4 v18, s[32:35], s47 offen lds
    s_mov_b32 m0, 139264
    s_add_u32 s47, s61, 6144
    buffer_load_dwordx4 v18, s[32:35], s47 offen lds
    s_mov_b32 m0, 140288
    s_add_u32 s47, s61, 7168
    buffer_load_dwordx4 v18, s[32:35], s47 offen lds
    s_waitcnt vmcnt(48)
    s_barrier
    s_add_u32 s61, s62, 106496
    s_and_b32 s61, s61, 0x1ffff
    s_mov_b32 m0, 67584
    s_add_u32 s47, s61, 0
    buffer_load_dwordx4 v3, s[28:31], s47 offen lds
    s_mov_b32 m0, 68608
    s_add_u32 s47, s61, 0
    buffer_load_dwordx4 v4, s[28:31], s47 offen lds
    s_mov_b32 m0, 69632
    s_add_u32 s47, s61, 0
    buffer_load_dwordx4 v5, s[28:31], s47 offen lds
    s_mov_b32 m0, 70656
    s_add_u32 s47, s61, 0
    buffer_load_dwordx4 v9, s[28:31], s47 offen lds
    s_mov_b32 m0, 71680
    s_add_u32 s47, s61, 4096
    buffer_load_dwordx4 v3, s[28:31], s47 offen lds
    s_mov_b32 m0, 72704
    s_add_u32 s47, s61, 4096
    buffer_load_dwordx4 v4, s[28:31], s47 offen lds
    s_mov_b32 m0, 73728
    s_add_u32 s47, s61, 4096
    buffer_load_dwordx4 v5, s[28:31], s47 offen lds
    s_mov_b32 m0, 74752
    s_add_u32 s47, s61, 4096
    buffer_load_dwordx4 v9, s[28:31], s47 offen lds
    s_add_u32 s61, s62, 81920
    s_and_b32 s61, s61, 0x1ffff
    s_mov_b32 m0, 149504
    s_add_u32 s47, s61, 0
    buffer_load_dwordx4 v18, s[32:35], s47 offen lds
    s_mov_b32 m0, 150528
    s_add_u32 s47, s61, 1024
    buffer_load_dwordx4 v18, s[32:35], s47 offen lds
    s_mov_b32 m0, 151552
    s_add_u32 s47, s61, 2048
    buffer_load_dwordx4 v18, s[32:35], s47 offen lds
    s_mov_b32 m0, 152576
    s_add_u32 s47, s61, 3072
    buffer_load_dwordx4 v18, s[32:35], s47 offen lds
    s_mov_b32 m0, 153600
    s_add_u32 s47, s61, 4096
    buffer_load_dwordx4 v18, s[32:35], s47 offen lds
    s_mov_b32 m0, 154624
    s_add_u32 s47, s61, 5120
    buffer_load_dwordx4 v18, s[32:35], s47 offen lds
    s_mov_b32 m0, 155648
    s_add_u32 s47, s61, 6144
    buffer_load_dwordx4 v18, s[32:35], s47 offen lds
    s_mov_b32 m0, 156672
    s_add_u32 s47, s61, 7168
    buffer_load_dwordx4 v18, s[32:35], s47 offen lds
    s_add_u32 m0, s54, 0
    s_add_u32 s47, s92, 0
    buffer_load_dwordx4 v26, s[72:75], s47 offen lds
    s_add_u32 m0, s54, 1024
    s_add_u32 s47, s92, 0
    buffer_load_dwordx4 v27, s[72:75], s47 offen lds
    s_add_u32 s46, s94, 0
    s_cmp_lt_u32 s45, 4
    s_cselect_b32 m0, s46, s57
    s_add_u32 s47, s93, 512
    buffer_load_dwordx4 v28, s[72:75], s47 offen lds
    s_waitcnt vmcnt(51)
    s_barrier
    s_add_u32 s61, s62, 114688
    s_and_b32 s61, s61, 0x1ffff
    s_mov_b32 m0, 75776
    s_add_u32 s47, s61, 0
    buffer_load_dwordx4 v3, s[28:31], s47 offen lds
    s_mov_b32 m0, 76800
    s_add_u32 s47, s61, 0
    buffer_load_dwordx4 v4, s[28:31], s47 offen lds
    s_mov_b32 m0, 77824
    s_add_u32 s47, s61, 0
    buffer_load_dwordx4 v5, s[28:31], s47 offen lds
    s_mov_b32 m0, 78848
    s_add_u32 s47, s61, 0
    buffer_load_dwordx4 v9, s[28:31], s47 offen lds
    s_mov_b32 m0, 79872
    s_add_u32 s47, s61, 4096
    buffer_load_dwordx4 v3, s[28:31], s47 offen lds
    s_mov_b32 m0, 80896
    s_add_u32 s47, s61, 4096
    buffer_load_dwordx4 v4, s[28:31], s47 offen lds
    s_mov_b32 m0, 81920
    s_add_u32 s47, s61, 4096
    buffer_load_dwordx4 v5, s[28:31], s47 offen lds
    s_mov_b32 m0, 82944
    s_add_u32 s47, s61, 4096
    buffer_load_dwordx4 v9, s[28:31], s47 offen lds
    s_add_u32 s61, s62, 90112
    s_and_b32 s61, s61, 0x1ffff
    s_mov_b32 m0, 92160
    s_add_u32 s47, s61, 0
    buffer_load_dwordx4 v18, s[32:35], s47 offen lds
    s_mov_b32 m0, 93184
    s_add_u32 s47, s61, 1024
    buffer_load_dwordx4 v18, s[32:35], s47 offen lds
    s_mov_b32 m0, 94208
    s_add_u32 s47, s61, 2048
    buffer_load_dwordx4 v18, s[32:35], s47 offen lds
    s_mov_b32 m0, 95232
    s_add_u32 s47, s61, 3072
    buffer_load_dwordx4 v18, s[32:35], s47 offen lds
    s_mov_b32 m0, 96256
    s_add_u32 s47, s61, 4096
    buffer_load_dwordx4 v18, s[32:35], s47 offen lds
    s_mov_b32 m0, 97280
    s_add_u32 s47, s61, 5120
    buffer_load_dwordx4 v18, s[32:35], s47 offen lds
    s_mov_b32 m0, 98304
    s_add_u32 s47, s61, 6144
    buffer_load_dwordx4 v18, s[32:35], s47 offen lds
    s_mov_b32 m0, 99328
    s_add_u32 s47, s61, 7168
    buffer_load_dwordx4 v18, s[32:35], s47 offen lds
    s_waitcnt vmcnt(51)
    s_barrier
    s_add_u32 s61, s62, 122880
    s_and_b32 s61, s61, 0x1ffff
    s_mov_b32 m0, 83968
    s_add_u32 s47, s61, 0
    buffer_load_dwordx4 v3, s[28:31], s47 offen lds
    s_mov_b32 m0, 84992
    s_add_u32 s47, s61, 0
    buffer_load_dwordx4 v4, s[28:31], s47 offen lds
    s_mov_b32 m0, 86016
    s_add_u32 s47, s61, 0
    buffer_load_dwordx4 v5, s[28:31], s47 offen lds
    s_mov_b32 m0, 87040
    s_add_u32 s47, s61, 0
    buffer_load_dwordx4 v9, s[28:31], s47 offen lds
    s_mov_b32 m0, 88064
    s_add_u32 s47, s61, 4096
    buffer_load_dwordx4 v3, s[28:31], s47 offen lds
    s_mov_b32 m0, 89088
    s_add_u32 s47, s61, 4096
    buffer_load_dwordx4 v4, s[28:31], s47 offen lds
    s_mov_b32 m0, 90112
    s_add_u32 s47, s61, 4096
    buffer_load_dwordx4 v5, s[28:31], s47 offen lds
    s_mov_b32 m0, 91136
    s_add_u32 s47, s61, 4096
    buffer_load_dwordx4 v9, s[28:31], s47 offen lds
    s_add_u32 s61, s62, 98304
    s_and_b32 s61, s61, 0x1ffff
    s_mov_b32 m0, 108544
    s_add_u32 s47, s61, 0
    buffer_load_dwordx4 v18, s[32:35], s47 offen lds
    s_mov_b32 m0, 109568
    s_add_u32 s47, s61, 1024
    buffer_load_dwordx4 v18, s[32:35], s47 offen lds
    s_mov_b32 m0, 110592
    s_add_u32 s47, s61, 2048
    buffer_load_dwordx4 v18, s[32:35], s47 offen lds
    s_mov_b32 m0, 111616
    s_add_u32 s47, s61, 3072
    buffer_load_dwordx4 v18, s[32:35], s47 offen lds
    s_mov_b32 m0, 112640
    s_add_u32 s47, s61, 4096
    buffer_load_dwordx4 v18, s[32:35], s47 offen lds
    s_mov_b32 m0, 113664
    s_add_u32 s47, s61, 5120
    buffer_load_dwordx4 v18, s[32:35], s47 offen lds
    s_mov_b32 m0, 114688
    s_add_u32 s47, s61, 6144
    buffer_load_dwordx4 v18, s[32:35], s47 offen lds
    s_mov_b32 m0, 115712
    s_add_u32 s47, s61, 7168
    buffer_load_dwordx4 v18, s[32:35], s47 offen lds
    s_add_u32 m0, s54, 20480
    s_add_u32 s47, s92, 36864
    buffer_load_dwordx4 v26, s[72:75], s47 offen lds
    s_add_u32 m0, s54, 21504
    s_add_u32 s47, s92, 36864
    buffer_load_dwordx4 v27, s[72:75], s47 offen lds
    s_add_u32 s46, s94, 20480
    s_cmp_lt_u32 s45, 4
    s_cselect_b32 m0, s46, s57
    s_add_u32 s47, s93, 37376
    buffer_load_dwordx4 v28, s[72:75], s47 offen lds
    s_waitcnt vmcnt(54)
    s_barrier
    s_add_u32 s61, s62, 106496
    s_and_b32 s61, s61, 0x1ffff
    s_mov_b32 m0, 124928
    s_add_u32 s47, s61, 0
    buffer_load_dwordx4 v18, s[32:35], s47 offen lds
    s_mov_b32 m0, 125952
    s_add_u32 s47, s61, 1024
    buffer_load_dwordx4 v18, s[32:35], s47 offen lds
    s_mov_b32 m0, 126976
    s_add_u32 s47, s61, 2048
    buffer_load_dwordx4 v18, s[32:35], s47 offen lds
    s_mov_b32 m0, 128000
    s_add_u32 s47, s61, 3072
    buffer_load_dwordx4 v18, s[32:35], s47 offen lds
    s_mov_b32 m0, 129024
    s_add_u32 s47, s61, 4096
    buffer_load_dwordx4 v18, s[32:35], s47 offen lds
    s_mov_b32 m0, 130048
    s_add_u32 s47, s61, 5120
    buffer_load_dwordx4 v18, s[32:35], s47 offen lds
    s_mov_b32 m0, 131072
    s_add_u32 s47, s61, 6144
    buffer_load_dwordx4 v18, s[32:35], s47 offen lds
    s_mov_b32 m0, 132096
    s_add_u32 s47, s61, 7168
    buffer_load_dwordx4 v18, s[32:35], s47 offen lds
    s_waitcnt vmcnt(46)
    s_barrier
    s_add_u32 s61, s62, 114688
    s_and_b32 s61, s61, 0x1ffff
    s_mov_b32 m0, 133120
    s_add_u32 s47, s61, 0
    buffer_load_dwordx4 v18, s[32:35], s47 offen lds
    s_mov_b32 m0, 134144
    s_add_u32 s47, s61, 1024
    buffer_load_dwordx4 v18, s[32:35], s47 offen lds
    s_mov_b32 m0, 135168
    s_add_u32 s47, s61, 2048
    buffer_load_dwordx4 v18, s[32:35], s47 offen lds
    s_mov_b32 m0, 136192
    s_add_u32 s47, s61, 3072
    buffer_load_dwordx4 v18, s[32:35], s47 offen lds
    s_mov_b32 m0, 137216
    s_add_u32 s47, s61, 4096
    buffer_load_dwordx4 v18, s[32:35], s47 offen lds
    s_mov_b32 m0, 138240
    s_add_u32 s47, s61, 5120
    buffer_load_dwordx4 v18, s[32:35], s47 offen lds
    s_mov_b32 m0, 139264
    s_add_u32 s47, s61, 6144
    buffer_load_dwordx4 v18, s[32:35], s47 offen lds
    s_mov_b32 m0, 140288
    s_add_u32 s47, s61, 7168
    buffer_load_dwordx4 v18, s[32:35], s47 offen lds
    s_waitcnt vmcnt(35)
    s_barrier
    s_add_u32 s61, s62, 122880
    s_and_b32 s61, s61, 0x1ffff
    s_mov_b32 m0, 149504
    s_add_u32 s47, s61, 0
    buffer_load_dwordx4 v18, s[32:35], s47 offen lds
    s_mov_b32 m0, 150528
    s_add_u32 s47, s61, 1024
    buffer_load_dwordx4 v18, s[32:35], s47 offen lds
    s_mov_b32 m0, 151552
    s_add_u32 s47, s61, 2048
    buffer_load_dwordx4 v18, s[32:35], s47 offen lds
    s_mov_b32 m0, 152576
    s_add_u32 s47, s61, 3072
    buffer_load_dwordx4 v18, s[32:35], s47 offen lds
    s_mov_b32 m0, 153600
    s_add_u32 s47, s61, 4096
    buffer_load_dwordx4 v18, s[32:35], s47 offen lds
    s_mov_b32 m0, 154624
    s_add_u32 s47, s61, 5120
    buffer_load_dwordx4 v18, s[32:35], s47 offen lds
    s_mov_b32 m0, 155648
    s_add_u32 s47, s61, 6144
    buffer_load_dwordx4 v18, s[32:35], s47 offen lds
    s_mov_b32 m0, 156672
    s_add_u32 s47, s61, 7168
    buffer_load_dwordx4 v18, s[32:35], s47 offen lds
    s_add_u32 m0, s54, 40960
    s_add_u32 s47, s92, 73728
    buffer_load_dwordx4 v26, s[72:75], s47 offen lds
    s_add_u32 m0, s54, 41984
    s_add_u32 s47, s92, 73728
    buffer_load_dwordx4 v27, s[72:75], s47 offen lds
    s_add_u32 s46, s94, 40960
    s_cmp_lt_u32 s45, 4
    s_cselect_b32 m0, s46, s57
    s_add_u32 s47, s93, 74240
    buffer_load_dwordx4 v28, s[72:75], s47 offen lds
    s_waitcnt vmcnt(30)
    s_barrier
    s_waitcnt vmcnt(19)
    s_barrier
    s_add_u32 m0, s54, 61440
    s_add_u32 s47, s92, 110592
    buffer_load_dwordx4 v26, s[72:75], s47 offen lds
    s_add_u32 m0, s54, 62464
    s_add_u32 s47, s92, 110592
    buffer_load_dwordx4 v27, s[72:75], s47 offen lds
    s_add_u32 s46, s94, 61440
    s_cmp_lt_u32 s45, 4
    s_cselect_b32 m0, s46, s57
    s_add_u32 s47, s93, 111104
    buffer_load_dwordx4 v28, s[72:75], s47 offen lds
    s_waitcnt vmcnt(14)
    s_barrier
    s_waitcnt vmcnt(6)
    s_barrier
    s_barrier
    s_waitcnt vmcnt(0)
    s_branch concat_heads__gqa_block_cached__gqa_block_cached__near_ridge_kernel_p3
concat_heads__gqa_block_cached__gqa_block_cached__near_ridge_kernel_exit:
    s_endpgm
.section .rodata,"a"
.p2align 6
.amdhsa_kernel concat_heads__gqa_block_cached__gqa_block_cached__near_ridge_kernel
  .amdhsa_next_free_vgpr 252
  .amdhsa_next_free_sgpr 100
  .amdhsa_accum_offset 252
  .amdhsa_group_segment_fixed_size 0
  .amdhsa_kernarg_size 104
  .amdhsa_user_sgpr_count 2
  .amdhsa_user_sgpr_kernarg_segment_ptr 1
  .amdhsa_system_sgpr_workgroup_id_x 1
.end_amdhsa_kernel
```
